```python
import torch

def _softmax(x, axis=-1):
    return torch.softmax(x, dim=axis)

def _gelu(x):
    return torch.nn.functional.gelu(x, approximate='tanh')

def _silu(x):
    return torch.nn.functional.silu(x)

def _sigmoid(x):
    return torch.sigmoid(x)

def _layernorm(x, axis=-1, eps=1e-05):
    m = x.mean(dim=axis, keepdim=True)
    v = x.var(dim=axis, keepdim=True, unbiased=False)
    return (x - m) / torch.sqrt(v + eps)

def _scatter_add(tgt, idx, src, axis=0):
    return tgt.clone().index_add_(axis, idx, src)

def _segment_sum(src, seg, n):
    out = torch.zeros((n,) + src.shape[1:], dtype=src.dtype)
    return out.index_add_(0, seg, src)

def _pad(x, pw):
    flat = tuple((v for pair in reversed(pw) for v in pair))
    return torch.nn.functional.pad(x, flat)
kernel_name = 'adaLN_cond__ssm_conv_h3__glu_gated_reglu__prompt'

def setup_inputs():

    _w = lambda a: (lambda t: t.to(torch.bfloat16) if t.is_floating_point() else t)(torch.as_tensor(a))

    def _A_setup():
        B, S, D = (1, 2048, 640)
        ks = 4
        return {'q': _w((lambda *s: torch.randn(*s, dtype=torch.bfloat16) * 0.05)(B, S, D)), 'k': _w((lambda *s: torch.randn(*s, dtype=torch.bfloat16) * 1.6)(B, S, D)), 'v': _w((lambda *s: torch.randn(*s, dtype=torch.bfloat16) * 1.6)(B, S, D)), 'shift_k': _w((lambda *s: torch.randn(*s, dtype=torch.bfloat16) * 1.6)(D, ks) * 0.5), 'ssm_k': _w((lambda *s: torch.randn(*s, dtype=torch.bfloat16) * 1.6)(D, S) * (1.0 / S ** 0.5)), 'ssm_D': _w((lambda *s: torch.randn(*s, dtype=torch.bfloat16) * 1.6)(D))}
    _A_in = _A_setup()

    def _B_setup():
        B, S, D, F = (1, 2048, 640, 1728)
        return {'x': _w((lambda *s: torch.randn(*s, dtype=torch.bfloat16) * 0.05)(B, S, D)), 'W_gate': _w((lambda *s: torch.randn(*s, dtype=torch.bfloat16) * 3.2)(D, F) * (2.0 / D) ** 0.5), 'W_up': _w((lambda *s: torch.randn(*s, dtype=torch.bfloat16) * 3.2)(D, F) * (2.0 / D) ** 0.5), 'W_down': _w((lambda *s: torch.randn(*s, dtype=torch.bfloat16) * 3.2)(F, D) * (1.0 / F) ** 0.5)}
    _B_in = _B_setup()
    return {'A_q': _A_in['q'], 'A_k': _A_in['k'], 'A_v': _A_in['v'], 'A_shift_k': _A_in['shift_k'], 'A_ssm_k': _A_in['ssm_k'], 'A_ssm_D': _A_in['ssm_D'], 'B_x': _B_in['x'], 'B_W_gate': _B_in['W_gate'], 'B_W_up': _B_in['W_up'], 'B_W_down': _B_in['W_down'], 'c': _w((lambda *s: torch.randn(*s, dtype=torch.bfloat16) * 0.1)(1, 640) * 8.0), 'w_mod': _w((lambda *s: torch.randn(*s, dtype=torch.bfloat16) * 0.1)(640, 6 * 640) * 640 ** (-0.5) * 8.0)}

def reference(A_q, A_k, A_v, A_shift_k, A_ssm_k, A_ssm_D, B_x, B_W_gate, B_W_up, B_W_down, c, w_mod):

    def _A_ref(q, k, v, shift_k, ssm_k, ssm_D):
        B, S, D = q.shape
        ks = shift_k.shape[-1]
        k_pad = _pad(k, ((0, 0), (ks - 1, 0), (0, 0)))
        k_shift = torch.zeros_like(k)
        for t in range(ks):
            k_shift = k_shift + k_pad[:, t:t + S, :] * shift_k[:, ks - 1 - t][None, None, :]
        kv = k_shift * v
        L = 2 * S
        kv_pad = _pad(kv, ((0, 0), (0, S), (0, 0)))
        kf_pad = _pad(ssm_k, ((0, 0), (0, S)))
        kv_f = (lambda x, axes=(-2, -1): torch.fft.rfft2(x.float(), dim=axes))(kv_pad[:, None, :, :], axes=(1, 2))
        kf_f = (lambda x, axes=(-2, -1): torch.fft.rfft2(x.float(), dim=axes))(kf_pad[:, None, :], axes=(1, 2))
        kf_f = (lambda x, *d: x.permute(*d))(kf_f, 1, 2, 0)
        y_f = kv_f * kf_f[None, :, :, :]
        y = (lambda x, s, axes=(-2, -1): torch.fft.irfft2(x, s=s, dim=axes).to(torch.bfloat16))(y_f, (1, L), axes=(1, 2))[:, 0, :S, :]
        y = y + kv * ssm_D[None, None, :]
        return q * y

    def _B_ref(x, W_gate, W_up, W_down):
        gate = torch.einsum('bsd,df->bsf', x, W_gate)
        up = torch.einsum('bsd,df->bsf', x, W_up)
        gate = gate * (lambda x, dt: x.to(dt))(gate > 0, gate.dtype)
        h = gate * up
        return torch.einsum('bsf,fd->bsd', h, W_down)
    x = A_q
    mod = (_silu(c) @ w_mod).reshape(c.shape[0], 6, 1, -1)
    sa, ca, ga, sb, cb, gb = (mod[:, 0].clone(), mod[:, 1].clone(), mod[:, 2].clone(), mod[:, 3].clone(), mod[:, 4].clone(), mod[:, 5].clone())
    h = _layernorm(x, axis=-1) * (1 + ca) + sa
    x = x + ga * _A_ref(h, A_k, A_v, A_shift_k, A_ssm_k, A_ssm_D)
    h = _layernorm(x, axis=-1) * (1 + cb) + sb
    x = x + gb * _B_ref(h, B_W_gate, B_W_up, B_W_down)
    return x
```

```asm
; @launch grid=(256,1,1) block=(256,1,1) lds=160768
.amdgcn_target "amdgcn-amd-amdhsa--gfx950"
.text
.globl adaLN_cond__ssm_conv_h3__glu_gated_reglu__prompt_kernel
.type adaLN_cond__ssm_conv_h3__glu_gated_reglu__prompt_kernel,@function
.p2align 8
adaLN_cond__ssm_conv_h3__glu_gated_reglu__prompt_kernel:
    s_cmp_ge_u32 s2, 256
    s_cbranch_scc1 L_end
    s_load_dwordx8 s[4:11], s[0:1], 0
    s_load_dwordx4 s[12:15], s[0:1], 32
    s_load_dwordx2 s[16:17], s[0:1], 112
    s_load_dwordx2 s[18:19], s[0:1], 96
    s_load_dwordx8 s[44:51], s[0:1], 56
    s_load_dwordx2 s[52:53], s[0:1], 88
    s_getpc_b64 s[54:55]
    s_lshr_b32 s3, s2, 3
    s_mul_i32 s3, s3, 1280
    v_min_u32 v3, 9, v0
    v_lshl_add_u32 v3, v3, 7, s3
    global_load_dword v254, v3, s[54:55]
    v_lshrrev_b32 v1, 6, v0
    v_and_b32 v2, 63, v0
    s_lshl_b32 s65, s2, 7
    v_readfirstlane_b32 s3, v1
    s_cmp_ge_u32 s2, 160
    s_cbranch_scc1 L_aux
    s_and_b32 s20, s2, 15
    s_lshr_b32 s21, s2, 4
    s_mul_i32 s22, s20, 163840
    s_lshl_b32 s23, s21, 7
    s_add_u32 s22, s22, s23
    v_and_b32 v5, 15, v0
    v_lshrrev_b32 v6, 4, v0
    v_mul_u32_u24 v7, 10240, v6
    v_lshl_add_u32 v7, v5, 3, v7
    v_add_u32 v7, s22, v7
    v_subrev_u32 v8, 3840, v7
    s_lshl_b32 s23, s21, 9
    v_lshl_add_u32 v9, v5, 5, s23
    s_movk_i32 s22, 5120
    s_waitcnt lgkmcnt(0)
    s_mov_b32 s24, s6
    s_mov_b32 s25, s7
    s_mov_b32 s26, 0x280000
    s_mov_b32 s27, 0x20000
    s_mov_b32 s28, s8
    s_mov_b32 s29, s9
    s_mov_b32 s30, 0x280000
    s_mov_b32 s31, 0x20000
    s_mov_b32 s32, s10
    s_mov_b32 s33, s11
    s_mov_b32 s34, 0x1400
    s_mov_b32 s35, 0x20000
    buffer_load_dwordx2 v[70:71], v7, s[24:27], 0 offen offset:0 nt
    buffer_load_dwordx2 v[72:73], v7, s[24:27], 0 offen offset:1280 nt
    buffer_load_dwordx2 v[74:75], v7, s[24:27], 0 offen offset:2560 nt
    buffer_load_dwordx2 v[76:77], v7, s[24:27], 0 offen offset:3840 nt
    buffer_load_dwordx2 v[78:79], v7, s[24:27], s22 offen offset:0 nt
    buffer_load_dwordx2 v[80:81], v7, s[24:27], s22 offen offset:1280 nt
    buffer_load_dwordx2 v[82:83], v7, s[24:27], s22 offen offset:2560 nt
    buffer_load_dwordx2 v[84:85], v7, s[24:27], s22 offen offset:3840 nt
    buffer_load_dwordx4 v[118:121], v9, s[32:35], 0 offen
    buffer_load_dwordx4 v[122:125], v9, s[32:35], 0 offen offset:16
    buffer_load_dwordx2 v[64:65], v8, s[24:27], 0 offen offset:0 nt
    buffer_load_dwordx2 v[66:67], v8, s[24:27], 0 offen offset:1280 nt
    buffer_load_dwordx2 v[68:69], v8, s[24:27], 0 offen offset:2560 nt
    buffer_load_dwordx2 v[86:87], v7, s[28:31], 0 offen offset:0 nt
    buffer_load_dwordx2 v[88:89], v7, s[28:31], 0 offen offset:1280 nt
    buffer_load_dwordx2 v[90:91], v7, s[28:31], 0 offen offset:2560 nt
    buffer_load_dwordx2 v[92:93], v7, s[28:31], 0 offen offset:3840 nt
    buffer_load_dwordx2 v[94:95], v7, s[28:31], s22 offen offset:0 nt
    buffer_load_dwordx2 v[96:97], v7, s[28:31], s22 offen offset:1280 nt
    buffer_load_dwordx2 v[98:99], v7, s[28:31], s22 offen offset:2560 nt
    buffer_load_dwordx2 v[100:101], v7, s[28:31], s22 offen offset:3840 nt
    s_add_u32 s56, s16, 0x16c0000
    s_addc_u32 s57, s17, 0
    s_mov_b32 s58, 0x50000
    s_mov_b32 s59, 0x20000
    v_mov_b32 v10, 32768
    buffer_load_dword v10, v10, s[56:59], 0 offen sc1
    s_mov_b64 s[68:69], s[48:49]
    s_mov_b32 s48, s4
    s_mov_b32 s49, s5
    s_mov_b32 s50, 0x280000
    s_mov_b32 s51, 0x20000
    s_and_b32 s43, s2, 7
    s_mul_i32 s43, s43, 20
    s_lshr_b32 s36, s2, 3
    s_add_u32 s43, s43, s36
    s_lshl_b32 s36, s43, 2
    s_add_u32 s36, s36, s3
    s_lshl_b32 s37, s36, 12
    s_mul_i32 s38, s3, 12928
    v_lshlrev_b32 v3, 4, v2
    v_subrev_u32 v4, 4, v3
    s_lshl_b32 s39, s36, 1
    v_mov_b32 v11, s39
    v_cmp_eq_u32 vcc, 0, v2
    v_mov_b32 v12, 0x7fffffff
    s_add_u32 s44, s12, s37
    v_cndmask_b32 v11, v12, v11, vcc
    s_addc_u32 s45, s13, 0
    s_movk_i32 s46, 4096
    s_mov_b32 s47, 0x20000
    s_mul_i32 s42, s2, 20480
    v_mul_u32_u24 v14, 1280, v6
    v_lshl_add_u32 v14, v5, 4, v14
    s_mov_b32 s32, s14
    s_mov_b32 s33, s15
    s_mov_b32 s34, 0x500
    s_mov_b32 s35, 0x20000
    s_mov_b32 s24, s16
    s_mov_b32 s25, s17
    s_mov_b32 s26, 0x280000
    s_mov_b32 s27, 0x20000
    s_add_u32 s28, s16, 0x1520000
    s_addc_u32 s29, s17, 0
    s_mov_b32 s30, 0x18000
    s_mov_b32 s31, 0x20000
    s_add_u32 s52, s16, 0x280000
    s_addc_u32 s53, s17, 0
    s_mov_b32 s54, 0x280000
    s_mov_b32 s55, 0x20000
    v_mul_u32_u24 v12, 272, v5
    v_lshl_add_u32 v12, v6, 4, v12
    v_add_u32 v12, 53248, v12
    v_mul_u32_u24 v13, 272, v6
    v_lshl_add_u32 v13, v5, 4, v13
    v_add_u32 v13, 53248, v13
    v_lshlrev_b32 v8, 14, v6
    v_lshl_add_u32 v8, v5, 4, v8
    s_lshl_b32 s22, s21, 18
    s_lshl_b32 s23, s20, 8
    s_add_u32 s40, s22, s23
    s_lshl_b32 s23, s20, 10
    s_add_u32 s41, s22, s23
    v_mul_u32_u24 v7, 288, v5
    v_lshl_add_u32 v7, v6, 3, v7
    v_add_u32 v7, 71680, v7
    v_lshrrev_b32 v9, 3, v0
    v_and_b32 v37, 7, v0
    v_mul_u32_u24 v15, 144, v9
    v_lshl_add_u32 v15, v37, 4, v15
    v_add_u32 v15, 71680, v15
    v_lshlrev_b32 v9, 14, v9
    v_lshl_add_u32 v9, v37, 4, v9
    s_lshl_b32 s41, s2, 7
    s_cmp_ge_u32 s2, 128
    s_cselect_b32 s41, 0x40000000, s41
    v_mov_b32 v38, 0
    v_mov_b32 v39, 0
    v_lshl_add_u32 v37, v2, 3, s38
    ds_write_b64 v37, v[38:39] offset:8320
    v_and_b32 v37, 3, v2
    v_lshl_add_u32 v37, v37, 3, s38
    ds_write_b64 v37, v[38:39]
    ds_write_b64 v37, v[38:39] offset:4160
    buffer_load_dwordx4 v[16:19], v3, s[44:47], 0 offen offset:0 nt
    buffer_load_dwordx4 v[20:23], v3, s[44:47], 0 offen offset:1024 nt
    buffer_load_dwordx4 v[24:27], v3, s[44:47], 0 offen offset:2048 nt
    buffer_load_dwordx4 v[28:31], v3, s[44:47], 0 offen offset:3072 nt
    buffer_load_dword v32, v4, s[44:47], 0 offen nt
    buffer_load_dword v33, v3, s[44:47], 0 offen offset:1020 nt
    buffer_load_dword v34, v3, s[44:47], 0 offen offset:2044 nt
    buffer_load_dword v35, v3, s[44:47], 0 offen offset:3068 nt
    buffer_load_ushort v36, v11, s[32:35], 0 offen
    buffer_load_dwordx4 v[224:227], v14, s[48:51], s42 offen offset:0 nt
    buffer_load_dwordx4 v[228:231], v14, s[48:51], s42 offen offset:256 nt
    buffer_load_dwordx4 v[232:235], v14, s[48:51], s42 offen offset:512 nt
    buffer_load_dwordx4 v[236:239], v14, s[48:51], s42 offen offset:768 nt
    buffer_load_dwordx4 v[240:243], v14, s[48:51], s42 offen offset:1024 nt
    s_waitcnt vmcnt(23)
    v_lshlrev_b32 v128, 16, v118
    v_lshlrev_b32 v129, 16, v120
    v_and_b32 v130, 0xffff0000, v118
    v_and_b32 v131, 0xffff0000, v120
    v_lshlrev_b32 v132, 16, v119
    v_lshlrev_b32 v133, 16, v121
    v_and_b32 v134, 0xffff0000, v119
    v_and_b32 v135, 0xffff0000, v121
    v_lshlrev_b32 v136, 16, v122
    v_lshlrev_b32 v137, 16, v124
    v_and_b32 v138, 0xffff0000, v122
    v_and_b32 v139, 0xffff0000, v124
    v_lshlrev_b32 v140, 16, v123
    v_lshlrev_b32 v141, 16, v125
    v_and_b32 v142, 0xffff0000, v123
    v_and_b32 v143, 0xffff0000, v125
    v_lshlrev_b32 v144, 16, v64
    v_and_b32 v145, 0xffff0000, v64
    v_lshlrev_b32 v146, 16, v65
    v_and_b32 v147, 0xffff0000, v65
    v_lshlrev_b32 v148, 16, v66
    v_and_b32 v149, 0xffff0000, v66
    v_lshlrev_b32 v150, 16, v67
    v_and_b32 v151, 0xffff0000, v67
    v_lshlrev_b32 v152, 16, v68
    v_and_b32 v153, 0xffff0000, v68
    v_lshlrev_b32 v154, 16, v69
    v_and_b32 v155, 0xffff0000, v69
    v_lshlrev_b32 v156, 16, v70
    v_and_b32 v157, 0xffff0000, v70
    v_lshlrev_b32 v158, 16, v71
    v_and_b32 v159, 0xffff0000, v71
    v_lshlrev_b32 v160, 16, v72
    v_and_b32 v161, 0xffff0000, v72
    v_lshlrev_b32 v162, 16, v73
    v_and_b32 v163, 0xffff0000, v73
    v_lshlrev_b32 v164, 16, v74
    v_and_b32 v165, 0xffff0000, v74
    v_lshlrev_b32 v166, 16, v75
    v_and_b32 v167, 0xffff0000, v75
    v_lshlrev_b32 v168, 16, v76
    v_and_b32 v169, 0xffff0000, v76
    v_lshlrev_b32 v170, 16, v77
    v_and_b32 v171, 0xffff0000, v77
    v_lshlrev_b32 v172, 16, v78
    v_and_b32 v173, 0xffff0000, v78
    v_lshlrev_b32 v174, 16, v79
    v_and_b32 v175, 0xffff0000, v79
    v_lshlrev_b32 v176, 16, v80
    v_and_b32 v177, 0xffff0000, v80
    v_lshlrev_b32 v178, 16, v81
    v_and_b32 v179, 0xffff0000, v81
    v_lshlrev_b32 v180, 16, v82
    v_and_b32 v181, 0xffff0000, v82
    v_lshlrev_b32 v182, 16, v83
    v_and_b32 v183, 0xffff0000, v83
    v_lshlrev_b32 v184, 16, v84
    v_and_b32 v185, 0xffff0000, v84
    v_lshlrev_b32 v186, 16, v85
    v_and_b32 v187, 0xffff0000, v85
    v_pk_mul_f32 v[188:189], v[144:145], v[134:135]
    v_pk_mul_f32 v[190:191], v[146:147], v[142:143]
    v_pk_mul_f32 v[192:193], v[148:149], v[134:135]
    v_pk_mul_f32 v[194:195], v[150:151], v[142:143]
    v_pk_mul_f32 v[196:197], v[152:153], v[134:135]
    v_pk_mul_f32 v[198:199], v[154:155], v[142:143]
    v_pk_mul_f32 v[200:201], v[156:157], v[134:135]
    v_pk_mul_f32 v[202:203], v[158:159], v[142:143]
    v_pk_mul_f32 v[204:205], v[160:161], v[134:135]
    v_pk_mul_f32 v[206:207], v[162:163], v[142:143]
    v_pk_mul_f32 v[208:209], v[164:165], v[134:135]
    v_pk_mul_f32 v[210:211], v[166:167], v[142:143]
    v_pk_mul_f32 v[212:213], v[168:169], v[134:135]
    v_pk_mul_f32 v[214:215], v[170:171], v[142:143]
    v_pk_mul_f32 v[216:217], v[172:173], v[134:135]
    v_pk_mul_f32 v[218:219], v[174:175], v[142:143]
    v_pk_fma_f32 v[188:189], v[148:149], v[132:133], v[188:189]
    v_pk_fma_f32 v[190:191], v[150:151], v[140:141], v[190:191]
    v_pk_fma_f32 v[192:193], v[152:153], v[132:133], v[192:193]
    v_pk_fma_f32 v[194:195], v[154:155], v[140:141], v[194:195]
    v_pk_fma_f32 v[196:197], v[156:157], v[132:133], v[196:197]
    v_pk_fma_f32 v[198:199], v[158:159], v[140:141], v[198:199]
    v_pk_fma_f32 v[200:201], v[160:161], v[132:133], v[200:201]
    v_pk_fma_f32 v[202:203], v[162:163], v[140:141], v[202:203]
    v_pk_fma_f32 v[204:205], v[164:165], v[132:133], v[204:205]
    v_pk_fma_f32 v[206:207], v[166:167], v[140:141], v[206:207]
    v_pk_fma_f32 v[208:209], v[168:169], v[132:133], v[208:209]
    v_pk_fma_f32 v[210:211], v[170:171], v[140:141], v[210:211]
    v_pk_fma_f32 v[212:213], v[172:173], v[132:133], v[212:213]
    v_pk_fma_f32 v[214:215], v[174:175], v[140:141], v[214:215]
    v_pk_fma_f32 v[216:217], v[176:177], v[132:133], v[216:217]
    v_pk_fma_f32 v[218:219], v[178:179], v[140:141], v[218:219]
    v_pk_fma_f32 v[188:189], v[152:153], v[130:131], v[188:189]
    v_pk_fma_f32 v[190:191], v[154:155], v[138:139], v[190:191]
    v_pk_fma_f32 v[192:193], v[156:157], v[130:131], v[192:193]
    v_pk_fma_f32 v[194:195], v[158:159], v[138:139], v[194:195]
    v_pk_fma_f32 v[196:197], v[160:161], v[130:131], v[196:197]
    v_pk_fma_f32 v[198:199], v[162:163], v[138:139], v[198:199]
    v_pk_fma_f32 v[200:201], v[164:165], v[130:131], v[200:201]
    v_pk_fma_f32 v[202:203], v[166:167], v[138:139], v[202:203]
    v_pk_fma_f32 v[204:205], v[168:169], v[130:131], v[204:205]
    v_pk_fma_f32 v[206:207], v[170:171], v[138:139], v[206:207]
    v_pk_fma_f32 v[208:209], v[172:173], v[130:131], v[208:209]
    v_pk_fma_f32 v[210:211], v[174:175], v[138:139], v[210:211]
    v_pk_fma_f32 v[212:213], v[176:177], v[130:131], v[212:213]
    v_pk_fma_f32 v[214:215], v[178:179], v[138:139], v[214:215]
    v_pk_fma_f32 v[216:217], v[180:181], v[130:131], v[216:217]
    v_pk_fma_f32 v[218:219], v[182:183], v[138:139], v[218:219]
    v_pk_fma_f32 v[188:189], v[156:157], v[128:129], v[188:189]
    v_pk_fma_f32 v[190:191], v[158:159], v[136:137], v[190:191]
    v_pk_fma_f32 v[192:193], v[160:161], v[128:129], v[192:193]
    v_pk_fma_f32 v[194:195], v[162:163], v[136:137], v[194:195]
    v_pk_fma_f32 v[196:197], v[164:165], v[128:129], v[196:197]
    v_pk_fma_f32 v[198:199], v[166:167], v[136:137], v[198:199]
    v_pk_fma_f32 v[200:201], v[168:169], v[128:129], v[200:201]
    v_pk_fma_f32 v[202:203], v[170:171], v[136:137], v[202:203]
    v_pk_fma_f32 v[204:205], v[172:173], v[128:129], v[204:205]
    v_pk_fma_f32 v[206:207], v[174:175], v[136:137], v[206:207]
    v_pk_fma_f32 v[208:209], v[176:177], v[128:129], v[208:209]
    v_pk_fma_f32 v[210:211], v[178:179], v[136:137], v[210:211]
    v_pk_fma_f32 v[212:213], v[180:181], v[128:129], v[212:213]
    v_pk_fma_f32 v[214:215], v[182:183], v[136:137], v[214:215]
    v_pk_fma_f32 v[216:217], v[184:185], v[128:129], v[216:217]
    v_pk_fma_f32 v[218:219], v[186:187], v[136:137], v[218:219]
    s_waitcnt vmcnt(14)
    v_readfirstlane_b32 s64, v10
    s_add_u32 s64, s64, 0x9e3779b1
    v_lshlrev_b32 v144, 16, v86
    v_and_b32 v145, 0xffff0000, v86
    v_lshlrev_b32 v146, 16, v87
    v_and_b32 v147, 0xffff0000, v87
    v_lshlrev_b32 v148, 16, v88
    v_and_b32 v149, 0xffff0000, v88
    v_lshlrev_b32 v150, 16, v89
    v_and_b32 v151, 0xffff0000, v89
    v_lshlrev_b32 v152, 16, v90
    v_and_b32 v153, 0xffff0000, v90
    v_lshlrev_b32 v154, 16, v91
    v_and_b32 v155, 0xffff0000, v91
    v_lshlrev_b32 v156, 16, v92
    v_and_b32 v157, 0xffff0000, v92
    v_lshlrev_b32 v158, 16, v93
    v_and_b32 v159, 0xffff0000, v93
    v_lshlrev_b32 v160, 16, v94
    v_and_b32 v161, 0xffff0000, v94
    v_lshlrev_b32 v162, 16, v95
    v_and_b32 v163, 0xffff0000, v95
    v_lshlrev_b32 v164, 16, v96
    v_and_b32 v165, 0xffff0000, v96
    v_lshlrev_b32 v166, 16, v97
    v_and_b32 v167, 0xffff0000, v97
    v_lshlrev_b32 v168, 16, v98
    v_and_b32 v169, 0xffff0000, v98
    v_lshlrev_b32 v170, 16, v99
    v_and_b32 v171, 0xffff0000, v99
    v_lshlrev_b32 v172, 16, v100
    v_and_b32 v173, 0xffff0000, v100
    v_lshlrev_b32 v174, 16, v101
    v_and_b32 v175, 0xffff0000, v101
    v_pk_mul_f32 v[188:189], v[188:189], v[144:145]
    v_pk_mul_f32 v[190:191], v[190:191], v[146:147]
    v_pk_mul_f32 v[192:193], v[192:193], v[148:149]
    v_pk_mul_f32 v[194:195], v[194:195], v[150:151]
    v_pk_mul_f32 v[196:197], v[196:197], v[152:153]
    v_pk_mul_f32 v[198:199], v[198:199], v[154:155]
    v_pk_mul_f32 v[200:201], v[200:201], v[156:157]
    v_pk_mul_f32 v[202:203], v[202:203], v[158:159]
    v_pk_mul_f32 v[204:205], v[204:205], v[160:161]
    v_pk_mul_f32 v[206:207], v[206:207], v[162:163]
    v_pk_mul_f32 v[208:209], v[208:209], v[164:165]
    v_pk_mul_f32 v[210:211], v[210:211], v[166:167]
    v_pk_mul_f32 v[212:213], v[212:213], v[168:169]
    v_pk_mul_f32 v[214:215], v[214:215], v[170:171]
    v_pk_mul_f32 v[216:217], v[216:217], v[172:173]
    v_pk_mul_f32 v[218:219], v[218:219], v[174:175]
    v_cvt_pk_bf16_f32 v64, v216, v212
    v_cvt_pk_bf16_f32 v65, v208, v204
    v_cvt_pk_bf16_f32 v66, v200, v196
    v_cvt_pk_bf16_f32 v67, v192, v188
    ds_write_b128 v12, v[64:67] offset:0
    v_cvt_pk_bf16_f32 v68, v217, v213
    v_cvt_pk_bf16_f32 v69, v209, v205
    v_cvt_pk_bf16_f32 v70, v201, v197
    v_cvt_pk_bf16_f32 v71, v193, v189
    ds_write_b128 v12, v[68:71] offset:4352
    v_cvt_pk_bf16_f32 v72, v218, v214
    v_cvt_pk_bf16_f32 v73, v210, v206
    v_cvt_pk_bf16_f32 v74, v202, v198
    v_cvt_pk_bf16_f32 v75, v194, v190
    ds_write_b128 v12, v[72:75] offset:8704
    v_cvt_pk_bf16_f32 v76, v219, v215
    v_cvt_pk_bf16_f32 v77, v211, v207
    v_cvt_pk_bf16_f32 v78, v203, v199
    v_cvt_pk_bf16_f32 v79, v195, v191
    ds_write_b128 v12, v[76:79] offset:13056
    s_add_u32 s60, s16, 0x1580000
    s_addc_u32 s61, s17, 0
    s_mov_b32 s62, 0xa0000
    s_mov_b32 s63, 0x20000
    v_lshlrev_b32 v12, 12, v6
    v_lshl_add_u32 v12, v5, 4, v12
    s_lshl_b32 s22, s21, 16
    s_lshl_b32 s23, s20, 8
    s_add_u32 s22, s22, s23
    s_waitcnt lgkmcnt(0)
    s_barrier
    ds_read_b128 v[144:147], v13 offset:0
    ds_read_b128 v[148:151], v13 offset:4352
    ds_read_b128 v[152:155], v13 offset:8704
    ds_read_b128 v[156:159], v13 offset:13056
    s_waitcnt lgkmcnt(3)
    buffer_store_dwordx4 v[144:147], v8, s[24:27], s40 offen sc1
    v_add3_u32 v64, v144, v145, v146
    v_alignbit_b32 v68, v147, v147, 13
    v_add3_u32 v64, v64, v68, s64
    s_add_u32 s40, s40, 4096
    s_waitcnt lgkmcnt(2)
    buffer_store_dwordx4 v[148:151], v8, s[24:27], s40 offen sc1
    v_add3_u32 v65, v148, v149, v150
    v_alignbit_b32 v68, v151, v151, 13
    v_add3_u32 v65, v65, v68, s64
    s_add_u32 s40, s40, 4096
    s_waitcnt lgkmcnt(1)
    buffer_store_dwordx4 v[152:155], v8, s[24:27], s40 offen sc1
    v_add3_u32 v66, v152, v153, v154
    v_alignbit_b32 v68, v155, v155, 13
    v_add3_u32 v66, v66, v68, s64
    s_add_u32 s40, s40, 4096
    s_waitcnt lgkmcnt(0)
    buffer_store_dwordx4 v[156:159], v8, s[24:27], s40 offen sc1
    v_add3_u32 v67, v156, v157, v158
    v_alignbit_b32 v68, v159, v159, 13
    v_add3_u32 v67, v67, v68, s64
    buffer_store_dwordx4 v[64:67], v12, s[60:63], s22 offen sc1
    s_getpc_b64 s[20:21]
L_pc_1:
    s_add_u32 s20, s20, L_uok-L_pc_1
    s_addc_u32 s21, s21, 0
    v_min_u32 v252, 59, v0
    v_lshlrev_b32 v252, 7, v252
    global_load_dword v252, v252, s[20:21]
    s_waitcnt vmcnt(11)
    v_add_u32 v10, s38, v3
    v_lshlrev_b32 v36, 16, v36
    v_lshlrev_b32 v37, 16, v16
    v_add_f32 v36, v36, v37
    v_cvt_pk_bf16_f32 v36, v36, v36
    s_mov_b32 s39, 0xffff
    v_bfi_b32 v16, s39, v36, v16
    ds_write_b128 v10, v[16:19] offset:32
    v_alignbit_b32 v40, v16, v32, 16
    v_alignbit_b32 v41, v17, v16, 16
    v_alignbit_b32 v42, v18, v17, 16
    v_alignbit_b32 v43, v19, v18, 16
    ds_write_b128 v10, v[40:43] offset:4192
    ds_write_b128 v10, v[20:23] offset:1056
    v_alignbit_b32 v44, v20, v33, 16
    v_alignbit_b32 v45, v21, v20, 16
    v_alignbit_b32 v46, v22, v21, 16
    v_alignbit_b32 v47, v23, v22, 16
    ds_write_b128 v10, v[44:47] offset:5216
    ds_write_b128 v10, v[24:27] offset:2080
    v_alignbit_b32 v48, v24, v34, 16
    v_alignbit_b32 v49, v25, v24, 16
    v_alignbit_b32 v50, v26, v25, 16
    v_alignbit_b32 v51, v27, v26, 16
    ds_write_b128 v10, v[48:51] offset:6240
    ds_write_b128 v10, v[28:31] offset:3104
    v_alignbit_b32 v52, v28, v35, 16
    v_alignbit_b32 v53, v29, v28, 16
    v_alignbit_b32 v54, v30, v29, 16
    v_alignbit_b32 v55, v31, v30, 16
    ds_write_b128 v10, v[52:55] offset:7264
    v_mov_b32 v124, v7
    v_mov_b32 v125, v15
    s_waitcnt vmcnt(6)
    ds_write_b64 v124, v[224:225] offset:0
    ds_write_b64 v124, v[226:227] offset:144
    ds_write_b64 v124, v[228:229] offset:4608
    ds_write_b64 v124, v[230:231] offset:4752
    ds_write_b64 v124, v[232:233] offset:9216
    ds_write_b64 v124, v[234:235] offset:9360
    ds_write_b64 v124, v[236:237] offset:13824
    ds_write_b64 v124, v[238:239] offset:13968
    ds_write_b64 v124, v[240:241] offset:18432
    ds_write_b64 v124, v[242:243] offset:18576
    s_waitcnt lgkmcnt(0)
    s_barrier
    ds_read_b128 v[160:163], v125 offset:0
    ds_read_b128 v[164:167], v125 offset:4608
    ds_read_b128 v[168:171], v125 offset:9216
    ds_read_b128 v[172:175], v125 offset:13824
    ds_read_b128 v[176:179], v125 offset:18432
    s_waitcnt lgkmcnt(4)
    buffer_store_dwordx4 v[160:163], v9, s[52:55], s41 offen sc1
    s_add_u32 s41, s41, 524288
    s_waitcnt lgkmcnt(3)
    buffer_store_dwordx4 v[164:167], v9, s[52:55], s41 offen sc1
    s_add_u32 s41, s41, 524288
    s_waitcnt lgkmcnt(2)
    buffer_store_dwordx4 v[168:171], v9, s[52:55], s41 offen sc1
    s_add_u32 s41, s41, 524288
    s_waitcnt lgkmcnt(1)
    buffer_store_dwordx4 v[172:175], v9, s[52:55], s41 offen sc1
    s_add_u32 s41, s41, 524288
    s_waitcnt lgkmcnt(0)
    buffer_store_dwordx4 v[176:179], v9, s[52:55], s41 offen sc1
    v_lshlrev_b32 v68, 16, v224
    v_and_b32 v69, 0xffff0000, v224
    v_pk_mul_f32 v[72:73], v[68:69], v[68:69]
    v_mov_b32 v70, v68
    v_mov_b32 v71, v69
    v_lshlrev_b32 v68, 16, v225
    v_and_b32 v69, 0xffff0000, v225
    v_pk_add_f32 v[70:71], v[70:71], v[68:69]
    v_pk_fma_f32 v[72:73], v[68:69], v[68:69], v[72:73]
    v_lshlrev_b32 v68, 16, v226
    v_and_b32 v69, 0xffff0000, v226
    v_pk_add_f32 v[70:71], v[70:71], v[68:69]
    v_pk_fma_f32 v[72:73], v[68:69], v[68:69], v[72:73]
    v_lshlrev_b32 v68, 16, v227
    v_and_b32 v69, 0xffff0000, v227
    v_pk_add_f32 v[70:71], v[70:71], v[68:69]
    v_pk_fma_f32 v[72:73], v[68:69], v[68:69], v[72:73]
    v_lshlrev_b32 v68, 16, v228
    v_and_b32 v69, 0xffff0000, v228
    v_pk_add_f32 v[70:71], v[70:71], v[68:69]
    v_pk_fma_f32 v[72:73], v[68:69], v[68:69], v[72:73]
    v_lshlrev_b32 v68, 16, v229
    v_and_b32 v69, 0xffff0000, v229
    v_pk_add_f32 v[70:71], v[70:71], v[68:69]
    v_pk_fma_f32 v[72:73], v[68:69], v[68:69], v[72:73]
    v_lshlrev_b32 v68, 16, v230
    v_and_b32 v69, 0xffff0000, v230
    v_pk_add_f32 v[70:71], v[70:71], v[68:69]
    v_pk_fma_f32 v[72:73], v[68:69], v[68:69], v[72:73]
    v_lshlrev_b32 v68, 16, v231
    v_and_b32 v69, 0xffff0000, v231
    v_pk_add_f32 v[70:71], v[70:71], v[68:69]
    v_pk_fma_f32 v[72:73], v[68:69], v[68:69], v[72:73]
    v_lshlrev_b32 v68, 16, v232
    v_and_b32 v69, 0xffff0000, v232
    v_pk_add_f32 v[70:71], v[70:71], v[68:69]
    v_pk_fma_f32 v[72:73], v[68:69], v[68:69], v[72:73]
    v_lshlrev_b32 v68, 16, v233
    v_and_b32 v69, 0xffff0000, v233
    v_pk_add_f32 v[70:71], v[70:71], v[68:69]
    v_pk_fma_f32 v[72:73], v[68:69], v[68:69], v[72:73]
    v_lshlrev_b32 v68, 16, v234
    v_and_b32 v69, 0xffff0000, v234
    v_pk_add_f32 v[70:71], v[70:71], v[68:69]
    v_pk_fma_f32 v[72:73], v[68:69], v[68:69], v[72:73]
    v_lshlrev_b32 v68, 16, v235
    v_and_b32 v69, 0xffff0000, v235
    v_pk_add_f32 v[70:71], v[70:71], v[68:69]
    v_pk_fma_f32 v[72:73], v[68:69], v[68:69], v[72:73]
    v_lshlrev_b32 v68, 16, v236
    v_and_b32 v69, 0xffff0000, v236
    v_pk_add_f32 v[70:71], v[70:71], v[68:69]
    v_pk_fma_f32 v[72:73], v[68:69], v[68:69], v[72:73]
    v_lshlrev_b32 v68, 16, v237
    v_and_b32 v69, 0xffff0000, v237
    v_pk_add_f32 v[70:71], v[70:71], v[68:69]
    v_pk_fma_f32 v[72:73], v[68:69], v[68:69], v[72:73]
    v_lshlrev_b32 v68, 16, v238
    v_and_b32 v69, 0xffff0000, v238
    v_pk_add_f32 v[70:71], v[70:71], v[68:69]
    v_pk_fma_f32 v[72:73], v[68:69], v[68:69], v[72:73]
    v_lshlrev_b32 v68, 16, v239
    v_and_b32 v69, 0xffff0000, v239
    v_pk_add_f32 v[70:71], v[70:71], v[68:69]
    v_pk_fma_f32 v[72:73], v[68:69], v[68:69], v[72:73]
    v_lshlrev_b32 v68, 16, v240
    v_and_b32 v69, 0xffff0000, v240
    v_pk_add_f32 v[70:71], v[70:71], v[68:69]
    v_pk_fma_f32 v[72:73], v[68:69], v[68:69], v[72:73]
    v_lshlrev_b32 v68, 16, v241
    v_and_b32 v69, 0xffff0000, v241
    v_pk_add_f32 v[70:71], v[70:71], v[68:69]
    v_pk_fma_f32 v[72:73], v[68:69], v[68:69], v[72:73]
    v_lshlrev_b32 v68, 16, v242
    v_and_b32 v69, 0xffff0000, v242
    v_pk_add_f32 v[70:71], v[70:71], v[68:69]
    v_pk_fma_f32 v[72:73], v[68:69], v[68:69], v[72:73]
    v_lshlrev_b32 v68, 16, v243
    v_and_b32 v69, 0xffff0000, v243
    v_pk_add_f32 v[70:71], v[70:71], v[68:69]
    v_pk_fma_f32 v[72:73], v[68:69], v[68:69], v[72:73]
    v_add_f32 v70, v70, v71
    v_add_f32 v72, v72, v73
    s_nop 0
    v_add_f32_dpp v70, v70, v70 row_ror:8 row_mask:0xf bank_mask:0xf
    v_add_f32_dpp v72, v72, v72 row_ror:8 row_mask:0xf bank_mask:0xf
    s_nop 0
    v_add_f32_dpp v70, v70, v70 row_ror:4 row_mask:0xf bank_mask:0xf
    v_add_f32_dpp v72, v72, v72 row_ror:4 row_mask:0xf bank_mask:0xf
    s_nop 0
    v_add_f32_dpp v70, v70, v70 row_ror:2 row_mask:0xf bank_mask:0xf
    v_add_f32_dpp v72, v72, v72 row_ror:2 row_mask:0xf bank_mask:0xf
    s_nop 0
    v_add_f32_dpp v70, v70, v70 row_ror:1 row_mask:0xf bank_mask:0xf
    v_add_f32_dpp v72, v72, v72 row_ror:1 row_mask:0xf bank_mask:0xf
    v_mul_f32 v70, 0xbacccccd, v70
    v_mul_f32 v72, 0x3acccccd, v72
    v_fma_f32 v72, -v70, v70, v72
    v_max_f32 v72, 0, v72
    v_add_f32 v72, 0x3727c5ac, v72
    v_rsq_f32 v72, v72
    v_mov_b32 v75, s64
    v_lshrrev_b32 v68, 4, v0
    v_lshlrev_b32 v68, 3, v68
    v_mov_b32 v73, v72
    v_mov_b32 v71, v70
    s_lshl_b32 s23, s2, 7
    s_cmp_ge_u32 s2, 128
    s_cselect_b32 s23, 0x40000000, s23
    v_and_b32 v69, 31, v2
    v_permlane16_swap_b32 v72, v73
    v_permlane16_swap_b32 v70, v71
    v_cmp_eq_u32 vcc, 0, v69
    v_cvt_pk_bf16_f32 v74, v70, v71
    s_mov_b64 exec, vcc
    buffer_store_dwordx4 v[72:75], v68, s[28:31], s23 offen sc1
    s_mov_b64 exec, -1
    v_and_b32 v11, 15, v2
    s_lshl_b32 s23, s3, 12
    v_and_b32 v8, 31, v2
    v_lshl_add_u32 v8, v8, 7, s23
    v_lshrrev_b32 v12, 4, v2
    v_lshlrev_b32 v13, 1, v11
    v_lshlrev_b32 v14, 4, v12
    v_sub_u32 v13, v13, v14
    v_and_b32 v15, 1, v2
    v_cmp_eq_u32 vcc, 0, v15
    v_mov_b32 v15, 4212
    v_mov_b32 v7, 50
    v_cndmask_b32 v15, v7, v15, vcc
    v_add3_u32 v56, v13, v15, s38
    v_add_u32 v57, 1024, v56
    v_add_u32 v58, 2048, v56
    v_add_u32 v59, 3072, v56
    v_lshl_add_u32 v60, v11, 5, v14
    v_add_u32 v60, 8352, v60
    v_add_u32 v60, s38, v60
    s_mul_i32 s39, s3, 4160
    v_lshlrev_b32 v61, 4, v11
    v_lshl_add_u32 v61, v12, 2, v61
    v_add_u32 v61, s39, v61
    v_add_u32 v61, 143360, v61
    v_bfe_u32 v13, v2, 2, 2
    v_mul_u32_u24 v62, 4160, v13
    v_lshl_add_u32 v62, v12, 5, v62
    v_and_b32 v13, 3, v2
    v_lshl_add_u32 v62, v13, 3, v62
    v_lshl_add_u32 v62, v1, 9, v62
    v_add_u32 v62, 143360, v62
    v_lshlrev_b32 v5, 4, v2
    v_lshl_add_u32 v5, v1, 12, v5
    s_lshl_b32 s22, s43, 14
    v_bfe_u32 v13, v2, 1, 2
    v_lshlrev_b32 v6, 3, v13
    s_lshl_b32 s23, s43, 5
    v_add_u32 v6, s23, v6
    s_lshl_b32 s39, s43, 12
    s_lshl_b32 s23, s3, 2
    s_add_u32 s39, s39, s23
    buffer_load_dwordx4 v[96:99], v3, s[24:27], s37 offen offset:0 sc1
    buffer_load_dwordx4 v[100:103], v3, s[24:27], s37 offen offset:1024 sc1
    buffer_load_dwordx4 v[104:107], v3, s[24:27], s37 offen offset:2048 sc1
    buffer_load_dwordx4 v[108:111], v3, s[24:27], s37 offen offset:3072 sc1
    buffer_load_dword v112, v3, s[60:63], s39 offen offset:0 sc1
    buffer_load_dword v113, v3, s[60:63], s39 offen offset:1024 sc1
    buffer_load_dword v114, v3, s[60:63], s39 offen offset:2048 sc1
    buffer_load_dword v115, v3, s[60:63], s39 offen offset:3072 sc1
    s_mov_b32 s44, s68
    s_mov_b32 s45, s69
    s_mov_b32 s46, 0x21c000
    s_mov_b32 s47, 0x20000
    s_and_b32 s66, s2, 1
    s_lshl_b32 s66, s66, 2
    s_lshr_b32 s20, s2, 6
    s_add_u32 s66, s66, s20
    s_mul_i32 s66, s66, 160
    s_mul_i32 s20, s3, 14
    s_lshr_b32 s21, s3, 1
    s_sub_u32 s20, s20, s21
    s_mul_i32 s20, s20, 40960
    s_add_u32 s20, s20, s66
    s_mul_i32 s21, s3, 15360
    s_add_u32 s21, s21, 57344
    v_add_u32 v7, 0, v2
    v_mul_u32_u24 v52, 205, v7
    v_lshrrev_b32 v52, 11, v52
    v_mul_u32_u24 v52, 1120, v52
    v_lshl_add_u32 v52, v2, 4, v52
    v_add_u32 v7, 64, v2
    v_mul_u32_u24 v53, 205, v7
    v_lshrrev_b32 v53, 11, v53
    v_mul_u32_u24 v53, 1120, v53
    v_lshl_add_u32 v53, v2, 4, v53
    v_add_u32 v7, 128, v2
    v_mul_u32_u24 v54, 205, v7
    v_lshrrev_b32 v54, 11, v54
    v_mul_u32_u24 v54, 1120, v54
    v_lshl_add_u32 v54, v2, 4, v54
    v_add_u32 v7, 192, v2
    v_mul_u32_u24 v55, 205, v7
    v_lshrrev_b32 v55, 11, v55
    v_mul_u32_u24 v55, 1120, v55
    v_lshl_add_u32 v55, v2, 4, v55
    v_add_u32 v7, 256, v2
    v_mul_u32_u24 v4, 205, v7
    v_lshrrev_b32 v4, 11, v4
    v_mul_u32_u24 v4, 1120, v4
    v_lshl_add_u32 v4, v7, 4, v4
    v_lshrrev_b32 v7, 4, v2
    v_mul_u32_u24 v7, 640, v7
    v_add_u32 v7, s21, v7
    v_lshrrev_b32 v51, 2, v2
    v_mul_u32_u24 v51, 160, v51
    v_add_u32 v7, v7, v51
    v_and_b32 v51, 3, v2
    v_lshl_add_u32 v7, v51, 3, v7
    s_waitcnt vmcnt(9)
    s_barrier
    s_cmp_lg_u32 s3, 0
    s_cbranch_scc1 L_sig_2
    v_mov_b32 v66, s64
    v_mov_b32 v67, 0
    s_mov_b64 exec, 1
    buffer_store_dword v66, v67, s[56:59], s65 offen offset:4 sc1
    s_mov_b64 exec, -1
L_sig_2:
    s_mov_b32 s66, 0x8000
    s_waitcnt vmcnt(1)
    s_cmp_eq_u32 s3, 0
    s_cbranch_scc1 L_uchk
L_uw:
    s_waitcnt vmcnt(0)
L_uchk:
    v_add3_u32 v116, v96, v97, v98
    v_alignbit_b32 v120, v99, v99, 13
    v_add3_u32 v116, v116, v120, s64
    v_add3_u32 v117, v100, v101, v102
    v_alignbit_b32 v120, v103, v103, 13
    v_add3_u32 v117, v117, v120, s64
    v_add3_u32 v118, v104, v105, v106
    v_alignbit_b32 v120, v107, v107, 13
    v_add3_u32 v118, v118, v120, s64
    v_add3_u32 v119, v108, v109, v110
    v_alignbit_b32 v120, v111, v111, 13
    v_add3_u32 v119, v119, v120, s64
    v_xor_b32 v116, v116, v112
    v_xor_b32 v117, v117, v113
    v_xor_b32 v118, v118, v114
    v_xor_b32 v119, v119, v115
    v_or3_b32 v116, v116, v117, v118
    v_or_b32 v116, v116, v119
    v_cmp_ne_u32 vcc, 0, v116
    s_cbranch_vccz L_uok
    s_sub_u32 s66, s66, 1
    s_cmp_eq_u32 s66, 0
    s_cbranch_scc1 L_uok
    buffer_load_dwordx4 v[96:99], v3, s[24:27], s37 offen offset:0 sc1
    buffer_load_dwordx4 v[100:103], v3, s[24:27], s37 offen offset:1024 sc1
    buffer_load_dwordx4 v[104:107], v3, s[24:27], s37 offen offset:2048 sc1
    buffer_load_dwordx4 v[108:111], v3, s[24:27], s37 offen offset:3072 sc1
    buffer_load_dword v112, v3, s[60:63], s39 offen offset:0 sc1
    buffer_load_dword v113, v3, s[60:63], s39 offen offset:1024 sc1
    buffer_load_dword v114, v3, s[60:63], s39 offen offset:2048 sc1
    buffer_load_dword v115, v3, s[60:63], s39 offen offset:3072 sc1
    s_branch L_uw
L_uok:
    ds_write_b128 v10, v[96:99] offset:8832
    ds_write_b128 v10, v[100:103] offset:9856
    ds_write_b128 v10, v[104:107] offset:10880
    ds_write_b128 v10, v[108:111] offset:11904
    s_add_u32 s32, s16, 0x1540000
    s_addc_u32 s33, s17, 0
    s_mov_b32 s34, 0x1e000
    s_mov_b32 s35, 0x20000
    s_add_u32 s24, s16, 0x500000
    s_addc_u32 s25, s17, 0
    s_mov_b32 s26, 0x280000
    s_mov_b32 s27, 0x20000
    s_movk_i32 s36, 5120
    s_movk_i32 s37, 10240
    s_waitcnt lgkmcnt(0)
    ds_read_b128 v[96:99], v60 offset:448
    ds_read2_b32 v[64:65], v56 offset0:0 offset1:1
    ds_read2_b32 v[66:67], v56 offset0:2 offset1:3
    ds_read_b128 v[100:103], v60 offset:960
    ds_read2_b32 v[68:69], v56 offset0:128 offset1:129
    ds_read2_b32 v[70:71], v56 offset0:130 offset1:131
    ds_read_b128 v[104:107], v60 offset:1472
    ds_read2_b32 v[72:73], v57 offset0:0 offset1:1
    ds_read2_b32 v[74:75], v57 offset0:2 offset1:3
    ds_read_b128 v[108:111], v60 offset:1984
    ds_read2_b32 v[76:77], v57 offset0:128 offset1:129
    ds_read2_b32 v[78:79], v57 offset0:130 offset1:131
    ds_read_b128 v[112:115], v60 offset:2496
    ds_read2_b32 v[80:81], v58 offset0:0 offset1:1
    ds_read2_b32 v[82:83], v58 offset0:2 offset1:3
    ds_read_b128 v[116:119], v60 offset:3008
    ds_read2_b32 v[84:85], v58 offset0:128 offset1:129
    ds_read2_b32 v[86:87], v58 offset0:130 offset1:131
    ds_read_b128 v[120:123], v60 offset:3520
    ds_read2_b32 v[88:89], v59 offset0:0 offset1:1
    ds_read2_b32 v[90:91], v59 offset0:2 offset1:3
    ds_read_b128 v[124:127], v60 offset:4032
    ds_read2_b32 v[92:93], v59 offset0:128 offset1:129
    ds_read2_b32 v[94:95], v59 offset0:130 offset1:131
    s_waitcnt lgkmcnt(0)
    v_mfma_f32_16x16x32_bf16 v[16:19], v[64:67], v[96:99], 0
    ds_read_b128 v[160:163], v60 offset:384
    v_mfma_f32_16x16x32_bf16 v[20:23], v[64:67], v[100:103], 0
    ds_read2_b32 v[128:129], v56 offset0:16 offset1:17
    v_mfma_f32_16x16x32_bf16 v[20:23], v[68:71], v[96:99], v[20:23]
    s_add_u32 m0, s21, 0
    ds_read2_b32 v[130:131], v56 offset0:18 offset1:19
    v_mfma_f32_16x16x32_bf16 v[24:27], v[64:67], v[104:107], 0
    buffer_load_dwordx4 v52, s[44:47], s20 offen offset:0 lds
    ds_read_b128 v[164:167], v60 offset:896
    v_mfma_f32_16x16x32_bf16 v[24:27], v[68:71], v[100:103], v[24:27]
    ds_read2_b32 v[132:133], v56 offset0:144 offset1:145
    v_mfma_f32_16x16x32_bf16 v[24:27], v[72:75], v[96:99], v[24:27]
    ds_read2_b32 v[134:135], v56 offset0:146 offset1:147
    v_mfma_f32_16x16x32_bf16 v[28:31], v[64:67], v[108:111], 0
    ds_read_b128 v[168:171], v60 offset:1408
    v_mfma_f32_16x16x32_bf16 v[28:31], v[68:71], v[104:107], v[28:31]
    ds_read2_b32 v[136:137], v57 offset0:16 offset1:17
    v_mfma_f32_16x16x32_bf16 v[28:31], v[72:75], v[100:103], v[28:31]
    ds_read2_b32 v[138:139], v57 offset0:18 offset1:19
    v_mfma_f32_16x16x32_bf16 v[28:31], v[76:79], v[96:99], v[28:31]
    buffer_load_dwordx4 v53, s[44:47], s20 offen offset:1024 lds
    ds_read_b128 v[172:175], v60 offset:1920
    v_mfma_f32_16x16x32_bf16 v[32:35], v[64:67], v[112:115], 0
    ds_read2_b32 v[140:141], v57 offset0:144 offset1:145
    v_mfma_f32_16x16x32_bf16 v[32:35], v[68:71], v[108:111], v[32:35]
    ds_read2_b32 v[142:143], v57 offset0:146 offset1:147
    v_mfma_f32_16x16x32_bf16 v[32:35], v[72:75], v[104:107], v[32:35]
    ds_read_b128 v[176:179], v60 offset:2432
    v_mfma_f32_16x16x32_bf16 v[32:35], v[76:79], v[100:103], v[32:35]
    ds_read2_b32 v[144:145], v58 offset0:16 offset1:17
    v_mfma_f32_16x16x32_bf16 v[32:35], v[80:83], v[96:99], v[32:35]
    ds_read2_b32 v[146:147], v58 offset0:18 offset1:19
    v_mfma_f32_16x16x32_bf16 v[36:39], v[64:67], v[116:119], 0
    buffer_load_dwordx4 v54, s[44:47], s20 offen offset:2048 lds
    ds_read_b128 v[180:183], v60 offset:2944
    v_mfma_f32_16x16x32_bf16 v[36:39], v[68:71], v[112:115], v[36:39]
    ds_read2_b32 v[148:149], v58 offset0:144 offset1:145
    v_mfma_f32_16x16x32_bf16 v[36:39], v[72:75], v[108:111], v[36:39]
    ds_read2_b32 v[150:151], v58 offset0:146 offset1:147
    v_mfma_f32_16x16x32_bf16 v[36:39], v[76:79], v[104:107], v[36:39]
    ds_read_b128 v[184:187], v60 offset:3456
    v_mfma_f32_16x16x32_bf16 v[36:39], v[80:83], v[100:103], v[36:39]
    ds_read2_b32 v[152:153], v59 offset0:16 offset1:17
    v_mfma_f32_16x16x32_bf16 v[36:39], v[84:87], v[96:99], v[36:39]
    ds_read2_b32 v[154:155], v59 offset0:18 offset1:19
    v_mfma_f32_16x16x32_bf16 v[40:43], v[64:67], v[120:123], 0
    buffer_load_dwordx4 v55, s[44:47], s20 offen offset:3072 lds
    ds_read_b128 v[188:191], v60 offset:3968
    v_mfma_f32_16x16x32_bf16 v[40:43], v[68:71], v[116:119], v[40:43]
    ds_read2_b32 v[156:157], v59 offset0:144 offset1:145
    v_mfma_f32_16x16x32_bf16 v[40:43], v[72:75], v[112:115], v[40:43]
    ds_read2_b32 v[158:159], v59 offset0:146 offset1:147
    v_mfma_f32_16x16x32_bf16 v[40:43], v[76:79], v[108:111], v[40:43]
    v_mfma_f32_16x16x32_bf16 v[40:43], v[80:83], v[104:107], v[40:43]
    v_mfma_f32_16x16x32_bf16 v[40:43], v[84:87], v[100:103], v[40:43]
    s_add_u32 m0, s21, 4096
    v_mfma_f32_16x16x32_bf16 v[40:43], v[88:91], v[96:99], v[40:43]
    buffer_load_dwordx4 v4, s[44:47], s20 offen offset:0 lds
    v_mfma_f32_16x16x32_bf16 v[44:47], v[64:67], v[124:127], 0
    v_mfma_f32_16x16x32_bf16 v[44:47], v[68:71], v[120:123], v[44:47]
    v_mfma_f32_16x16x32_bf16 v[44:47], v[72:75], v[116:119], v[44:47]
    v_mfma_f32_16x16x32_bf16 v[44:47], v[76:79], v[112:115], v[44:47]
    v_mfma_f32_16x16x32_bf16 v[44:47], v[80:83], v[108:111], v[44:47]
    s_add_u32 m0, s21, 5120
    s_add_u32 s20, s20, 40960
    v_mfma_f32_16x16x32_bf16 v[44:47], v[84:87], v[104:107], v[44:47]
    buffer_load_dwordx4 v52, s[44:47], s20 offen offset:0 lds
    v_mfma_f32_16x16x32_bf16 v[44:47], v[88:91], v[100:103], v[44:47]
    v_mfma_f32_16x16x32_bf16 v[44:47], v[92:95], v[96:99], v[44:47]
    s_waitcnt lgkmcnt(0)
    v_mfma_f32_16x16x32_bf16 v[16:19], v[128:131], v[160:163], v[16:19]
    s_getpc_b64 s[60:61]
L_pc_3:
    s_add_u32 s60, s60, L_g1-L_pc_3
    s_addc_u32 s61, s61, 0
    ds_read_b128 v[96:99], v60 offset:320
    v_mfma_f32_16x16x32_bf16 v[20:23], v[128:131], v[164:167], v[20:23]
    v_min_u32 v63, 149, v0
    ds_read2_b32 v[64:65], v56 offset0:32 offset1:33
    v_mfma_f32_16x16x32_bf16 v[20:23], v[132:135], v[160:163], v[20:23]
    v_lshlrev_b32 v63, 7, v63
    ds_read2_b32 v[66:67], v56 offset0:34 offset1:35
    v_mfma_f32_16x16x32_bf16 v[24:27], v[128:131], v[168:171], v[24:27]
    global_load_dword v63, v63, s[60:61]
    buffer_load_dwordx4 v53, s[44:47], s20 offen offset:1024 lds
    ds_read_b128 v[100:103], v60 offset:832
    v_mfma_f32_16x16x32_bf16 v[24:27], v[132:135], v[164:167], v[24:27]
    ds_read2_b32 v[68:69], v56 offset0:160 offset1:161
    v_mfma_f32_16x16x32_bf16 v[24:27], v[136:139], v[160:163], v[24:27]
    ds_read2_b32 v[70:71], v56 offset0:162 offset1:163
    v_mfma_f32_16x16x32_bf16 v[28:31], v[128:131], v[172:175], v[28:31]
    ds_read_b128 v[104:107], v60 offset:1344
    v_mfma_f32_16x16x32_bf16 v[28:31], v[132:135], v[168:171], v[28:31]
    ds_read2_b32 v[72:73], v57 offset0:32 offset1:33
    v_mfma_f32_16x16x32_bf16 v[28:31], v[136:139], v[164:167], v[28:31]
    ds_read2_b32 v[74:75], v57 offset0:34 offset1:35
    v_mfma_f32_16x16x32_bf16 v[28:31], v[140:143], v[160:163], v[28:31]
    buffer_load_dwordx4 v54, s[44:47], s20 offen offset:2048 lds
    ds_read_b128 v[108:111], v60 offset:1856
    v_mfma_f32_16x16x32_bf16 v[32:35], v[128:131], v[176:179], v[32:35]
    ds_read2_b32 v[76:77], v57 offset0:160 offset1:161
    v_mfma_f32_16x16x32_bf16 v[32:35], v[132:135], v[172:175], v[32:35]
    ds_read2_b32 v[78:79], v57 offset0:162 offset1:163
    v_mfma_f32_16x16x32_bf16 v[32:35], v[136:139], v[168:171], v[32:35]
    ds_read_b128 v[112:115], v60 offset:2368
    v_mfma_f32_16x16x32_bf16 v[32:35], v[140:143], v[164:167], v[32:35]
    ds_read2_b32 v[80:81], v58 offset0:32 offset1:33
    v_mfma_f32_16x16x32_bf16 v[32:35], v[144:147], v[160:163], v[32:35]
    ds_read2_b32 v[82:83], v58 offset0:34 offset1:35
    v_mfma_f32_16x16x32_bf16 v[36:39], v[128:131], v[180:183], v[36:39]
    buffer_load_dwordx4 v55, s[44:47], s20 offen offset:3072 lds
    ds_read_b128 v[116:119], v60 offset:2880
    v_mfma_f32_16x16x32_bf16 v[36:39], v[132:135], v[176:179], v[36:39]
    ds_read2_b32 v[84:85], v58 offset0:160 offset1:161
    v_mfma_f32_16x16x32_bf16 v[36:39], v[136:139], v[172:175], v[36:39]
    ds_read2_b32 v[86:87], v58 offset0:162 offset1:163
    v_mfma_f32_16x16x32_bf16 v[36:39], v[140:143], v[168:171], v[36:39]
    ds_read_b128 v[120:123], v60 offset:3392
    v_mfma_f32_16x16x32_bf16 v[36:39], v[144:147], v[164:167], v[36:39]
    ds_read2_b32 v[88:89], v59 offset0:32 offset1:33
    v_mfma_f32_16x16x32_bf16 v[36:39], v[148:151], v[160:163], v[36:39]
    s_add_u32 m0, s21, 9216
    ds_read2_b32 v[90:91], v59 offset0:34 offset1:35
    v_mfma_f32_16x16x32_bf16 v[40:43], v[128:131], v[184:187], v[40:43]
    buffer_load_dwordx4 v4, s[44:47], s20 offen offset:0 lds
    ds_read_b128 v[124:127], v60 offset:3904
    v_mfma_f32_16x16x32_bf16 v[40:43], v[132:135], v[180:183], v[40:43]
    ds_read2_b32 v[92:93], v59 offset0:160 offset1:161
    v_mfma_f32_16x16x32_bf16 v[40:43], v[136:139], v[176:179], v[40:43]
    ds_read2_b32 v[94:95], v59 offset0:162 offset1:163
    v_mfma_f32_16x16x32_bf16 v[40:43], v[140:143], v[172:175], v[40:43]
    v_mfma_f32_16x16x32_bf16 v[40:43], v[144:147], v[168:171], v[40:43]
    v_mfma_f32_16x16x32_bf16 v[40:43], v[148:151], v[164:167], v[40:43]
    s_add_u32 m0, s21, 10240
    s_add_u32 s20, s20, 40960
    v_mfma_f32_16x16x32_bf16 v[40:43], v[152:155], v[160:163], v[40:43]
    buffer_load_dwordx4 v52, s[44:47], s20 offen offset:0 lds
    v_mfma_f32_16x16x32_bf16 v[44:47], v[128:131], v[188:191], v[44:47]
    v_mfma_f32_16x16x32_bf16 v[44:47], v[132:135], v[184:187], v[44:47]
    v_mfma_f32_16x16x32_bf16 v[44:47], v[136:139], v[180:183], v[44:47]
    v_mfma_f32_16x16x32_bf16 v[44:47], v[140:143], v[176:179], v[44:47]
    v_mfma_f32_16x16x32_bf16 v[44:47], v[144:147], v[172:175], v[44:47]
    v_mfma_f32_16x16x32_bf16 v[44:47], v[148:151], v[168:171], v[44:47]
    buffer_load_dwordx4 v53, s[44:47], s20 offen offset:1024 lds
    v_mfma_f32_16x16x32_bf16 v[44:47], v[152:155], v[164:167], v[44:47]
    v_mfma_f32_16x16x32_bf16 v[44:47], v[156:159], v[160:163], v[44:47]
    s_waitcnt lgkmcnt(0)
    v_mfma_f32_16x16x32_bf16 v[16:19], v[64:67], v[96:99], v[16:19]
    ds_read_b128 v[160:163], v60 offset:256
    v_mfma_f32_16x16x32_bf16 v[20:23], v[64:67], v[100:103], v[20:23]
    ds_read2_b32 v[128:129], v56 offset0:48 offset1:49
    v_mfma_f32_16x16x32_bf16 v[20:23], v[68:71], v[96:99], v[20:23]
    ds_read2_b32 v[130:131], v56 offset0:50 offset1:51
    v_mfma_f32_16x16x32_bf16 v[24:27], v[64:67], v[104:107], v[24:27]
    buffer_load_dwordx4 v54, s[44:47], s20 offen offset:2048 lds
    ds_read_b128 v[164:167], v60 offset:768
    v_mfma_f32_16x16x32_bf16 v[24:27], v[68:71], v[100:103], v[24:27]
    ds_read2_b32 v[132:133], v56 offset0:176 offset1:177
    v_mfma_f32_16x16x32_bf16 v[24:27], v[72:75], v[96:99], v[24:27]
    ds_read2_b32 v[134:135], v56 offset0:178 offset1:179
    v_mfma_f32_16x16x32_bf16 v[28:31], v[64:67], v[108:111], v[28:31]
    ds_read_b128 v[168:171], v60 offset:1280
    v_mfma_f32_16x16x32_bf16 v[28:31], v[68:71], v[104:107], v[28:31]
    ds_read2_b32 v[136:137], v57 offset0:48 offset1:49
    v_mfma_f32_16x16x32_bf16 v[28:31], v[72:75], v[100:103], v[28:31]
    ds_read2_b32 v[138:139], v57 offset0:50 offset1:51
    v_mfma_f32_16x16x32_bf16 v[28:31], v[76:79], v[96:99], v[28:31]
    buffer_load_dwordx4 v55, s[44:47], s20 offen offset:3072 lds
    ds_read_b128 v[172:175], v60 offset:1792
    v_mfma_f32_16x16x32_bf16 v[32:35], v[64:67], v[112:115], v[32:35]
    ds_read2_b32 v[140:141], v57 offset0:176 offset1:177
    v_mfma_f32_16x16x32_bf16 v[32:35], v[68:71], v[108:111], v[32:35]
    ds_read2_b32 v[142:143], v57 offset0:178 offset1:179
    v_mfma_f32_16x16x32_bf16 v[32:35], v[72:75], v[104:107], v[32:35]
    ds_read_b128 v[176:179], v60 offset:2304
    v_mfma_f32_16x16x32_bf16 v[32:35], v[76:79], v[100:103], v[32:35]
    ds_read2_b32 v[144:145], v58 offset0:48 offset1:49
    v_mfma_f32_16x16x32_bf16 v[32:35], v[80:83], v[96:99], v[32:35]
    s_add_u32 m0, s21, 14336
    ds_read2_b32 v[146:147], v58 offset0:50 offset1:51
    v_mfma_f32_16x16x32_bf16 v[36:39], v[64:67], v[116:119], v[36:39]
    buffer_load_dwordx4 v4, s[44:47], s20 offen offset:0 lds
    ds_read_b128 v[180:183], v60 offset:2816
    v_mfma_f32_16x16x32_bf16 v[36:39], v[68:71], v[112:115], v[36:39]
    ds_read2_b32 v[148:149], v58 offset0:176 offset1:177
    v_mfma_f32_16x16x32_bf16 v[36:39], v[72:75], v[108:111], v[36:39]
    ds_read2_b32 v[150:151], v58 offset0:178 offset1:179
    v_mfma_f32_16x16x32_bf16 v[36:39], v[76:79], v[104:107], v[36:39]
    ds_read_b128 v[184:187], v60 offset:3328
    v_mfma_f32_16x16x32_bf16 v[36:39], v[80:83], v[100:103], v[36:39]
    ds_read2_b32 v[152:153], v59 offset0:48 offset1:49
    v_mfma_f32_16x16x32_bf16 v[36:39], v[84:87], v[96:99], v[36:39]
    ds_read2_b32 v[154:155], v59 offset0:50 offset1:51
    v_mfma_f32_16x16x32_bf16 v[40:43], v[64:67], v[120:123], v[40:43]
    ds_read_b128 v[188:191], v60 offset:3840
    v_mfma_f32_16x16x32_bf16 v[40:43], v[68:71], v[116:119], v[40:43]
    ds_read2_b32 v[156:157], v59 offset0:176 offset1:177
    v_mfma_f32_16x16x32_bf16 v[40:43], v[72:75], v[112:115], v[40:43]
    ds_read2_b32 v[158:159], v59 offset0:178 offset1:179
    v_mfma_f32_16x16x32_bf16 v[40:43], v[76:79], v[108:111], v[40:43]
    v_mfma_f32_16x16x32_bf16 v[40:43], v[80:83], v[104:107], v[40:43]
    v_mfma_f32_16x16x32_bf16 v[40:43], v[84:87], v[100:103], v[40:43]
    v_mfma_f32_16x16x32_bf16 v[40:43], v[88:91], v[96:99], v[40:43]
    v_mfma_f32_16x16x32_bf16 v[44:47], v[64:67], v[124:127], v[44:47]
    v_mfma_f32_16x16x32_bf16 v[44:47], v[68:71], v[120:123], v[44:47]
    v_mfma_f32_16x16x32_bf16 v[44:47], v[72:75], v[116:119], v[44:47]
    v_mfma_f32_16x16x32_bf16 v[44:47], v[76:79], v[112:115], v[44:47]
    v_mfma_f32_16x16x32_bf16 v[44:47], v[80:83], v[108:111], v[44:47]
    v_mfma_f32_16x16x32_bf16 v[44:47], v[84:87], v[104:107], v[44:47]
    v_mfma_f32_16x16x32_bf16 v[44:47], v[88:91], v[100:103], v[44:47]
    v_mfma_f32_16x16x32_bf16 v[44:47], v[92:95], v[96:99], v[44:47]
    s_waitcnt lgkmcnt(0)
    v_mfma_f32_16x16x32_bf16 v[16:19], v[128:131], v[160:163], v[16:19]
    ds_read_b128 v[96:99], v60 offset:192
    v_mfma_f32_16x16x32_bf16 v[20:23], v[128:131], v[164:167], v[20:23]
    ds_read2_b32 v[64:65], v56 offset0:64 offset1:65
    v_mfma_f32_16x16x32_bf16 v[20:23], v[132:135], v[160:163], v[20:23]
    ds_read2_b32 v[66:67], v56 offset0:66 offset1:67
    v_mfma_f32_16x16x32_bf16 v[24:27], v[128:131], v[168:171], v[24:27]
    ds_read_b128 v[100:103], v60 offset:704
    v_mfma_f32_16x16x32_bf16 v[24:27], v[132:135], v[164:167], v[24:27]
    ds_read2_b32 v[68:69], v56 offset0:192 offset1:193
    v_mfma_f32_16x16x32_bf16 v[24:27], v[136:139], v[160:163], v[24:27]
    ds_read2_b32 v[70:71], v56 offset0:194 offset1:195
    v_mfma_f32_16x16x32_bf16 v[28:31], v[128:131], v[172:175], v[28:31]
    ds_read_b128 v[104:107], v60 offset:1216
    v_mfma_f32_16x16x32_bf16 v[28:31], v[132:135], v[168:171], v[28:31]
    ds_read2_b32 v[72:73], v57 offset0:64 offset1:65
    v_mfma_f32_16x16x32_bf16 v[28:31], v[136:139], v[164:167], v[28:31]
    ds_read2_b32 v[74:75], v57 offset0:66 offset1:67
    v_mfma_f32_16x16x32_bf16 v[28:31], v[140:143], v[160:163], v[28:31]
    ds_read_b128 v[108:111], v60 offset:1728
    v_mfma_f32_16x16x32_bf16 v[32:35], v[128:131], v[176:179], v[32:35]
    ds_read2_b32 v[76:77], v57 offset0:192 offset1:193
    v_mfma_f32_16x16x32_bf16 v[32:35], v[132:135], v[172:175], v[32:35]
    ds_read2_b32 v[78:79], v57 offset0:194 offset1:195
    v_mfma_f32_16x16x32_bf16 v[32:35], v[136:139], v[168:171], v[32:35]
    ds_read_b128 v[112:115], v60 offset:2240
    v_mfma_f32_16x16x32_bf16 v[32:35], v[140:143], v[164:167], v[32:35]
    ds_read2_b32 v[80:81], v58 offset0:64 offset1:65
    v_mfma_f32_16x16x32_bf16 v[32:35], v[144:147], v[160:163], v[32:35]
    ds_read2_b32 v[82:83], v58 offset0:66 offset1:67
    v_mfma_f32_16x16x32_bf16 v[36:39], v[128:131], v[180:183], v[36:39]
    buffer_load_dword v9, v8, s[56:59], 0 offen offset:4 sc1
    ds_read_b128 v[116:119], v60 offset:2752
    v_mfma_f32_16x16x32_bf16 v[36:39], v[132:135], v[176:179], v[36:39]
    ds_read2_b32 v[84:85], v58 offset0:192 offset1:193
    v_mfma_f32_16x16x32_bf16 v[36:39], v[136:139], v[172:175], v[36:39]
    ds_read2_b32 v[86:87], v58 offset0:194 offset1:195
    v_mfma_f32_16x16x32_bf16 v[36:39], v[140:143], v[168:171], v[36:39]
    ds_read_b128 v[120:123], v60 offset:3264
    v_mfma_f32_16x16x32_bf16 v[36:39], v[144:147], v[164:167], v[36:39]
    ds_read2_b32 v[88:89], v59 offset0:64 offset1:65
    v_mfma_f32_16x16x32_bf16 v[36:39], v[148:151], v[160:163], v[36:39]
    ds_read2_b32 v[90:91], v59 offset0:66 offset1:67
    v_mfma_f32_16x16x32_bf16 v[40:43], v[128:131], v[184:187], v[40:43]
    ds_read_b128 v[124:127], v60 offset:3776
    v_mfma_f32_16x16x32_bf16 v[40:43], v[132:135], v[180:183], v[40:43]
    ds_read2_b32 v[92:93], v59 offset0:192 offset1:193
    v_mfma_f32_16x16x32_bf16 v[40:43], v[136:139], v[176:179], v[40:43]
    ds_read2_b32 v[94:95], v59 offset0:194 offset1:195
    v_mfma_f32_16x16x32_bf16 v[40:43], v[140:143], v[172:175], v[40:43]
    v_mfma_f32_16x16x32_bf16 v[40:43], v[144:147], v[168:171], v[40:43]
    v_mfma_f32_16x16x32_bf16 v[40:43], v[148:151], v[164:167], v[40:43]
    v_mfma_f32_16x16x32_bf16 v[40:43], v[152:155], v[160:163], v[40:43]
    v_mfma_f32_16x16x32_bf16 v[44:47], v[128:131], v[188:191], v[44:47]
    v_mfma_f32_16x16x32_bf16 v[44:47], v[132:135], v[184:187], v[44:47]
    s_waitcnt vmcnt(12)
    ds_read_b64_tr_b16 a[48:49], v7 offset:0
    v_mfma_f32_16x16x32_bf16 v[44:47], v[136:139], v[180:183], v[44:47]
    ds_read_b64_tr_b16 a[50:51], v7 offset:640
    v_mfma_f32_16x16x32_bf16 v[44:47], v[140:143], v[176:179], v[44:47]
    v_mfma_f32_16x16x32_bf16 v[44:47], v[144:147], v[172:175], v[44:47]
    ds_read_b64_tr_b16 a[52:53], v7 offset:32
    v_mfma_f32_16x16x32_bf16 v[44:47], v[148:151], v[168:171], v[44:47]
    ds_read_b64_tr_b16 a[54:55], v7 offset:672
    v_mfma_f32_16x16x32_bf16 v[44:47], v[152:155], v[164:167], v[44:47]
    ds_read_b64_tr_b16 a[56:57], v7 offset:64
    v_mfma_f32_16x16x32_bf16 v[44:47], v[156:159], v[160:163], v[44:47]
    s_waitcnt lgkmcnt(0)
    v_mfma_f32_16x16x32_bf16 v[16:19], v[64:67], v[96:99], v[16:19]
    ds_read_b64_tr_b16 a[58:59], v7 offset:704
    ds_read_b128 v[160:163], v60 offset:128
    v_mfma_f32_16x16x32_bf16 v[20:23], v[64:67], v[100:103], v[20:23]
    ds_read_b64_tr_b16 a[60:61], v7 offset:96
    buffer_load_dwordx4 v[208:211], v5, s[28:31], 0 offen offset:0 sc1
    ds_read2_b32 v[128:129], v56 offset0:80 offset1:81
    v_mfma_f32_16x16x32_bf16 v[20:23], v[68:71], v[96:99], v[20:23]
    ds_read_b64_tr_b16 a[62:63], v7 offset:736
    ds_read2_b32 v[130:131], v56 offset0:82 offset1:83
    v_mfma_f32_16x16x32_bf16 v[24:27], v[64:67], v[104:107], v[24:27]
    ds_read_b128 v[164:167], v60 offset:640
    v_mfma_f32_16x16x32_bf16 v[24:27], v[68:71], v[100:103], v[24:27]
    ds_read_b64_tr_b16 a[64:65], v7 offset:128
    ds_read2_b32 v[132:133], v56 offset0:208 offset1:209
    v_mfma_f32_16x16x32_bf16 v[24:27], v[72:75], v[96:99], v[24:27]
    ds_read_b64_tr_b16 a[66:67], v7 offset:768
    buffer_load_dwordx4 v[212:215], v5, s[28:31], 0 offen offset:1024 sc1
    ds_read2_b32 v[134:135], v56 offset0:210 offset1:211
    v_mfma_f32_16x16x32_bf16 v[28:31], v[64:67], v[108:111], v[28:31]
    ds_read_b128 v[168:171], v60 offset:1152
    v_mfma_f32_16x16x32_bf16 v[28:31], v[68:71], v[104:107], v[28:31]
    ds_read2_b32 v[136:137], v57 offset0:80 offset1:81
    v_mfma_f32_16x16x32_bf16 v[28:31], v[72:75], v[100:103], v[28:31]
    ds_read2_b32 v[138:139], v57 offset0:82 offset1:83
    v_mfma_f32_16x16x32_bf16 v[28:31], v[76:79], v[96:99], v[28:31]
    buffer_load_dwordx4 v[216:219], v5, s[28:31], 0 offen offset:2048 sc1
    ds_read_b128 v[172:175], v60 offset:1664
    v_mfma_f32_16x16x32_bf16 v[32:35], v[64:67], v[112:115], v[32:35]
    ds_read2_b32 v[140:141], v57 offset0:208 offset1:209
    v_mfma_f32_16x16x32_bf16 v[32:35], v[68:71], v[108:111], v[32:35]
    ds_read2_b32 v[142:143], v57 offset0:210 offset1:211
    v_mfma_f32_16x16x32_bf16 v[32:35], v[72:75], v[104:107], v[32:35]
    ds_read_b128 v[176:179], v60 offset:2176
    v_mfma_f32_16x16x32_bf16 v[32:35], v[76:79], v[100:103], v[32:35]
    buffer_load_dwordx4 v[220:223], v5, s[28:31], 0 offen offset:3072 sc1
    ds_read2_b32 v[144:145], v58 offset0:80 offset1:81
    v_mfma_f32_16x16x32_bf16 v[32:35], v[80:83], v[96:99], v[32:35]
    ds_read2_b32 v[146:147], v58 offset0:82 offset1:83
    v_mfma_f32_16x16x32_bf16 v[36:39], v[64:67], v[116:119], v[36:39]
    ds_read_b128 v[180:183], v60 offset:2688
    v_mfma_f32_16x16x32_bf16 v[36:39], v[68:71], v[112:115], v[36:39]
    ds_read2_b32 v[148:149], v58 offset0:208 offset1:209
    v_mfma_f32_16x16x32_bf16 v[36:39], v[72:75], v[108:111], v[36:39]
    buffer_load_dwordx2 v[10:11], v6, s[32:35], 0 offen sc1
    ds_read2_b32 v[150:151], v58 offset0:210 offset1:211
    v_mfma_f32_16x16x32_bf16 v[36:39], v[76:79], v[104:107], v[36:39]
    ds_read_b128 v[184:187], v60 offset:3200
    v_mfma_f32_16x16x32_bf16 v[36:39], v[80:83], v[100:103], v[36:39]
    ds_read2_b32 v[152:153], v59 offset0:80 offset1:81
    v_mfma_f32_16x16x32_bf16 v[36:39], v[84:87], v[96:99], v[36:39]
    ds_read2_b32 v[154:155], v59 offset0:82 offset1:83
    v_mfma_f32_16x16x32_bf16 v[40:43], v[64:67], v[120:123], v[40:43]
    buffer_load_dwordx2 v[12:13], v6, s[32:35], s36 offen sc1
    ds_read_b128 v[188:191], v60 offset:3712
    v_mfma_f32_16x16x32_bf16 v[40:43], v[68:71], v[116:119], v[40:43]
    ds_read2_b32 v[156:157], v59 offset0:208 offset1:209
    v_mfma_f32_16x16x32_bf16 v[40:43], v[72:75], v[112:115], v[40:43]
    s_waitcnt vmcnt(12)
    ds_read2_b32 v[158:159], v59 offset0:210 offset1:211
    v_mfma_f32_16x16x32_bf16 v[40:43], v[76:79], v[108:111], v[40:43]
    ds_read_b64_tr_b16 a[68:69], v7 offset:5120
    v_mfma_f32_16x16x32_bf16 v[40:43], v[80:83], v[104:107], v[40:43]
    ds_read_b64_tr_b16 a[70:71], v7 offset:5760
    buffer_load_dwordx2 v[14:15], v6, s[32:35], s37 offen sc1
    v_mfma_f32_16x16x32_bf16 v[40:43], v[84:87], v[100:103], v[40:43]
    ds_read_b64_tr_b16 a[72:73], v7 offset:5152
    v_mfma_f32_16x16x32_bf16 v[40:43], v[88:91], v[96:99], v[40:43]
    v_mfma_f32_16x16x32_bf16 v[44:47], v[64:67], v[124:127], v[44:47]
    ds_read_b64_tr_b16 a[74:75], v7 offset:5792
    v_mfma_f32_16x16x32_bf16 v[44:47], v[68:71], v[120:123], v[44:47]
    ds_read_b64_tr_b16 a[76:77], v7 offset:5184
    v_mfma_f32_16x16x32_bf16 v[44:47], v[72:75], v[116:119], v[44:47]
    ds_read_b64_tr_b16 a[78:79], v7 offset:5824
    v_mfma_f32_16x16x32_bf16 v[44:47], v[76:79], v[112:115], v[44:47]
    v_mfma_f32_16x16x32_bf16 v[44:47], v[80:83], v[108:111], v[44:47]
    ds_read_b64_tr_b16 a[80:81], v7 offset:5216
    v_mfma_f32_16x16x32_bf16 v[44:47], v[84:87], v[104:107], v[44:47]
    ds_read_b64_tr_b16 a[82:83], v7 offset:5856
    v_mfma_f32_16x16x32_bf16 v[44:47], v[88:91], v[100:103], v[44:47]
    ds_read_b64_tr_b16 a[84:85], v7 offset:5248
    v_mfma_f32_16x16x32_bf16 v[44:47], v[92:95], v[96:99], v[44:47]
    s_waitcnt vmcnt(7)
    v_cmp_ne_u32 vcc, s64, v9
    s_cbranch_vccz L_qok
    s_mov_b32 s66, 0x8000
    s_branch L_pfst_7
L_poll_4:
    s_sleep 2
L_pfst_7:
    buffer_load_dword v9, v8, s[56:59], 0 offen offset:4 sc1
L_pchk_5:
    s_sub_u32 s66, s66, 1
    s_cmp_eq_u32 s66, 0
    s_waitcnt vmcnt(0)
    s_cbranch_scc1 L_pdone_6
    v_cmp_ne_u32 vcc, s64, v9
    s_cbranch_vccnz L_poll_4
L_pdone_6:
L_qok:
    s_waitcnt lgkmcnt(0)
    v_mfma_f32_16x16x32_bf16 v[16:19], v[128:131], v[160:163], v[16:19]
    ds_read_b64_tr_b16 a[86:87], v7 offset:5888
    ds_read_b128 v[96:99], v60 offset:64
    v_mfma_f32_16x16x32_bf16 v[20:23], v[128:131], v[164:167], v[20:23]
    buffer_load_dwordx4 v[192:195], v5, s[52:55], s22 offen offset:0 sc1
    ds_read2_b32 v[64:65], v56 offset0:96 offset1:97
    v_mfma_f32_16x16x32_bf16 v[20:23], v[132:135], v[160:163], v[20:23]
    ds_read2_b32 v[66:67], v56 offset0:98 offset1:99
    v_mfma_f32_16x16x32_bf16 v[24:27], v[128:131], v[168:171], v[24:27]
    ds_read_b128 v[100:103], v60 offset:576
    v_mfma_f32_16x16x32_bf16 v[24:27], v[132:135], v[164:167], v[24:27]
    ds_read2_b32 v[68:69], v56 offset0:224 offset1:225
    v_mfma_f32_16x16x32_bf16 v[24:27], v[136:139], v[160:163], v[24:27]
    buffer_load_dwordx4 v[196:199], v5, s[52:55], s22 offen offset:1024 sc1
    ds_read2_b32 v[70:71], v56 offset0:226 offset1:227
    v_mfma_f32_16x16x32_bf16 v[28:31], v[128:131], v[172:175], v[28:31]
    ds_read_b128 v[104:107], v60 offset:1088
    v_mfma_f32_16x16x32_bf16 v[28:31], v[132:135], v[168:171], v[28:31]
    ds_read2_b32 v[72:73], v57 offset0:96 offset1:97
    v_mfma_f32_16x16x32_bf16 v[28:31], v[136:139], v[164:167], v[28:31]
    ds_read2_b32 v[74:75], v57 offset0:98 offset1:99
    v_mfma_f32_16x16x32_bf16 v[28:31], v[140:143], v[160:163], v[28:31]
    buffer_load_dwordx4 v[200:203], v5, s[52:55], s22 offen offset:2048 sc1
    ds_read_b128 v[108:111], v60 offset:1600
    v_mfma_f32_16x16x32_bf16 v[32:35], v[128:131], v[176:179], v[32:35]
    ds_read2_b32 v[76:77], v57 offset0:224 offset1:225
    v_mfma_f32_16x16x32_bf16 v[32:35], v[132:135], v[172:175], v[32:35]
    ds_read2_b32 v[78:79], v57 offset0:226 offset1:227
    v_mfma_f32_16x16x32_bf16 v[32:35], v[136:139], v[168:171], v[32:35]
    ds_read_b128 v[112:115], v60 offset:2112
    v_mfma_f32_16x16x32_bf16 v[32:35], v[140:143], v[164:167], v[32:35]
    buffer_load_dwordx4 v[204:207], v5, s[52:55], s22 offen offset:3072 sc1
    ds_read2_b32 v[80:81], v58 offset0:96 offset1:97
    v_mfma_f32_16x16x32_bf16 v[32:35], v[144:147], v[160:163], v[32:35]
    ds_read2_b32 v[82:83], v58 offset0:98 offset1:99
    v_mfma_f32_16x16x32_bf16 v[36:39], v[128:131], v[180:183], v[36:39]
    ds_read_b128 v[116:119], v60 offset:2624
    v_mfma_f32_16x16x32_bf16 v[36:39], v[132:135], v[176:179], v[36:39]
    ds_read2_b32 v[84:85], v58 offset0:224 offset1:225
    v_mfma_f32_16x16x32_bf16 v[36:39], v[136:139], v[172:175], v[36:39]
    ds_read_b64_tr_b16 a[88:89], v7 offset:10240
    ds_read2_b32 v[86:87], v58 offset0:226 offset1:227
    v_mfma_f32_16x16x32_bf16 v[36:39], v[140:143], v[168:171], v[36:39]
    ds_read_b64_tr_b16 a[90:91], v7 offset:10880
    ds_read_b128 v[120:123], v60 offset:3136
    v_mfma_f32_16x16x32_bf16 v[36:39], v[144:147], v[164:167], v[36:39]
    ds_read2_b32 v[88:89], v59 offset0:96 offset1:97
    v_mfma_f32_16x16x32_bf16 v[36:39], v[148:151], v[160:163], v[36:39]
    ds_read_b64_tr_b16 a[92:93], v7 offset:10272
    ds_read2_b32 v[90:91], v59 offset0:98 offset1:99
    v_mfma_f32_16x16x32_bf16 v[40:43], v[128:131], v[184:187], v[40:43]
    ds_read_b64_tr_b16 a[94:95], v7 offset:10912
    ds_read_b128 v[124:127], v60 offset:3648
    v_mfma_f32_16x16x32_bf16 v[40:43], v[132:135], v[180:183], v[40:43]
    ds_read_b64_tr_b16 a[96:97], v7 offset:10304
    ds_read2_b32 v[92:93], v59 offset0:224 offset1:225
    v_mfma_f32_16x16x32_bf16 v[40:43], v[136:139], v[176:179], v[40:43]
    ds_read2_b32 v[94:95], v59 offset0:226 offset1:227
    v_mfma_f32_16x16x32_bf16 v[40:43], v[140:143], v[172:175], v[40:43]
    ds_read_b64_tr_b16 a[98:99], v7 offset:10944
    v_mfma_f32_16x16x32_bf16 v[40:43], v[144:147], v[168:171], v[40:43]
    ds_read_b64_tr_b16 a[100:101], v7 offset:10336
    v_mfma_f32_16x16x32_bf16 v[40:43], v[148:151], v[164:167], v[40:43]
    ds_read_b64_tr_b16 a[102:103], v7 offset:10976
    v_mfma_f32_16x16x32_bf16 v[40:43], v[152:155], v[160:163], v[40:43]
    v_mfma_f32_16x16x32_bf16 v[44:47], v[128:131], v[188:191], v[44:47]
    ds_read_b64_tr_b16 a[104:105], v7 offset:10368
    v_mfma_f32_16x16x32_bf16 v[44:47], v[132:135], v[184:187], v[44:47]
    ds_read_b64_tr_b16 a[106:107], v7 offset:11008
    v_mfma_f32_16x16x32_bf16 v[44:47], v[136:139], v[180:183], v[44:47]
    v_mfma_f32_16x16x32_bf16 v[44:47], v[140:143], v[176:179], v[44:47]
    v_mfma_f32_16x16x32_bf16 v[44:47], v[144:147], v[172:175], v[44:47]
    v_mfma_f32_16x16x32_bf16 v[44:47], v[148:151], v[168:171], v[44:47]
    v_mfma_f32_16x16x32_bf16 v[44:47], v[152:155], v[164:167], v[44:47]
    v_mfma_f32_16x16x32_bf16 v[44:47], v[156:159], v[160:163], v[44:47]
    s_waitcnt lgkmcnt(0)
    v_mfma_f32_16x16x32_bf16 v[16:19], v[64:67], v[96:99], v[16:19]
    ds_read_b128 v[160:163], v60 offset:0
    v_mfma_f32_16x16x32_bf16 v[20:23], v[64:67], v[100:103], v[20:23]
    ds_read2_b32 v[128:129], v56 offset0:112 offset1:113
    v_mfma_f32_16x16x32_bf16 v[20:23], v[68:71], v[96:99], v[20:23]
    ds_read2_b32 v[130:131], v56 offset0:114 offset1:115
    v_mfma_f32_16x16x32_bf16 v[24:27], v[64:67], v[104:107], v[24:27]
    ds_read_b128 v[164:167], v60 offset:512
    v_mfma_f32_16x16x32_bf16 v[24:27], v[68:71], v[100:103], v[24:27]
    ds_read2_b32 v[132:133], v56 offset0:240 offset1:241
    v_mfma_f32_16x16x32_bf16 v[24:27], v[72:75], v[96:99], v[24:27]
    ds_read2_b32 v[134:135], v56 offset0:242 offset1:243
    v_mfma_f32_16x16x32_bf16 v[28:31], v[64:67], v[108:111], v[28:31]
    ds_read_b128 v[168:171], v60 offset:1024
    v_mfma_f32_16x16x32_bf16 v[28:31], v[68:71], v[104:107], v[28:31]
    ds_read2_b32 v[136:137], v57 offset0:112 offset1:113
    v_mfma_f32_16x16x32_bf16 v[28:31], v[72:75], v[100:103], v[28:31]
    ds_read2_b32 v[138:139], v57 offset0:114 offset1:115
    v_mfma_f32_16x16x32_bf16 v[28:31], v[76:79], v[96:99], v[28:31]
    ds_read_b128 v[172:175], v60 offset:1536
    v_mfma_f32_16x16x32_bf16 v[32:35], v[64:67], v[112:115], v[32:35]
    ds_read2_b32 v[140:141], v57 offset0:240 offset1:241
    v_mfma_f32_16x16x32_bf16 v[32:35], v[68:71], v[108:111], v[32:35]
    ds_read2_b32 v[142:143], v57 offset0:242 offset1:243
    v_mfma_f32_16x16x32_bf16 v[32:35], v[72:75], v[104:107], v[32:35]
    ds_read_b128 v[176:179], v60 offset:2048
    v_mfma_f32_16x16x32_bf16 v[32:35], v[76:79], v[100:103], v[32:35]
    ds_read2_b32 v[144:145], v58 offset0:112 offset1:113
    v_mfma_f32_16x16x32_bf16 v[32:35], v[80:83], v[96:99], v[32:35]
    ds_read2_b32 v[146:147], v58 offset0:114 offset1:115
    v_mfma_f32_16x16x32_bf16 v[36:39], v[64:67], v[116:119], v[36:39]
    ds_read_b128 v[180:183], v60 offset:2560
    v_mfma_f32_16x16x32_bf16 v[36:39], v[68:71], v[112:115], v[36:39]
    ds_read2_b32 v[148:149], v58 offset0:240 offset1:241
    v_mfma_f32_16x16x32_bf16 v[36:39], v[72:75], v[108:111], v[36:39]
    ds_read2_b32 v[150:151], v58 offset0:242 offset1:243
    v_mfma_f32_16x16x32_bf16 v[36:39], v[76:79], v[104:107], v[36:39]
    ds_read_b128 v[184:187], v60 offset:3072
    v_mfma_f32_16x16x32_bf16 v[36:39], v[80:83], v[100:103], v[36:39]
    s_waitcnt vmcnt(4)
    v_min3_u32 v49, v211, v215, v219
    ds_read2_b32 v[152:153], v59 offset0:112 offset1:113
    v_mfma_f32_16x16x32_bf16 v[36:39], v[84:87], v[96:99], v[36:39]
    v_max3_u32 v50, v211, v215, v219
    ds_read2_b32 v[154:155], v59 offset0:114 offset1:115
    v_mfma_f32_16x16x32_bf16 v[40:43], v[64:67], v[120:123], v[40:43]
    v_min3_u32 v49, v49, v223, v11
    ds_read_b128 v[188:191], v60 offset:3584
    v_mfma_f32_16x16x32_bf16 v[40:43], v[68:71], v[116:119], v[40:43]
    v_max3_u32 v50, v50, v223, v11
    ds_read2_b32 v[156:157], v59 offset0:240 offset1:241
    v_mfma_f32_16x16x32_bf16 v[40:43], v[72:75], v[112:115], v[40:43]
    v_min3_u32 v49, v49, v13, v15
    ds_read2_b32 v[158:159], v59 offset0:242 offset1:243
    v_mfma_f32_16x16x32_bf16 v[40:43], v[76:79], v[108:111], v[40:43]
    v_max3_u32 v50, v50, v13, v15
    v_mfma_f32_16x16x32_bf16 v[40:43], v[80:83], v[104:107], v[40:43]
    v_xor_b32 v49, s64, v49
    v_mfma_f32_16x16x32_bf16 v[40:43], v[84:87], v[100:103], v[40:43]
    v_xor_b32 v50, s64, v50
    v_mfma_f32_16x16x32_bf16 v[40:43], v[88:91], v[96:99], v[40:43]
    v_or_b32 v49, v49, v50
    v_mfma_f32_16x16x32_bf16 v[44:47], v[64:67], v[124:127], v[44:47]
    v_cmp_ne_u32 vcc, 0, v49
    v_mfma_f32_16x16x32_bf16 v[44:47], v[68:71], v[120:123], v[44:47]
    v_mfma_f32_16x16x32_bf16 v[44:47], v[72:75], v[116:119], v[44:47]
    v_mfma_f32_16x16x32_bf16 v[44:47], v[76:79], v[112:115], v[44:47]
    v_mfma_f32_16x16x32_bf16 v[44:47], v[80:83], v[108:111], v[44:47]
    v_mfma_f32_16x16x32_bf16 v[44:47], v[84:87], v[104:107], v[44:47]
    v_mfma_f32_16x16x32_bf16 v[44:47], v[88:91], v[100:103], v[44:47]
    v_mfma_f32_16x16x32_bf16 v[44:47], v[92:95], v[96:99], v[44:47]
    s_cbranch_vccz L_gok
    s_mov_b32 s66, 0x8000
    s_branch L_gf_11
L_gl_8:
    s_sleep 2
L_gf_11:
    buffer_load_dwordx4 v[208:211], v5, s[28:31], 0 offen offset:0 sc1
    buffer_load_dwordx4 v[212:215], v5, s[28:31], 0 offen offset:1024 sc1
    buffer_load_dwordx4 v[216:219], v5, s[28:31], 0 offen offset:2048 sc1
    buffer_load_dwordx4 v[220:223], v5, s[28:31], 0 offen offset:3072 sc1
    buffer_load_dwordx2 v[10:11], v6, s[32:35], 0 offen sc1
    buffer_load_dwordx2 v[12:13], v6, s[32:35], s36 offen sc1
    buffer_load_dwordx2 v[14:15], v6, s[32:35], s37 offen sc1
L_gc_9:
    s_sub_u32 s66, s66, 1
    s_cmp_eq_u32 s66, 0
    s_waitcnt vmcnt(0)
    s_cbranch_scc1 L_gd_10
    v_cmp_ne_u32 vcc, s64, v211
    s_cbranch_vccnz L_gl_8
    v_cmp_ne_u32 vcc, s64, v215
    s_cbranch_vccnz L_gl_8
    v_cmp_ne_u32 vcc, s64, v219
    s_cbranch_vccnz L_gl_8
    v_cmp_ne_u32 vcc, s64, v223
    s_cbranch_vccnz L_gl_8
    v_cmp_ne_u32 vcc, s64, v11
    s_cbranch_vccnz L_gl_8
    v_cmp_ne_u32 vcc, s64, v13
    s_cbranch_vccnz L_gl_8
    v_cmp_ne_u32 vcc, s64, v15
    s_cbranch_vccnz L_gl_8
L_gd_10:
L_gok:
    s_waitcnt vmcnt(0)
    s_waitcnt lgkmcnt(0)
    v_mfma_f32_16x16x32_bf16 v[16:19], v[128:131], v[160:163], v[16:19]
    v_cvt_pk_bf16_f32 v10, v10, v10
    v_cvt_pk_bf16_f32 v12, v12, v12
    v_mfma_f32_16x16x32_bf16 v[20:23], v[128:131], v[164:167], v[20:23]
    v_cvt_pk_bf16_f32 v14, v14, v14
    v_lshlrev_b32 v10, 16, v10
    v_mfma_f32_16x16x32_bf16 v[20:23], v[132:135], v[160:163], v[20:23]
    v_lshlrev_b32 v12, 16, v12
    v_lshlrev_b32 v14, 16, v14
    v_mfma_f32_16x16x32_bf16 v[24:27], v[128:131], v[168:171], v[24:27]
    v_add_f32 v12, 1.0, v12
    v_mul_f32 v10, v14, v10
    v_mfma_f32_16x16x32_bf16 v[24:27], v[132:135], v[164:167], v[24:27]
    v_cvt_pk_bf16_f32 v12, v12, v12
    v_lshlrev_b32 v12, 16, v12
    v_mfma_f32_16x16x32_bf16 v[24:27], v[136:139], v[160:163], v[24:27]
    v_mul_f32 v12, v14, v12
    v_readlane_b32 s8, v10, 0
    v_mfma_f32_16x16x32_bf16 v[28:31], v[128:131], v[172:175], v[28:31]
    v_readlane_b32 s9, v10, 2
    v_readlane_b32 s10, v10, 4
    v_mfma_f32_16x16x32_bf16 v[28:31], v[132:135], v[168:171], v[28:31]
    v_readlane_b32 s11, v10, 6
    v_readlane_b32 s4, v12, 0
    v_mfma_f32_16x16x32_bf16 v[28:31], v[136:139], v[164:167], v[28:31]
    v_readlane_b32 s5, v12, 2
    v_readlane_b32 s6, v12, 4
    v_mfma_f32_16x16x32_bf16 v[28:31], v[140:143], v[160:163], v[28:31]
    v_readlane_b32 s7, v12, 6
    v_mov_b32 v52, s8
    v_mfma_f32_16x16x32_bf16 v[32:35], v[128:131], v[176:179], v[32:35]
    v_mov_b32 v53, s9
    v_mov_b32 v54, s10
    v_mfma_f32_16x16x32_bf16 v[32:35], v[132:135], v[172:175], v[32:35]
    v_mov_b32 v55, s11
    v_lshlrev_b32 v48, 16, v210
    v_mfma_f32_16x16x32_bf16 v[32:35], v[136:139], v[168:171], v[32:35]
    v_mul_f32 v48, v48, v208
    v_lshlrev_b32 v224, 16, v192
    v_mfma_f32_16x16x32_bf16 v[32:35], v[140:143], v[164:167], v[32:35]
    v_and_b32 v225, 0xffff0000, v192
    v_lshlrev_b32 v226, 16, v193
    v_mfma_f32_16x16x32_bf16 v[32:35], v[144:147], v[160:163], v[32:35]
    v_and_b32 v227, 0xffff0000, v193
    v_fma_f32 v224, v224, v208, v48
    v_mfma_f32_16x16x32_bf16 v[36:39], v[128:131], v[180:183], v[36:39]
    v_fma_f32 v225, v225, v208, v48
    v_fma_f32 v226, v226, v208, v48
    v_mfma_f32_16x16x32_bf16 v[36:39], v[132:135], v[176:179], v[36:39]
    v_fma_f32 v227, v227, v208, v48
    v_fma_f32 v224, v224, s4, v52
    v_mfma_f32_16x16x32_bf16 v[36:39], v[136:139], v[172:175], v[36:39]
    v_fma_f32 v225, v225, s5, v53
    v_fma_f32 v226, v226, s6, v54
    v_mfma_f32_16x16x32_bf16 v[36:39], v[140:143], v[168:171], v[36:39]
    v_fma_f32 v227, v227, s7, v55
    v_and_b32 v48, 0xffff0000, v210
    v_mfma_f32_16x16x32_bf16 v[36:39], v[144:147], v[164:167], v[36:39]
    v_mul_f32 v48, v48, v209
    v_lshlrev_b32 v228, 16, v194
    v_mfma_f32_16x16x32_bf16 v[36:39], v[148:151], v[160:163], v[36:39]
    v_and_b32 v229, 0xffff0000, v194
    v_lshlrev_b32 v230, 16, v195
    v_mfma_f32_16x16x32_bf16 v[40:43], v[128:131], v[184:187], v[40:43]
    v_and_b32 v231, 0xffff0000, v195
    v_fma_f32 v228, v228, v209, v48
    v_mfma_f32_16x16x32_bf16 v[40:43], v[132:135], v[180:183], v[40:43]
    v_fma_f32 v229, v229, v209, v48
    v_fma_f32 v230, v230, v209, v48
    v_mfma_f32_16x16x32_bf16 v[40:43], v[136:139], v[176:179], v[40:43]
    v_fma_f32 v231, v231, v209, v48
    v_fma_f32 v228, v228, s4, v52
    v_mfma_f32_16x16x32_bf16 v[40:43], v[140:143], v[172:175], v[40:43]
    v_fma_f32 v229, v229, s5, v53
    v_fma_f32 v230, v230, s6, v54
    v_mfma_f32_16x16x32_bf16 v[40:43], v[144:147], v[168:171], v[40:43]
    v_fma_f32 v231, v231, s7, v55
    v_lshlrev_b32 v48, 16, v214
    v_mfma_f32_16x16x32_bf16 v[40:43], v[148:151], v[164:167], v[40:43]
    v_mul_f32 v48, v48, v212
    v_lshlrev_b32 v232, 16, v196
    v_mfma_f32_16x16x32_bf16 v[40:43], v[152:155], v[160:163], v[40:43]
    v_and_b32 v233, 0xffff0000, v196
    v_lshlrev_b32 v234, 16, v197
    v_mfma_f32_16x16x32_bf16 v[44:47], v[128:131], v[188:191], v[44:47]
    v_and_b32 v235, 0xffff0000, v197
    v_fma_f32 v232, v232, v212, v48
    v_mfma_f32_16x16x32_bf16 v[44:47], v[132:135], v[184:187], v[44:47]
    v_fma_f32 v233, v233, v212, v48
    v_fma_f32 v234, v234, v212, v48
    v_mfma_f32_16x16x32_bf16 v[44:47], v[136:139], v[180:183], v[44:47]
    v_fma_f32 v235, v235, v212, v48
    v_fma_f32 v232, v232, s4, v52
    v_mfma_f32_16x16x32_bf16 v[44:47], v[140:143], v[176:179], v[44:47]
    v_fma_f32 v233, v233, s5, v53
    v_fma_f32 v234, v234, s6, v54
    v_mfma_f32_16x16x32_bf16 v[44:47], v[144:147], v[172:175], v[44:47]
    v_fma_f32 v235, v235, s7, v55
    v_and_b32 v48, 0xffff0000, v214
    v_mfma_f32_16x16x32_bf16 v[44:47], v[148:151], v[168:171], v[44:47]
    v_mul_f32 v48, v48, v213
    v_lshlrev_b32 v236, 16, v198
    v_mfma_f32_16x16x32_bf16 v[44:47], v[152:155], v[164:167], v[44:47]
    v_and_b32 v237, 0xffff0000, v198
    v_lshlrev_b32 v238, 16, v199
    v_mfma_f32_16x16x32_bf16 v[44:47], v[156:159], v[160:163], v[44:47]
    v_and_b32 v239, 0xffff0000, v199
    v_fma_f32 v236, v236, v213, v48
    s_bfe_u32 s67, s2, 0x20001
    s_lshl_b32 s67, s67, 2
    s_bfe_u32 s66, s2, 0x20003
    s_add_u32 s67, s67, s66
    s_mul_i32 s67, s67, 27
    s_lshr_b32 s67, s67, 2
    v_and_b32 v88, 3, v2
    v_lshl_add_u32 v88, v88, 1, s67
    v_lshrrev_b32 v88, 2, v88
    v_bfe_u32 v89, v2, 2, 1
    v_mul_u32_u24 v89, 27, v89
    v_add_u32 v88, v88, v89
    v_add_u32 v88, 160, v88
    v_lshlrev_b32 v88, 7, v88
    buffer_load_dword v90, v88, s[56:59], 0 offen offset:4 sc1
    v_cvt_pk_bf16_f32 v64, v16, v18
    v_cvt_pk_bf16_f32 v65, v17, v19
    ds_write2st64_b32 v61, v64, v65 offset0:0 offset1:8
    v_cvt_pk_bf16_f32 v66, v20, v22
    v_cvt_pk_bf16_f32 v67, v21, v23
    ds_write2st64_b32 v61, v66, v67 offset0:1 offset1:9
    v_cvt_pk_bf16_f32 v68, v24, v26
    v_cvt_pk_bf16_f32 v69, v25, v27
    ds_write2st64_b32 v61, v68, v69 offset0:2 offset1:10
    v_cvt_pk_bf16_f32 v70, v28, v30
    v_cvt_pk_bf16_f32 v71, v29, v31
    ds_write2st64_b32 v61, v70, v71 offset0:3 offset1:11
    v_cvt_pk_bf16_f32 v72, v32, v34
    v_cvt_pk_bf16_f32 v73, v33, v35
    ds_write2st64_b32 v61, v72, v73 offset0:4 offset1:12
    v_cvt_pk_bf16_f32 v74, v36, v38
    v_cvt_pk_bf16_f32 v75, v37, v39
    ds_write2st64_b32 v61, v74, v75 offset0:5 offset1:13
    v_cvt_pk_bf16_f32 v76, v40, v42
    v_cvt_pk_bf16_f32 v77, v41, v43
    ds_write2st64_b32 v61, v76, v77 offset0:6 offset1:14
    s_nop 7
    v_cvt_pk_bf16_f32 v78, v44, v46
    v_cvt_pk_bf16_f32 v79, v45, v47
    ds_write2st64_b32 v61, v78, v79 offset0:7 offset1:15
    v_fma_f32 v237, v237, v213, v48
    v_fma_f32 v238, v238, v213, v48
    v_fma_f32 v239, v239, v213, v48
    v_fma_f32 v236, v236, s4, v52
    v_fma_f32 v237, v237, s5, v53
    v_fma_f32 v238, v238, s6, v54
    v_fma_f32 v239, v239, s7, v55
    v_lshlrev_b32 v48, 16, v218
    v_mul_f32 v48, v48, v216
    v_lshlrev_b32 v240, 16, v200
    v_and_b32 v241, 0xffff0000, v200
    v_lshlrev_b32 v242, 16, v201
    v_and_b32 v243, 0xffff0000, v201
    v_fma_f32 v240, v240, v216, v48
    v_fma_f32 v241, v241, v216, v48
    v_fma_f32 v242, v242, v216, v48
    v_fma_f32 v243, v243, v216, v48
    v_fma_f32 v240, v240, s4, v52
    v_fma_f32 v241, v241, s5, v53
    v_fma_f32 v242, v242, s6, v54
    v_fma_f32 v243, v243, s7, v55
    v_and_b32 v48, 0xffff0000, v218
    v_mul_f32 v48, v48, v217
    v_lshlrev_b32 v244, 16, v202
    v_and_b32 v245, 0xffff0000, v202
    v_lshlrev_b32 v246, 16, v203
    v_and_b32 v247, 0xffff0000, v203
    v_fma_f32 v244, v244, v217, v48
    v_fma_f32 v245, v245, v217, v48
    v_fma_f32 v246, v246, v217, v48
    v_fma_f32 v247, v247, v217, v48
    v_fma_f32 v244, v244, s4, v52
    v_fma_f32 v245, v245, s5, v53
    v_fma_f32 v246, v246, s6, v54
    v_fma_f32 v247, v247, s7, v55
    v_lshlrev_b32 v48, 16, v222
    v_mul_f32 v48, v48, v220
    v_lshlrev_b32 v248, 16, v204
    v_and_b32 v249, 0xffff0000, v204
    v_lshlrev_b32 v250, 16, v205
    v_and_b32 v251, 0xffff0000, v205
    v_fma_f32 v248, v248, v220, v48
    v_fma_f32 v249, v249, v220, v48
    v_fma_f32 v250, v250, v220, v48
    v_fma_f32 v251, v251, v220, v48
    v_fma_f32 v248, v248, s4, v52
    v_fma_f32 v249, v249, s5, v53
    v_fma_f32 v250, v250, s6, v54
    v_fma_f32 v251, v251, s7, v55
    v_and_b32 v48, 0xffff0000, v222
    v_mul_f32 v48, v48, v221
    v_lshlrev_b32 v252, 16, v206
    v_and_b32 v253, 0xffff0000, v206
    v_lshlrev_b32 v254, 16, v207
    v_and_b32 v255, 0xffff0000, v207
    v_fma_f32 v252, v252, v221, v48
    v_fma_f32 v253, v253, v221, v48
    v_fma_f32 v254, v254, v221, v48
    v_fma_f32 v255, v255, v221, v48
    v_fma_f32 v252, v252, s4, v52
    v_fma_f32 v253, v253, s5, v53
    v_fma_f32 v254, v254, s6, v54
    v_fma_f32 v255, v255, s7, v55
    s_waitcnt lgkmcnt(0)
    s_barrier
    ds_read_b64_tr_b16 v[96:97], v62 offset:0
    ds_read_b64_tr_b16 v[98:99], v62 offset:2048
    ds_read_b64_tr_b16 v[100:101], v62 offset:128
    ds_read_b64_tr_b16 v[102:103], v62 offset:2176
    ds_read_b64_tr_b16 v[104:105], v62 offset:256
    ds_read_b64_tr_b16 v[106:107], v62 offset:2304
    ds_read_b64_tr_b16 v[108:109], v62 offset:384
    ds_read_b64_tr_b16 v[110:111], v62 offset:2432
    v_lshlrev_b32 v112, 16, v192
    v_and_b32 v113, 0xffff0000, v192
    v_lshlrev_b32 v114, 16, v193
    v_and_b32 v115, 0xffff0000, v193
    s_waitcnt lgkmcnt(7)
    v_lshlrev_b32 v116, 16, v96
    v_and_b32 v117, 0xffff0000, v96
    v_lshlrev_b32 v118, 16, v97
    v_and_b32 v119, 0xffff0000, v97
    v_pk_fma_f32 v[112:113], v[224:225], v[116:117], v[112:113]
    v_pk_fma_f32 v[114:115], v[226:227], v[118:119], v[114:115]
    v_cvt_pk_bf16_f32 v128, v112, v113
    v_cvt_pk_bf16_f32 v129, v114, v115
    v_lshlrev_b32 v112, 16, v194
    v_and_b32 v113, 0xffff0000, v194
    v_lshlrev_b32 v114, 16, v195
    v_and_b32 v115, 0xffff0000, v195
    s_waitcnt lgkmcnt(6)
    v_lshlrev_b32 v116, 16, v98
    v_and_b32 v117, 0xffff0000, v98
    v_lshlrev_b32 v118, 16, v99
    v_and_b32 v119, 0xffff0000, v99
    v_pk_fma_f32 v[112:113], v[228:229], v[116:117], v[112:113]
    v_pk_fma_f32 v[114:115], v[230:231], v[118:119], v[114:115]
    v_cvt_pk_bf16_f32 v130, v112, v113
    v_cvt_pk_bf16_f32 v131, v114, v115
    buffer_store_dwordx4 v[128:131], v5, s[24:27], s22 offen offset:0 sc1
    v_lshlrev_b32 v112, 16, v196
    v_and_b32 v113, 0xffff0000, v196
    v_lshlrev_b32 v114, 16, v197
    v_and_b32 v115, 0xffff0000, v197
    s_waitcnt lgkmcnt(5)
    v_lshlrev_b32 v116, 16, v100
    v_and_b32 v117, 0xffff0000, v100
    v_lshlrev_b32 v118, 16, v101
    v_and_b32 v119, 0xffff0000, v101
    v_pk_fma_f32 v[112:113], v[232:233], v[116:117], v[112:113]
    v_pk_fma_f32 v[114:115], v[234:235], v[118:119], v[114:115]
    v_cvt_pk_bf16_f32 v132, v112, v113
    v_cvt_pk_bf16_f32 v133, v114, v115
    v_lshlrev_b32 v112, 16, v198
    v_and_b32 v113, 0xffff0000, v198
    v_lshlrev_b32 v114, 16, v199
    v_and_b32 v115, 0xffff0000, v199
    s_waitcnt lgkmcnt(4)
    v_lshlrev_b32 v116, 16, v102
    v_and_b32 v117, 0xffff0000, v102
    v_lshlrev_b32 v118, 16, v103
    v_and_b32 v119, 0xffff0000, v103
    v_pk_fma_f32 v[112:113], v[236:237], v[116:117], v[112:113]
    v_pk_fma_f32 v[114:115], v[238:239], v[118:119], v[114:115]
    v_cvt_pk_bf16_f32 v134, v112, v113
    v_cvt_pk_bf16_f32 v135, v114, v115
    buffer_store_dwordx4 v[132:135], v5, s[24:27], s22 offen offset:1024 sc1
    v_lshlrev_b32 v112, 16, v200
    v_and_b32 v113, 0xffff0000, v200
    v_lshlrev_b32 v114, 16, v201
    v_and_b32 v115, 0xffff0000, v201
    s_waitcnt lgkmcnt(3)
    v_lshlrev_b32 v116, 16, v104
    v_and_b32 v117, 0xffff0000, v104
    v_lshlrev_b32 v118, 16, v105
    v_and_b32 v119, 0xffff0000, v105
    v_pk_fma_f32 v[112:113], v[240:241], v[116:117], v[112:113]
    v_pk_fma_f32 v[114:115], v[242:243], v[118:119], v[114:115]
    v_cvt_pk_bf16_f32 v136, v112, v113
    v_cvt_pk_bf16_f32 v137, v114, v115
    v_lshlrev_b32 v112, 16, v202
    v_and_b32 v113, 0xffff0000, v202
    v_lshlrev_b32 v114, 16, v203
    v_and_b32 v115, 0xffff0000, v203
    s_waitcnt lgkmcnt(2)
    v_lshlrev_b32 v116, 16, v106
    v_and_b32 v117, 0xffff0000, v106
    v_lshlrev_b32 v118, 16, v107
    v_and_b32 v119, 0xffff0000, v107
    v_pk_fma_f32 v[112:113], v[244:245], v[116:117], v[112:113]
    v_pk_fma_f32 v[114:115], v[246:247], v[118:119], v[114:115]
    v_cvt_pk_bf16_f32 v138, v112, v113
    v_cvt_pk_bf16_f32 v139, v114, v115
    buffer_store_dwordx4 v[136:139], v5, s[24:27], s22 offen offset:2048 sc1
    v_lshlrev_b32 v112, 16, v204
    v_and_b32 v113, 0xffff0000, v204
    v_lshlrev_b32 v114, 16, v205
    v_and_b32 v115, 0xffff0000, v205
    s_waitcnt lgkmcnt(1)
    v_lshlrev_b32 v116, 16, v108
    v_and_b32 v117, 0xffff0000, v108
    v_lshlrev_b32 v118, 16, v109
    v_and_b32 v119, 0xffff0000, v109
    v_pk_fma_f32 v[112:113], v[248:249], v[116:117], v[112:113]
    v_pk_fma_f32 v[114:115], v[250:251], v[118:119], v[114:115]
    v_cvt_pk_bf16_f32 v140, v112, v113
    v_cvt_pk_bf16_f32 v141, v114, v115
    v_lshlrev_b32 v112, 16, v206
    v_and_b32 v113, 0xffff0000, v206
    v_lshlrev_b32 v114, 16, v207
    v_and_b32 v115, 0xffff0000, v207
    s_waitcnt lgkmcnt(0)
    v_lshlrev_b32 v116, 16, v110
    v_and_b32 v117, 0xffff0000, v110
    v_lshlrev_b32 v118, 16, v111
    v_and_b32 v119, 0xffff0000, v111
    v_pk_fma_f32 v[112:113], v[252:253], v[116:117], v[112:113]
    v_pk_fma_f32 v[114:115], v[254:255], v[118:119], v[114:115]
    v_cvt_pk_bf16_f32 v142, v112, v113
    v_cvt_pk_bf16_f32 v143, v114, v115
    buffer_store_dwordx4 v[140:143], v5, s[24:27], s22 offen offset:3072 sc1
    s_waitcnt vmcnt(4)
    s_branch L_g1
L_aux:
    s_sub_u32 s20, s2, 160
    s_mul_i32 s22, s20, 205
    s_lshr_b32 s22, s22, 11
    s_mul_i32 s21, s22, 10
    s_sub_u32 s21, s20, s21
    s_lshl_b32 s23, s22, 2
    s_lshr_b32 s23, 0x53176420, s23
    s_and_b32 s23, s23, 15
    s_cmp_ge_u32 s22, 8
    s_cselect_b32 s22, 8, s23
    v_lshrrev_b32 v3, 3, v2
    v_and_b32 v4, 7, v2
    v_mul_u32_u24 v9, 1280, v3
    v_lshl_add_u32 v9, v4, 4, v9
    s_lshl_b32 s23, s3, 10
    s_cmp_ge_u32 s20, 54
    s_cbranch_scc1 L_mod
    s_cmp_ge_u32 s20, 27
    s_cselect_b32 s37, 1, 0
    s_mul_i32 s36, s37, 27
    s_sub_u32 s36, s20, s36
    s_mul_i32 s38, s37, 1105920
    s_lshl_b32 s40, s36, 7
    s_add_u32 s38, s38, s40
    s_mul_i32 s40, s3, 27648
    s_add_u32 s38, s38, s40
    v_mul_u32_u24 v3, 3456, v3
    v_lshl_add_u32 v3, v4, 4, v3
    s_waitcnt lgkmcnt(0)
    s_add_u32 s56, s16, 0x16c0000
    s_addc_u32 s57, s17, 0
    s_mov_b32 s58, 0x50000
    s_mov_b32 s59, 0x20000
    v_mov_b32 v10, 32768
    buffer_load_dword v10, v10, s[56:59], 0 offen sc1
    s_mov_b32 s32, s44
    s_mov_b32 s33, s45
    s_mov_b32 s34, 0x21c000
    s_mov_b32 s35, 0x20000
    s_mov_b32 s44, s46
    s_mov_b32 s45, s47
    s_mov_b32 s46, 0x21c000
    s_mov_b32 s47, 0x20000
    s_mov_b32 m0, s23
    s_add_u32 s23, s23, 4096
    buffer_load_dwordx4 v3, s[32:35], s38 offen nt lds
    s_add_u32 m0, m0, 40960
    s_nop 0
    buffer_load_dwordx4 v3, s[44:47], s38 offen nt lds
    s_add_u32 s38, s38, 110592
    s_mov_b32 m0, s23
    s_add_u32 s23, s23, 4096
    buffer_load_dwordx4 v3, s[32:35], s38 offen nt lds
    s_add_u32 m0, m0, 40960
    s_nop 0
    buffer_load_dwordx4 v3, s[44:47], s38 offen nt lds
    s_add_u32 s38, s38, 110592
    s_mov_b32 m0, s23
    s_add_u32 s23, s23, 4096
    buffer_load_dwordx4 v3, s[32:35], s38 offen nt lds
    s_add_u32 m0, m0, 40960
    s_nop 0
    buffer_load_dwordx4 v3, s[44:47], s38 offen nt lds
    s_add_u32 s38, s38, 110592
    s_mov_b32 m0, s23
    s_add_u32 s23, s23, 4096
    buffer_load_dwordx4 v3, s[32:35], s38 offen nt lds
    s_add_u32 m0, m0, 40960
    s_nop 0
    buffer_load_dwordx4 v3, s[44:47], s38 offen nt lds
    s_add_u32 s38, s38, 110592
    s_mov_b32 m0, s23
    s_add_u32 s23, s23, 4096
    buffer_load_dwordx4 v3, s[32:35], s38 offen nt lds
    s_add_u32 m0, m0, 40960
    s_nop 0
    buffer_load_dwordx4 v3, s[44:47], s38 offen nt lds
    s_add_u32 s38, s38, 110592
    s_mov_b32 m0, s23
    s_add_u32 s23, s23, 4096
    buffer_load_dwordx4 v3, s[32:35], s38 offen nt lds
    s_add_u32 m0, m0, 40960
    s_nop 0
    buffer_load_dwordx4 v3, s[44:47], s38 offen nt lds
    s_add_u32 s38, s38, 110592
    s_mov_b32 m0, s23
    s_add_u32 s23, s23, 4096
    buffer_load_dwordx4 v3, s[32:35], s38 offen nt lds
    s_add_u32 m0, m0, 40960
    s_nop 0
    buffer_load_dwordx4 v3, s[44:47], s38 offen nt lds
    s_add_u32 s38, s38, 110592
    s_mov_b32 m0, s23
    s_add_u32 s23, s23, 4096
    buffer_load_dwordx4 v3, s[32:35], s38 offen nt lds
    s_add_u32 m0, m0, 40960
    s_nop 0
    buffer_load_dwordx4 v3, s[44:47], s38 offen nt lds
    s_add_u32 s38, s38, 110592
    s_mov_b32 m0, s23
    s_add_u32 s23, s23, 4096
    buffer_load_dwordx4 v3, s[32:35], s38 offen nt lds
    s_add_u32 m0, m0, 40960
    s_nop 0
    buffer_load_dwordx4 v3, s[44:47], s38 offen nt lds
    s_add_u32 s38, s38, 110592
    s_mov_b32 m0, s23
    s_add_u32 s23, s23, 4096
    buffer_load_dwordx4 v3, s[32:35], s38 offen nt lds
    s_add_u32 m0, m0, 40960
    s_nop 0
    buffer_load_dwordx4 v3, s[44:47], s38 offen nt lds
    s_mov_b32 s32, s48
    s_mov_b32 s33, s49
    s_mov_b32 s34, 0x21c000
    s_mov_b32 s35, 0x20000
    s_mul_i32 s38, s22, 245760
    s_lshl_b32 s40, s21, 7
    s_add_u32 s38, s38, s40
    s_mul_i32 s40, s3, 10240
    s_add_u32 s38, s38, s40
    s_lshl_b32 s23, s3, 10
    s_add_u32 s23, s23, 107520
    v_lshrrev_b32 v247, 4, v2
    v_lshlrev_b32 v246, 10, v247
    v_bfe_u32 v248, v2, 2, 2
    v_lshl_add_u32 v246, v248, 7, v246
    v_lshl_add_u32 v246, v1, 5, v246
    v_and_b32 v248, 3, v2
    v_lshl_add_u32 v248, v248, 3, v246
    v_add_u32 v248, 107520, v248
    v_lshlrev_b32 v249, 4, v2
    s_mov_b32 m0, s23
    s_add_u32 s23, s23, 4096
    buffer_load_dwordx4 v9, s[32:35], s38 offen lds
    s_add_u32 s38, s38, 40960
    s_mov_b32 m0, s23
    s_add_u32 s23, s23, 4096
    buffer_load_dwordx4 v9, s[32:35], s38 offen lds
    s_add_u32 s38, s38, 40960
    s_mov_b32 m0, s23
    s_add_u32 s23, s23, 4096
    buffer_load_dwordx4 v9, s[32:35], s38 offen lds
    s_add_u32 s38, s38, 40960
    s_mov_b32 m0, s23
    s_add_u32 s23, s23, 4096
    buffer_load_dwordx4 v9, s[32:35], s38 offen lds
    s_add_u32 s38, s38, 40960
    s_mov_b32 m0, s23
    s_add_u32 s23, s23, 4096
    buffer_load_dwordx4 v9, s[32:35], s38 offen lds
    s_add_u32 s38, s38, 40960
    s_mov_b32 m0, s23
    s_add_u32 s23, s23, 4096
    buffer_load_dwordx4 v9, s[32:35], s38 offen lds
    s_add_u32 s24, s16, 0x1540000
    s_addc_u32 s25, s17, 0
    s_mov_b32 s26, 0x1e000
    s_mov_b32 s27, 0x20000
    s_add_u32 s28, s16, 0x780000
    s_addc_u32 s29, s17, 0
    s_mov_b32 s30, 0x438000
    s_mov_b32 s31, 0x20000
    s_mul_i32 s40, s37, 2560
    v_min_u32 v4, 159, v0
    v_lshl_add_u32 v4, v4, 4, s40
    v_and_b32 v12, 1, v2
    v_lshl_add_u32 v6, v12, 4, v246
    v_bfe_u32 v12, v2, 1, 1
    v_lshl_add_u32 v6, v12, 3, v6
    v_add_u32 v18, 40960, v6
    v_and_b32 v19, 15, v2
    v_lshlrev_b32 v19, 4, v19
    v_lshl_add_u32 v19, v247, 9, v19
    v_lshlrev_b32 v13, 5, v247
    v_add_u32 v13, 81920, v13
    v_lshlrev_b32 v14, 4, v247
    v_add_u32 v14, 83968, v14
    s_lshl_b32 s20, s36, 2
    s_add_u32 s20, s20, s3
    s_mul_i32 s39, s20, 40960
    s_mul_i32 s40, s37, 20480
    s_add_u32 s39, s39, s40
    v_mov_b32 v28, 0x3f803f80
    v_mov_b32 v29, v28
    v_mov_b32 v30, v28
    v_mov_b32 v31, v28
    s_mov_b32 s4, 20480
    s_mov_b32 s5, 51200
    s_mov_b32 s6, 81920
    s_mov_b32 s7, 112640
    s_waitcnt vmcnt(20)
    v_readfirstlane_b32 s64, v10
    s_add_u32 s64, s64, 0x9e3779b1
    s_waitcnt vmcnt(0)
    s_mov_b32 s66, 0x8000
    s_branch L_gf_15
L_gl_12:
    s_sleep 8
L_gf_15:
    buffer_load_dwordx4 v[128:131], v4, s[24:27], s4 offen sc1
    buffer_load_dwordx4 v[132:135], v4, s[24:27], s5 offen sc1
    buffer_load_dwordx4 v[136:139], v4, s[24:27], s6 offen sc1
    buffer_load_dwordx4 v[140:143], v4, s[24:27], s7 offen sc1
L_gc_13:
    s_sub_u32 s66, s66, 1
    s_cmp_eq_u32 s66, 0
    s_waitcnt vmcnt(0)
    s_cbranch_scc1 L_gd_14
    v_cmp_ne_u32 vcc, s64, v129
    s_cbranch_vccnz L_gl_12
    v_cmp_ne_u32 vcc, s64, v131
    s_cbranch_vccnz L_gl_12
    v_cmp_ne_u32 vcc, s64, v133
    s_cbranch_vccnz L_gl_12
    v_cmp_ne_u32 vcc, s64, v135
    s_cbranch_vccnz L_gl_12
    v_cmp_ne_u32 vcc, s64, v137
    s_cbranch_vccnz L_gl_12
    v_cmp_ne_u32 vcc, s64, v139
    s_cbranch_vccnz L_gl_12
    v_cmp_ne_u32 vcc, s64, v141
    s_cbranch_vccnz L_gl_12
    v_cmp_ne_u32 vcc, s64, v143
    s_cbranch_vccnz L_gl_12
L_gd_14:
    v_add_f32 v128, v128, v132
    v_add_f32 v130, v130, v134
    v_add_f32 v136, v136, v140
    v_add_f32 v138, v138, v142
    v_add_f32 v128, v128, v136
    v_add_f32 v130, v130, v138
    v_cvt_pk_bf16_f32 v12, v128, v130
    v_lshlrev_b32 v5, 3, v0
    v_lshlrev_b32 v10, 16, v12
    v_and_b32 v11, 0xffff0000, v12
    v_add_f32 v10, 1.0, v10
    v_add_f32 v11, 1.0, v11
    v_cvt_pk_bf16_f32 v12, v10, v11
    v_add_u32 v5, 81920, v5
    v_lshlrev_b32 v10, 16, v12
    v_and_b32 v11, 0xffff0000, v12
    ds_write_b64 v5, v[10:11]
    s_waitcnt lgkmcnt(0)
    s_barrier
    s_cmp_lg_u32 s3, 0
    s_cbranch_scc1 L_sig_16
    v_mov_b32 v60, s64
    v_mov_b32 v61, 0
    s_mov_b64 exec, 1
    buffer_store_dword v60, v61, s[56:59], s65 offen offset:0 sc1
    s_mov_b64 exec, -1
L_sig_16:
    ds_read_b64_tr_b16 v[144:145], v6 offset:0
    ds_read_b64_tr_b16 v[146:147], v6 offset:512
    ds_read_b64_tr_b16 v[148:149], v18 offset:0
    ds_read_b64_tr_b16 v[150:151], v18 offset:512
    ds_read_b128 v[32:35], v13 offset:0
    ds_read_b128 v[36:39], v13 offset:16
    ds_read_b64_tr_b16 v[152:153], v6 offset:4096
    ds_read_b64_tr_b16 v[154:155], v6 offset:4608
    ds_read_b64_tr_b16 v[156:157], v18 offset:4096
    ds_read_b64_tr_b16 v[158:159], v18 offset:4608
    ds_read_b128 v[40:43], v13 offset:128
    ds_read_b128 v[44:47], v13 offset:144
    s_waitcnt lgkmcnt(6)
    v_lshlrev_b32 v20, 16, v144
    v_and_b32 v21, 0xffff0000, v144
    v_lshlrev_b32 v22, 16, v145
    v_and_b32 v23, 0xffff0000, v145
    v_lshlrev_b32 v24, 16, v146
    v_and_b32 v25, 0xffff0000, v146
    v_lshlrev_b32 v26, 16, v147
    v_and_b32 v27, 0xffff0000, v147
    v_pk_mul_f32 v[20:21], v[20:21], v[32:33]
    v_pk_mul_f32 v[22:23], v[22:23], v[34:35]
    v_pk_mul_f32 v[24:25], v[24:25], v[36:37]
    v_pk_mul_f32 v[26:27], v[26:27], v[38:39]
    v_cvt_pk_bf16_f32 v72, v20, v21
    v_cvt_pk_bf16_f32 v73, v22, v23
    v_cvt_pk_bf16_f32 v74, v24, v25
    v_cvt_pk_bf16_f32 v75, v26, v27
    buffer_store_dwordx4 v[72:75], v249, s[28:31], s39 offen offset:0 sc1
    s_nop 0
    v_mfma_f32_16x16x32_bf16 v[224:227], v[28:31], v[72:75], 0
    v_lshlrev_b32 v20, 16, v148
    v_and_b32 v21, 0xffff0000, v148
    v_lshlrev_b32 v22, 16, v149
    v_and_b32 v23, 0xffff0000, v149
    v_lshlrev_b32 v24, 16, v150
    v_and_b32 v25, 0xffff0000, v150
    v_lshlrev_b32 v26, 16, v151
    v_and_b32 v27, 0xffff0000, v151
    v_pk_mul_f32 v[20:21], v[20:21], v[32:33]
    v_pk_mul_f32 v[22:23], v[22:23], v[34:35]
    v_pk_mul_f32 v[24:25], v[24:25], v[36:37]
    v_pk_mul_f32 v[26:27], v[26:27], v[38:39]
    v_cvt_pk_bf16_f32 v76, v20, v21
    v_cvt_pk_bf16_f32 v77, v22, v23
    v_cvt_pk_bf16_f32 v78, v24, v25
    v_cvt_pk_bf16_f32 v79, v26, v27
    buffer_store_dwordx4 v[76:79], v249, s[28:31], s39 offen offset:1024 sc1
    s_nop 0
    v_mfma_f32_16x16x32_bf16 v[228:231], v[28:31], v[76:79], 0
    ds_read_b64_tr_b16 v[160:161], v6 offset:8192
    ds_read_b64_tr_b16 v[162:163], v6 offset:8704
    ds_read_b64_tr_b16 v[164:165], v18 offset:8192
    ds_read_b64_tr_b16 v[166:167], v18 offset:8704
    ds_read_b128 v[32:35], v13 offset:256
    ds_read_b128 v[36:39], v13 offset:272
    s_waitcnt lgkmcnt(6)
    v_lshlrev_b32 v20, 16, v152
    v_and_b32 v21, 0xffff0000, v152
    v_lshlrev_b32 v22, 16, v153
    v_and_b32 v23, 0xffff0000, v153
    v_lshlrev_b32 v24, 16, v154
    v_and_b32 v25, 0xffff0000, v154
    v_lshlrev_b32 v26, 16, v155
    v_and_b32 v27, 0xffff0000, v155
    v_pk_mul_f32 v[20:21], v[20:21], v[40:41]
    v_pk_mul_f32 v[22:23], v[22:23], v[42:43]
    v_pk_mul_f32 v[24:25], v[24:25], v[44:45]
    v_pk_mul_f32 v[26:27], v[26:27], v[46:47]
    v_cvt_pk_bf16_f32 v80, v20, v21
    v_cvt_pk_bf16_f32 v81, v22, v23
    v_cvt_pk_bf16_f32 v82, v24, v25
    v_cvt_pk_bf16_f32 v83, v26, v27
    buffer_store_dwordx4 v[80:83], v249, s[28:31], s39 offen offset:2048 sc1
    s_nop 0
    v_mfma_f32_16x16x32_bf16 v[224:227], v[28:31], v[80:83], v[224:227]
    v_lshlrev_b32 v20, 16, v156
    v_and_b32 v21, 0xffff0000, v156
    v_lshlrev_b32 v22, 16, v157
    v_and_b32 v23, 0xffff0000, v157
    v_lshlrev_b32 v24, 16, v158
    v_and_b32 v25, 0xffff0000, v158
    v_lshlrev_b32 v26, 16, v159
    v_and_b32 v27, 0xffff0000, v159
    v_pk_mul_f32 v[20:21], v[20:21], v[40:41]
    v_pk_mul_f32 v[22:23], v[22:23], v[42:43]
    v_pk_mul_f32 v[24:25], v[24:25], v[44:45]
    v_pk_mul_f32 v[26:27], v[26:27], v[46:47]
    v_cvt_pk_bf16_f32 v84, v20, v21
    v_cvt_pk_bf16_f32 v85, v22, v23
    v_cvt_pk_bf16_f32 v86, v24, v25
    v_cvt_pk_bf16_f32 v87, v26, v27
    buffer_store_dwordx4 v[84:87], v249, s[28:31], s39 offen offset:3072 sc1
    s_nop 0
    v_mfma_f32_16x16x32_bf16 v[228:231], v[28:31], v[84:87], v[228:231]
    s_add_u32 s39, s39, 4096
    ds_read_b64_tr_b16 v[168:169], v6 offset:12288
    ds_read_b64_tr_b16 v[170:171], v6 offset:12800
    ds_read_b64_tr_b16 v[172:173], v18 offset:12288
    ds_read_b64_tr_b16 v[174:175], v18 offset:12800
    ds_read_b128 v[40:43], v13 offset:384
    ds_read_b128 v[44:47], v13 offset:400
    s_waitcnt lgkmcnt(6)
    v_lshlrev_b32 v20, 16, v160
    v_and_b32 v21, 0xffff0000, v160
    v_lshlrev_b32 v22, 16, v161
    v_and_b32 v23, 0xffff0000, v161
    v_lshlrev_b32 v24, 16, v162
    v_and_b32 v25, 0xffff0000, v162
    v_lshlrev_b32 v26, 16, v163
    v_and_b32 v27, 0xffff0000, v163
    v_pk_mul_f32 v[20:21], v[20:21], v[32:33]
    v_pk_mul_f32 v[22:23], v[22:23], v[34:35]
    v_pk_mul_f32 v[24:25], v[24:25], v[36:37]
    v_pk_mul_f32 v[26:27], v[26:27], v[38:39]
    v_cvt_pk_bf16_f32 v72, v20, v21
    v_cvt_pk_bf16_f32 v73, v22, v23
    v_cvt_pk_bf16_f32 v74, v24, v25
    v_cvt_pk_bf16_f32 v75, v26, v27
    buffer_store_dwordx4 v[72:75], v249, s[28:31], s39 offen offset:0 sc1
    s_nop 0
    v_mfma_f32_16x16x32_bf16 v[224:227], v[28:31], v[72:75], v[224:227]
    v_lshlrev_b32 v20, 16, v164
    v_and_b32 v21, 0xffff0000, v164
    v_lshlrev_b32 v22, 16, v165
    v_and_b32 v23, 0xffff0000, v165
    v_lshlrev_b32 v24, 16, v166
    v_and_b32 v25, 0xffff0000, v166
    v_lshlrev_b32 v26, 16, v167
    v_and_b32 v27, 0xffff0000, v167
    v_pk_mul_f32 v[20:21], v[20:21], v[32:33]
    v_pk_mul_f32 v[22:23], v[22:23], v[34:35]
    v_pk_mul_f32 v[24:25], v[24:25], v[36:37]
    v_pk_mul_f32 v[26:27], v[26:27], v[38:39]
    v_cvt_pk_bf16_f32 v76, v20, v21
    v_cvt_pk_bf16_f32 v77, v22, v23
    v_cvt_pk_bf16_f32 v78, v24, v25
    v_cvt_pk_bf16_f32 v79, v26, v27
    buffer_store_dwordx4 v[76:79], v249, s[28:31], s39 offen offset:1024 sc1
    s_nop 0
    v_mfma_f32_16x16x32_bf16 v[228:231], v[28:31], v[76:79], v[228:231]
    ds_read_b64_tr_b16 v[176:177], v6 offset:16384
    ds_read_b64_tr_b16 v[178:179], v6 offset:16896
    ds_read_b64_tr_b16 v[180:181], v18 offset:16384
    ds_read_b64_tr_b16 v[182:183], v18 offset:16896
    ds_read_b128 v[32:35], v13 offset:512
    ds_read_b128 v[36:39], v13 offset:528
    s_waitcnt lgkmcnt(6)
    v_lshlrev_b32 v20, 16, v168
    v_and_b32 v21, 0xffff0000, v168
    v_lshlrev_b32 v22, 16, v169
    v_and_b32 v23, 0xffff0000, v169
    v_lshlrev_b32 v24, 16, v170
    v_and_b32 v25, 0xffff0000, v170
    v_lshlrev_b32 v26, 16, v171
    v_and_b32 v27, 0xffff0000, v171
    v_pk_mul_f32 v[20:21], v[20:21], v[40:41]
    v_pk_mul_f32 v[22:23], v[22:23], v[42:43]
    v_pk_mul_f32 v[24:25], v[24:25], v[44:45]
    v_pk_mul_f32 v[26:27], v[26:27], v[46:47]
    v_cvt_pk_bf16_f32 v80, v20, v21
    v_cvt_pk_bf16_f32 v81, v22, v23
    v_cvt_pk_bf16_f32 v82, v24, v25
    v_cvt_pk_bf16_f32 v83, v26, v27
    buffer_store_dwordx4 v[80:83], v249, s[28:31], s39 offen offset:2048 sc1
    s_nop 0
    v_mfma_f32_16x16x32_bf16 v[224:227], v[28:31], v[80:83], v[224:227]
    v_lshlrev_b32 v20, 16, v172
    v_and_b32 v21, 0xffff0000, v172
    v_lshlrev_b32 v22, 16, v173
    v_and_b32 v23, 0xffff0000, v173
    v_lshlrev_b32 v24, 16, v174
    v_and_b32 v25, 0xffff0000, v174
    v_lshlrev_b32 v26, 16, v175
    v_and_b32 v27, 0xffff0000, v175
    v_pk_mul_f32 v[20:21], v[20:21], v[40:41]
    v_pk_mul_f32 v[22:23], v[22:23], v[42:43]
    v_pk_mul_f32 v[24:25], v[24:25], v[44:45]
    v_pk_mul_f32 v[26:27], v[26:27], v[46:47]
    v_cvt_pk_bf16_f32 v84, v20, v21
    v_cvt_pk_bf16_f32 v85, v22, v23
    v_cvt_pk_bf16_f32 v86, v24, v25
    v_cvt_pk_bf16_f32 v87, v26, v27
    buffer_store_dwordx4 v[84:87], v249, s[28:31], s39 offen offset:3072 sc1
    s_nop 0
    v_mfma_f32_16x16x32_bf16 v[228:231], v[28:31], v[84:87], v[228:231]
    s_add_u32 s39, s39, 4096
    ds_read_b64_tr_b16 v[184:185], v6 offset:20480
    ds_read_b64_tr_b16 v[186:187], v6 offset:20992
    ds_read_b64_tr_b16 v[188:189], v18 offset:20480
    ds_read_b64_tr_b16 v[190:191], v18 offset:20992
    ds_read_b128 v[40:43], v13 offset:640
    ds_read_b128 v[44:47], v13 offset:656
    s_waitcnt lgkmcnt(6)
    v_lshlrev_b32 v20, 16, v176
    v_and_b32 v21, 0xffff0000, v176
    v_lshlrev_b32 v22, 16, v177
    v_and_b32 v23, 0xffff0000, v177
    v_lshlrev_b32 v24, 16, v178
    v_and_b32 v25, 0xffff0000, v178
    v_lshlrev_b32 v26, 16, v179
    v_and_b32 v27, 0xffff0000, v179
    v_pk_mul_f32 v[20:21], v[20:21], v[32:33]
    v_pk_mul_f32 v[22:23], v[22:23], v[34:35]
    v_pk_mul_f32 v[24:25], v[24:25], v[36:37]
    v_pk_mul_f32 v[26:27], v[26:27], v[38:39]
    v_cvt_pk_bf16_f32 v72, v20, v21
    v_cvt_pk_bf16_f32 v73, v22, v23
    v_cvt_pk_bf16_f32 v74, v24, v25
    v_cvt_pk_bf16_f32 v75, v26, v27
    buffer_store_dwordx4 v[72:75], v249, s[28:31], s39 offen offset:0 sc1
    s_nop 0
    v_mfma_f32_16x16x32_bf16 v[224:227], v[28:31], v[72:75], v[224:227]
    v_lshlrev_b32 v20, 16, v180
    v_and_b32 v21, 0xffff0000, v180
    v_lshlrev_b32 v22, 16, v181
    v_and_b32 v23, 0xffff0000, v181
    v_lshlrev_b32 v24, 16, v182
    v_and_b32 v25, 0xffff0000, v182
    v_lshlrev_b32 v26, 16, v183
    v_and_b32 v27, 0xffff0000, v183
    v_pk_mul_f32 v[20:21], v[20:21], v[32:33]
    v_pk_mul_f32 v[22:23], v[22:23], v[34:35]
    v_pk_mul_f32 v[24:25], v[24:25], v[36:37]
    v_pk_mul_f32 v[26:27], v[26:27], v[38:39]
    v_cvt_pk_bf16_f32 v76, v20, v21
    v_cvt_pk_bf16_f32 v77, v22, v23
    v_cvt_pk_bf16_f32 v78, v24, v25
    v_cvt_pk_bf16_f32 v79, v26, v27
    buffer_store_dwordx4 v[76:79], v249, s[28:31], s39 offen offset:1024 sc1
    s_nop 0
    v_mfma_f32_16x16x32_bf16 v[228:231], v[28:31], v[76:79], v[228:231]
    ds_read_b64_tr_b16 v[192:193], v6 offset:24576
    ds_read_b64_tr_b16 v[194:195], v6 offset:25088
    ds_read_b64_tr_b16 v[196:197], v18 offset:24576
    ds_read_b64_tr_b16 v[198:199], v18 offset:25088
    ds_read_b128 v[32:35], v13 offset:768
    ds_read_b128 v[36:39], v13 offset:784
    s_waitcnt lgkmcnt(6)
    v_lshlrev_b32 v20, 16, v184
    v_and_b32 v21, 0xffff0000, v184
    v_lshlrev_b32 v22, 16, v185
    v_and_b32 v23, 0xffff0000, v185
    v_lshlrev_b32 v24, 16, v186
    v_and_b32 v25, 0xffff0000, v186
    v_lshlrev_b32 v26, 16, v187
    v_and_b32 v27, 0xffff0000, v187
    v_pk_mul_f32 v[20:21], v[20:21], v[40:41]
    v_pk_mul_f32 v[22:23], v[22:23], v[42:43]
    v_pk_mul_f32 v[24:25], v[24:25], v[44:45]
    v_pk_mul_f32 v[26:27], v[26:27], v[46:47]
    v_cvt_pk_bf16_f32 v80, v20, v21
    v_cvt_pk_bf16_f32 v81, v22, v23
    v_cvt_pk_bf16_f32 v82, v24, v25
    v_cvt_pk_bf16_f32 v83, v26, v27
    buffer_store_dwordx4 v[80:83], v249, s[28:31], s39 offen offset:2048 sc1
    s_nop 0
    v_mfma_f32_16x16x32_bf16 v[224:227], v[28:31], v[80:83], v[224:227]
    v_lshlrev_b32 v20, 16, v188
    v_and_b32 v21, 0xffff0000, v188
    v_lshlrev_b32 v22, 16, v189
    v_and_b32 v23, 0xffff0000, v189
    v_lshlrev_b32 v24, 16, v190
    v_and_b32 v25, 0xffff0000, v190
    v_lshlrev_b32 v26, 16, v191
    v_and_b32 v27, 0xffff0000, v191
    v_pk_mul_f32 v[20:21], v[20:21], v[40:41]
    v_pk_mul_f32 v[22:23], v[22:23], v[42:43]
    v_pk_mul_f32 v[24:25], v[24:25], v[44:45]
    v_pk_mul_f32 v[26:27], v[26:27], v[46:47]
    v_cvt_pk_bf16_f32 v84, v20, v21
    v_cvt_pk_bf16_f32 v85, v22, v23
    v_cvt_pk_bf16_f32 v86, v24, v25
    v_cvt_pk_bf16_f32 v87, v26, v27
    buffer_store_dwordx4 v[84:87], v249, s[28:31], s39 offen offset:3072 sc1
    s_nop 0
    v_mfma_f32_16x16x32_bf16 v[228:231], v[28:31], v[84:87], v[228:231]
    s_add_u32 s39, s39, 4096
    ds_read_b64_tr_b16 v[200:201], v6 offset:28672
    ds_read_b64_tr_b16 v[202:203], v6 offset:29184
    ds_read_b64_tr_b16 v[204:205], v18 offset:28672
    ds_read_b64_tr_b16 v[206:207], v18 offset:29184
    ds_read_b128 v[40:43], v13 offset:896
    ds_read_b128 v[44:47], v13 offset:912
    s_waitcnt lgkmcnt(6)
    v_lshlrev_b32 v20, 16, v192
    v_and_b32 v21, 0xffff0000, v192
    v_lshlrev_b32 v22, 16, v193
    v_and_b32 v23, 0xffff0000, v193
    v_lshlrev_b32 v24, 16, v194
    v_and_b32 v25, 0xffff0000, v194
    v_lshlrev_b32 v26, 16, v195
    v_and_b32 v27, 0xffff0000, v195
    v_pk_mul_f32 v[20:21], v[20:21], v[32:33]
    v_pk_mul_f32 v[22:23], v[22:23], v[34:35]
    v_pk_mul_f32 v[24:25], v[24:25], v[36:37]
    v_pk_mul_f32 v[26:27], v[26:27], v[38:39]
    v_cvt_pk_bf16_f32 v72, v20, v21
    v_cvt_pk_bf16_f32 v73, v22, v23
    v_cvt_pk_bf16_f32 v74, v24, v25
    v_cvt_pk_bf16_f32 v75, v26, v27
    buffer_store_dwordx4 v[72:75], v249, s[28:31], s39 offen offset:0 sc1
    s_nop 0
    v_mfma_f32_16x16x32_bf16 v[224:227], v[28:31], v[72:75], v[224:227]
    v_lshlrev_b32 v20, 16, v196
    v_and_b32 v21, 0xffff0000, v196
    v_lshlrev_b32 v22, 16, v197
    v_and_b32 v23, 0xffff0000, v197
    v_lshlrev_b32 v24, 16, v198
    v_and_b32 v25, 0xffff0000, v198
    v_lshlrev_b32 v26, 16, v199
    v_and_b32 v27, 0xffff0000, v199
    v_pk_mul_f32 v[20:21], v[20:21], v[32:33]
    v_pk_mul_f32 v[22:23], v[22:23], v[34:35]
    v_pk_mul_f32 v[24:25], v[24:25], v[36:37]
    v_pk_mul_f32 v[26:27], v[26:27], v[38:39]
    v_cvt_pk_bf16_f32 v76, v20, v21
    v_cvt_pk_bf16_f32 v77, v22, v23
    v_cvt_pk_bf16_f32 v78, v24, v25
    v_cvt_pk_bf16_f32 v79, v26, v27
    buffer_store_dwordx4 v[76:79], v249, s[28:31], s39 offen offset:1024 sc1
    s_nop 0
    v_mfma_f32_16x16x32_bf16 v[228:231], v[28:31], v[76:79], v[228:231]
    ds_read_b64_tr_b16 v[208:209], v6 offset:32768
    ds_read_b64_tr_b16 v[210:211], v6 offset:33280
    ds_read_b64_tr_b16 v[212:213], v18 offset:32768
    ds_read_b64_tr_b16 v[214:215], v18 offset:33280
    ds_read_b128 v[32:35], v13 offset:1024
    ds_read_b128 v[36:39], v13 offset:1040
    s_waitcnt lgkmcnt(6)
    v_lshlrev_b32 v20, 16, v200
    v_and_b32 v21, 0xffff0000, v200
    v_lshlrev_b32 v22, 16, v201
    v_and_b32 v23, 0xffff0000, v201
    v_lshlrev_b32 v24, 16, v202
    v_and_b32 v25, 0xffff0000, v202
    v_lshlrev_b32 v26, 16, v203
    v_and_b32 v27, 0xffff0000, v203
    v_pk_mul_f32 v[20:21], v[20:21], v[40:41]
    v_pk_mul_f32 v[22:23], v[22:23], v[42:43]
    v_pk_mul_f32 v[24:25], v[24:25], v[44:45]
    v_pk_mul_f32 v[26:27], v[26:27], v[46:47]
    v_cvt_pk_bf16_f32 v80, v20, v21
    v_cvt_pk_bf16_f32 v81, v22, v23
    v_cvt_pk_bf16_f32 v82, v24, v25
    v_cvt_pk_bf16_f32 v83, v26, v27
    buffer_store_dwordx4 v[80:83], v249, s[28:31], s39 offen offset:2048 sc1
    s_nop 0
    v_mfma_f32_16x16x32_bf16 v[224:227], v[28:31], v[80:83], v[224:227]
    v_lshlrev_b32 v20, 16, v204
    v_and_b32 v21, 0xffff0000, v204
    v_lshlrev_b32 v22, 16, v205
    v_and_b32 v23, 0xffff0000, v205
    v_lshlrev_b32 v24, 16, v206
    v_and_b32 v25, 0xffff0000, v206
    v_lshlrev_b32 v26, 16, v207
    v_and_b32 v27, 0xffff0000, v207
    v_pk_mul_f32 v[20:21], v[20:21], v[40:41]
    v_pk_mul_f32 v[22:23], v[22:23], v[42:43]
    v_pk_mul_f32 v[24:25], v[24:25], v[44:45]
    v_pk_mul_f32 v[26:27], v[26:27], v[46:47]
    v_cvt_pk_bf16_f32 v84, v20, v21
    v_cvt_pk_bf16_f32 v85, v22, v23
    v_cvt_pk_bf16_f32 v86, v24, v25
    v_cvt_pk_bf16_f32 v87, v26, v27
    buffer_store_dwordx4 v[84:87], v249, s[28:31], s39 offen offset:3072 sc1
    s_nop 0
    v_mfma_f32_16x16x32_bf16 v[228:231], v[28:31], v[84:87], v[228:231]
    s_add_u32 s39, s39, 4096
    ds_read_b64_tr_b16 v[216:217], v6 offset:36864
    ds_read_b64_tr_b16 v[218:219], v6 offset:37376
    ds_read_b64_tr_b16 v[220:221], v18 offset:36864
    ds_read_b64_tr_b16 v[222:223], v18 offset:37376
    ds_read_b128 v[40:43], v13 offset:1152
    ds_read_b128 v[44:47], v13 offset:1168
    s_waitcnt lgkmcnt(6)
    v_lshlrev_b32 v20, 16, v208
    v_and_b32 v21, 0xffff0000, v208
    v_lshlrev_b32 v22, 16, v209
    v_and_b32 v23, 0xffff0000, v209
    v_lshlrev_b32 v24, 16, v210
    v_and_b32 v25, 0xffff0000, v210
    v_lshlrev_b32 v26, 16, v211
    v_and_b32 v27, 0xffff0000, v211
    v_pk_mul_f32 v[20:21], v[20:21], v[32:33]
    v_pk_mul_f32 v[22:23], v[22:23], v[34:35]
    v_pk_mul_f32 v[24:25], v[24:25], v[36:37]
    v_pk_mul_f32 v[26:27], v[26:27], v[38:39]
    v_cvt_pk_bf16_f32 v72, v20, v21
    v_cvt_pk_bf16_f32 v73, v22, v23
    v_cvt_pk_bf16_f32 v74, v24, v25
    v_cvt_pk_bf16_f32 v75, v26, v27
    buffer_store_dwordx4 v[72:75], v249, s[28:31], s39 offen offset:0 sc1
    s_nop 0
    v_mfma_f32_16x16x32_bf16 v[224:227], v[28:31], v[72:75], v[224:227]
    v_lshlrev_b32 v20, 16, v212
    v_and_b32 v21, 0xffff0000, v212
    v_lshlrev_b32 v22, 16, v213
    v_and_b32 v23, 0xffff0000, v213
    v_lshlrev_b32 v24, 16, v214
    v_and_b32 v25, 0xffff0000, v214
    v_lshlrev_b32 v26, 16, v215
    v_and_b32 v27, 0xffff0000, v215
    v_pk_mul_f32 v[20:21], v[20:21], v[32:33]
    v_pk_mul_f32 v[22:23], v[22:23], v[34:35]
    v_pk_mul_f32 v[24:25], v[24:25], v[36:37]
    v_pk_mul_f32 v[26:27], v[26:27], v[38:39]
    v_cvt_pk_bf16_f32 v76, v20, v21
    v_cvt_pk_bf16_f32 v77, v22, v23
    v_cvt_pk_bf16_f32 v78, v24, v25
    v_cvt_pk_bf16_f32 v79, v26, v27
    buffer_store_dwordx4 v[76:79], v249, s[28:31], s39 offen offset:1024 sc1
    s_nop 0
    v_mfma_f32_16x16x32_bf16 v[228:231], v[28:31], v[76:79], v[228:231]
    s_waitcnt lgkmcnt(0)
    v_lshlrev_b32 v20, 16, v216
    v_and_b32 v21, 0xffff0000, v216
    v_lshlrev_b32 v22, 16, v217
    v_and_b32 v23, 0xffff0000, v217
    v_lshlrev_b32 v24, 16, v218
    v_and_b32 v25, 0xffff0000, v218
    v_lshlrev_b32 v26, 16, v219
    v_and_b32 v27, 0xffff0000, v219
    v_pk_mul_f32 v[20:21], v[20:21], v[40:41]
    v_pk_mul_f32 v[22:23], v[22:23], v[42:43]
    v_pk_mul_f32 v[24:25], v[24:25], v[44:45]
    v_pk_mul_f32 v[26:27], v[26:27], v[46:47]
    v_cvt_pk_bf16_f32 v80, v20, v21
    v_cvt_pk_bf16_f32 v81, v22, v23
    v_cvt_pk_bf16_f32 v82, v24, v25
    v_cvt_pk_bf16_f32 v83, v26, v27
    buffer_store_dwordx4 v[80:83], v249, s[28:31], s39 offen offset:2048 sc1
    s_nop 0
    v_mfma_f32_16x16x32_bf16 v[224:227], v[28:31], v[80:83], v[224:227]
    v_lshlrev_b32 v20, 16, v220
    v_and_b32 v21, 0xffff0000, v220
    v_lshlrev_b32 v22, 16, v221
    v_and_b32 v23, 0xffff0000, v221
    v_lshlrev_b32 v24, 16, v222
    v_and_b32 v25, 0xffff0000, v222
    v_lshlrev_b32 v26, 16, v223
    v_and_b32 v27, 0xffff0000, v223
    v_pk_mul_f32 v[20:21], v[20:21], v[40:41]
    v_pk_mul_f32 v[22:23], v[22:23], v[42:43]
    v_pk_mul_f32 v[24:25], v[24:25], v[44:45]
    v_pk_mul_f32 v[26:27], v[26:27], v[46:47]
    v_cvt_pk_bf16_f32 v84, v20, v21
    v_cvt_pk_bf16_f32 v85, v22, v23
    v_cvt_pk_bf16_f32 v86, v24, v25
    v_cvt_pk_bf16_f32 v87, v26, v27
    buffer_store_dwordx4 v[84:87], v249, s[28:31], s39 offen offset:3072 sc1
    s_nop 0
    v_mfma_f32_16x16x32_bf16 v[228:231], v[28:31], v[84:87], v[228:231]
    s_add_u32 s39, s39, 4096
    s_waitcnt vmcnt(0)
    s_barrier
    s_cmp_lg_u32 s3, 0
    s_cbranch_scc1 L_sig_17
    v_mov_b32 v60, s64
    v_mov_b32 v61, 0
    s_mov_b64 exec, 1
    buffer_store_dword v60, v61, s[56:59], s65 offen offset:4 sc1
    s_mov_b64 exec, -1
L_sig_17:
    s_mov_b32 s44, s48
    s_mov_b32 s45, s49
    s_mov_b32 s46, 0x21c000
    s_mov_b32 s47, 0x20000
    s_and_b32 s66, s2, 1
    s_lshl_b32 s66, s66, 2
    s_lshr_b32 s14, s2, 6
    s_add_u32 s66, s66, s14
    s_mul_i32 s66, s66, 160
    s_mul_i32 s14, s3, 14
    s_lshr_b32 s15, s3, 1
    s_sub_u32 s14, s14, s15
    s_mul_i32 s14, s14, 40960
    s_add_u32 s14, s14, s66
    s_mul_i32 s15, s3, 15360
    s_add_u32 s15, s15, 0
    v_add_u32 v239, 0, v2
    v_mul_u32_u24 v234, 205, v239
    v_lshrrev_b32 v234, 11, v234
    v_mul_u32_u24 v234, 1120, v234
    v_lshl_add_u32 v234, v2, 4, v234
    v_add_u32 v239, 64, v2
    v_mul_u32_u24 v235, 205, v239
    v_lshrrev_b32 v235, 11, v235
    v_mul_u32_u24 v235, 1120, v235
    v_lshl_add_u32 v235, v2, 4, v235
    v_add_u32 v239, 128, v2
    v_mul_u32_u24 v236, 205, v239
    v_lshrrev_b32 v236, 11, v236
    v_mul_u32_u24 v236, 1120, v236
    v_lshl_add_u32 v236, v2, 4, v236
    v_add_u32 v239, 192, v2
    v_mul_u32_u24 v237, 205, v239
    v_lshrrev_b32 v237, 11, v237
    v_mul_u32_u24 v237, 1120, v237
    v_lshl_add_u32 v237, v2, 4, v237
    v_add_u32 v239, 256, v2
    v_mul_u32_u24 v238, 205, v239
    v_lshrrev_b32 v238, 11, v238
    v_mul_u32_u24 v238, 1120, v238
    v_lshl_add_u32 v238, v239, 4, v238
    v_lshrrev_b32 v239, 4, v2
    v_mul_u32_u24 v239, 640, v239
    v_add_u32 v239, s15, v239
    v_lshrrev_b32 v240, 2, v2
    v_mul_u32_u24 v240, 160, v240
    v_add_u32 v239, v239, v240
    v_and_b32 v240, 3, v2
    v_lshl_add_u32 v239, v240, 3, v239
    s_add_u32 m0, s15, 0
    s_nop 0
    buffer_load_dwordx4 v234, s[44:47], s14 offen offset:0 lds
    buffer_load_dwordx4 v235, s[44:47], s14 offen offset:1024 lds
    buffer_load_dwordx4 v236, s[44:47], s14 offen offset:2048 lds
    buffer_load_dwordx4 v237, s[44:47], s14 offen offset:3072 lds
    s_add_u32 m0, s15, 4096
    s_nop 0
    buffer_load_dwordx4 v238, s[44:47], s14 offen offset:0 lds
    s_add_u32 m0, s15, 5120
    s_add_u32 s14, s14, 40960
    s_nop 0
    buffer_load_dwordx4 v234, s[44:47], s14 offen offset:0 lds
    buffer_load_dwordx4 v235, s[44:47], s14 offen offset:1024 lds
    buffer_load_dwordx4 v236, s[44:47], s14 offen offset:2048 lds
    buffer_load_dwordx4 v237, s[44:47], s14 offen offset:3072 lds
    s_add_u32 m0, s15, 9216
    s_nop 0
    buffer_load_dwordx4 v238, s[44:47], s14 offen offset:0 lds
    s_add_u32 m0, s15, 10240
    s_add_u32 s14, s14, 40960
    s_nop 0
    buffer_load_dwordx4 v234, s[44:47], s14 offen offset:0 lds
    buffer_load_dwordx4 v235, s[44:47], s14 offen offset:1024 lds
    buffer_load_dwordx4 v236, s[44:47], s14 offen offset:2048 lds
    buffer_load_dwordx4 v237, s[44:47], s14 offen offset:3072 lds
    s_add_u32 m0, s15, 14336
    s_nop 0
    buffer_load_dwordx4 v238, s[44:47], s14 offen offset:0 lds
    s_lshl_b32 s39, s37, 9
    s_lshl_b32 s12, s20, 11
    s_add_u32 s12, s12, s39
    s_branch L_w2
L_mod:
    s_sub_u32 s36, s20, 54
    s_mul_i32 s37, s36, 205
    s_lshr_b32 s37, s37, 11
    s_mul_i32 s38, s37, 10
    s_sub_u32 s38, s36, s38
    s_add_u32 s38, s38, 40
    s_min_u32 s37, s37, 3
    s_mov_b32 s39, s36
    s_cmp_ge_u32 s36, 40
    s_cselect_b32 s43, 0x40000000, 0
    s_mul_i32 s41, s37, 30720
    s_lshl_b32 s40, s38, 9
    s_add_u32 s41, s41, s40
    s_add_u32 s41, s41, s43
    s_lshl_b32 s42, s39, 9
    s_add_u32 s42, s42, s43
    s_lshl_b32 s38, s38, 7
    s_mul_i32 s40, s37, 1228800
    s_add_u32 s38, s38, s40
    s_add_u32 s36, s38, 1280
    s_lshl_b32 s39, s39, 7
    v_lshrrev_b32 v250, 5, v0
    v_and_b32 v251, 31, v0
    v_mul_u32_u24 v252, 7680, v250
    v_lshl_add_u32 v252, v251, 4, v252
    v_add_u32 v252, s43, v252
    v_lshlrev_b32 v5, 1, v0
    v_lshrrev_b32 v6, 3, v0
    v_and_b32 v7, 7, v0
    v_mul_u32_u24 v8, 7680, v6
    v_lshl_add_u32 v8, v7, 4, v8
    v_add_u32 v8, s43, v8
    s_waitcnt lgkmcnt(0)
    s_mov_b32 s24, s50
    s_mov_b32 s25, s51
    s_mov_b32 s26, 0x500
    s_mov_b32 s27, 0x20000
    s_mov_b32 s28, s52
    s_mov_b32 s29, s53
    s_mov_b32 s30, 0x4b0000
    s_mov_b32 s31, 0x20000
    buffer_load_ushort v11, v5, s[24:27], 0 offen offset:0
    buffer_load_ushort v12, v5, s[24:27], 0 offen offset:512
    buffer_load_ushort v13, v5, s[24:27], 0 offen offset:1024
    s_add_u32 s56, s16, 0x16c0000
    s_addc_u32 s57, s17, 0
    s_mov_b32 s58, 0x50000
    s_mov_b32 s59, 0x20000
    v_mov_b32 v10, 32768
    buffer_load_dword v10, v10, s[56:59], 0 offen sc1
    buffer_load_dwordx4 v[64:67], v8, s[28:31], s38 offen nt
    s_add_u32 s38, s38, 245760
    buffer_load_dwordx4 v[68:71], v8, s[28:31], s38 offen nt
    s_add_u32 s38, s38, 245760
    buffer_load_dwordx4 v[72:75], v8, s[28:31], s38 offen nt
    s_add_u32 s38, s38, 245760
    buffer_load_dwordx4 v[76:79], v8, s[28:31], s38 offen nt
    s_add_u32 s38, s38, 245760
    buffer_load_dwordx4 v[80:83], v8, s[28:31], s38 offen nt
    s_add_u32 s24, s16, 0x1540000
    s_addc_u32 s25, s17, 0
    s_mov_b32 s26, 0x1e000
    s_mov_b32 s27, 0x20000
    s_mul_i32 s37, s37, 640
    v_lshlrev_b32 v18, 2, v6
    v_add_u32 v18, 86016, v18
    v_add_u32 v17, s37, v18
    v_mul_u32_u24 v241, 272, v6
    v_lshl_add_u32 v241, v7, 5, v241
    v_add_u32 v241, 90112, v241
    v_and_b32 v243, 3, v0
    v_lshrrev_b32 v244, 2, v0
    v_mul_u32_u24 v242, 272, v243
    v_lshl_add_u32 v242, v244, 2, v242
    v_add_u32 v242, 90112, v242
    v_lshlrev_b32 v244, 3, v244
    s_waitcnt vmcnt(5)
    v_readfirstlane_b32 s64, v10
    s_add_u32 s64, s64, 0x9e3779b1
    v_lshlrev_b32 v11, 16, v11
    v_lshlrev_b32 v12, 16, v12
    v_lshlrev_b32 v13, 16, v13
    v_mul_f32 v14, 0xbfb8aa3b, v11
    v_mul_f32 v15, 0xbfb8aa3b, v12
    v_mul_f32 v16, 0xbfb8aa3b, v13
    v_exp_f32 v14, v14
    v_exp_f32 v15, v15
    v_exp_f32 v16, v16
    v_add_f32 v14, 1.0, v14
    v_add_f32 v15, 1.0, v15
    v_add_f32 v16, 1.0, v16
    v_rcp_f32 v14, v14
    v_rcp_f32 v15, v15
    v_rcp_f32 v16, v16
    v_mul_f32 v14, v11, v14
    v_mul_f32 v15, v12, v15
    v_mul_f32 v16, v13, v16
    v_cvt_pk_bf16_f32 v14, v14, v14
    v_cvt_pk_bf16_f32 v15, v15, v15
    v_cvt_pk_bf16_f32 v16, v16, v16
    v_lshlrev_b32 v14, 16, v14
    v_lshlrev_b32 v15, 16, v15
    v_lshlrev_b32 v16, 16, v16
    v_lshlrev_b32 v5, 2, v0
    v_add_u32 v5, 86016, v5
    ds_write_b32 v5, v14 offset:0
    ds_write_b32 v5, v15 offset:1024
    ds_write_b32 v5, v16 offset:2048
    s_waitcnt lgkmcnt(0)
    s_barrier
    ds_read_b32 v20, v17 offset:0
    ds_read_b32 v21, v17 offset:128
    ds_read_b32 v22, v17 offset:256
    ds_read_b32 v23, v17 offset:384
    ds_read_b32 v24, v17 offset:512
    s_waitcnt lgkmcnt(0)
    ds_read_b32 v200, v18 offset:0
    ds_read_b32 v201, v18 offset:128
    ds_read_b32 v202, v18 offset:256
    ds_read_b32 v203, v18 offset:384
    ds_read_b32 v204, v18 offset:512
    ds_read_b32 v205, v18 offset:640
    ds_read_b32 v206, v18 offset:768
    ds_read_b32 v207, v18 offset:896
    ds_read_b32 v208, v18 offset:1024
    ds_read_b32 v209, v18 offset:1152
    s_waitcnt lgkmcnt(0)
    ds_read_b32 v210, v18 offset:1280
    ds_read_b32 v211, v18 offset:1408
    ds_read_b32 v212, v18 offset:1536
    ds_read_b32 v213, v18 offset:1664
    ds_read_b32 v214, v18 offset:1792
    ds_read_b32 v215, v18 offset:1920
    ds_read_b32 v216, v18 offset:2048
    ds_read_b32 v217, v18 offset:2176
    ds_read_b32 v218, v18 offset:2304
    ds_read_b32 v219, v18 offset:2432
    s_waitcnt vmcnt(4)
    v_lshlrev_b32 v56, 16, v64
    v_and_b32 v57, 0xffff0000, v64
    v_lshlrev_b32 v58, 16, v65
    v_and_b32 v59, 0xffff0000, v65
    v_lshlrev_b32 v60, 16, v66
    v_and_b32 v61, 0xffff0000, v66
    v_lshlrev_b32 v62, 16, v67
    v_and_b32 v63, 0xffff0000, v67
    v_mul_f32 v48, v20, v56
    v_mul_f32 v49, v20, v57
    v_mul_f32 v50, v20, v58
    v_mul_f32 v51, v20, v59
    v_mul_f32 v52, v20, v60
    v_mul_f32 v53, v20, v61
    v_mul_f32 v54, v20, v62
    v_mul_f32 v55, v20, v63
    s_waitcnt vmcnt(3)
    v_lshlrev_b32 v56, 16, v68
    v_and_b32 v57, 0xffff0000, v68
    v_lshlrev_b32 v58, 16, v69
    v_and_b32 v59, 0xffff0000, v69
    v_lshlrev_b32 v60, 16, v70
    v_and_b32 v61, 0xffff0000, v70
    v_lshlrev_b32 v62, 16, v71
    v_and_b32 v63, 0xffff0000, v71
    v_fmac_f32 v48, v21, v56
    v_fmac_f32 v49, v21, v57
    v_fmac_f32 v50, v21, v58
    v_fmac_f32 v51, v21, v59
    v_fmac_f32 v52, v21, v60
    v_fmac_f32 v53, v21, v61
    v_fmac_f32 v54, v21, v62
    v_fmac_f32 v55, v21, v63
    s_waitcnt vmcnt(2)
    v_lshlrev_b32 v56, 16, v72
    v_and_b32 v57, 0xffff0000, v72
    v_lshlrev_b32 v58, 16, v73
    v_and_b32 v59, 0xffff0000, v73
    v_lshlrev_b32 v60, 16, v74
    v_and_b32 v61, 0xffff0000, v74
    v_lshlrev_b32 v62, 16, v75
    v_and_b32 v63, 0xffff0000, v75
    v_fmac_f32 v48, v22, v56
    v_fmac_f32 v49, v22, v57
    v_fmac_f32 v50, v22, v58
    v_fmac_f32 v51, v22, v59
    v_fmac_f32 v52, v22, v60
    v_fmac_f32 v53, v22, v61
    v_fmac_f32 v54, v22, v62
    v_fmac_f32 v55, v22, v63
    s_waitcnt vmcnt(1)
    v_lshlrev_b32 v56, 16, v76
    v_and_b32 v57, 0xffff0000, v76
    v_lshlrev_b32 v58, 16, v77
    v_and_b32 v59, 0xffff0000, v77
    v_lshlrev_b32 v60, 16, v78
    v_and_b32 v61, 0xffff0000, v78
    v_lshlrev_b32 v62, 16, v79
    v_and_b32 v63, 0xffff0000, v79
    v_fmac_f32 v48, v23, v56
    v_fmac_f32 v49, v23, v57
    v_fmac_f32 v50, v23, v58
    v_fmac_f32 v51, v23, v59
    v_fmac_f32 v52, v23, v60
    v_fmac_f32 v53, v23, v61
    v_fmac_f32 v54, v23, v62
    v_fmac_f32 v55, v23, v63
    s_waitcnt vmcnt(0)
    v_lshlrev_b32 v56, 16, v80
    v_and_b32 v57, 0xffff0000, v80
    v_lshlrev_b32 v58, 16, v81
    v_and_b32 v59, 0xffff0000, v81
    v_lshlrev_b32 v60, 16, v82
    v_and_b32 v61, 0xffff0000, v82
    v_lshlrev_b32 v62, 16, v83
    v_and_b32 v63, 0xffff0000, v83
    v_fmac_f32 v48, v24, v56
    v_fmac_f32 v49, v24, v57
    v_fmac_f32 v50, v24, v58
    v_fmac_f32 v51, v24, v59
    v_fmac_f32 v52, v24, v60
    v_fmac_f32 v53, v24, v61
    v_fmac_f32 v54, v24, v62
    v_fmac_f32 v55, v24, v63
    ds_write_b128 v241, v[48:51] offset:0
    ds_write_b128 v241, v[52:55] offset:16
    s_waitcnt lgkmcnt(0)
    s_barrier
    ds_read_b32 v36, v242 offset:0
    ds_read_b32 v37, v242 offset:1088
    ds_read_b32 v38, v242 offset:2176
    ds_read_b32 v39, v242 offset:3264
    ds_read_b32 v40, v242 offset:4352
    ds_read_b32 v41, v242 offset:5440
    ds_read_b32 v42, v242 offset:6528
    ds_read_b32 v43, v242 offset:7616
    s_waitcnt lgkmcnt(0)
    v_add_f32 v36, v36, v40
    v_add_f32 v37, v37, v41
    v_add_f32 v38, v38, v42
    v_add_f32 v39, v39, v43
    v_add_f32 v36, v36, v38
    v_add_f32 v37, v37, v39
    v_add_f32 v36, v36, v37
    v_mov_b32 v37, s64
    s_nop 0
    v_add_f32_dpp v36, v36, v36 quad_perm:[1,0,3,2] row_mask:0xf bank_mask:0xf
    s_nop 1
    v_add_f32_dpp v36, v36, v36 quad_perm:[2,3,0,1] row_mask:0xf bank_mask:0xf
    s_mov_b32 exec_lo, 0x11111111
    s_mov_b32 exec_hi, 0x11111111
    buffer_store_dwordx2 v[36:37], v244, s[24:27], s41 offen sc1
    s_mov_b64 exec, -1
    s_cmp_lg_u32 s3, 0
    s_cbranch_scc1 L_sig_18
    v_mov_b32 v44, s64
    v_mov_b32 v45, 0
    s_mov_b64 exec, 1
    buffer_store_dword v44, v45, s[56:59], s65 offen offset:0 sc1
    s_mov_b64 exec, -1
L_sig_18:
    buffer_load_dwordx4 v[104:107], v8, s[28:31], s39 offen nt
    s_add_u32 s39, s39, 245760
    buffer_load_dwordx4 v[108:111], v8, s[28:31], s39 offen nt
    s_add_u32 s39, s39, 245760
    buffer_load_dwordx4 v[112:115], v8, s[28:31], s39 offen nt
    s_add_u32 s39, s39, 245760
    buffer_load_dwordx4 v[116:119], v8, s[28:31], s39 offen nt
    s_add_u32 s39, s39, 245760
    buffer_load_dwordx4 v[120:123], v8, s[28:31], s39 offen nt
    s_add_u32 s39, s39, 245760
    buffer_load_dwordx4 v[124:127], v8, s[28:31], s39 offen nt
    s_add_u32 s39, s39, 245760
    buffer_load_dwordx4 v[128:131], v8, s[28:31], s39 offen nt
    s_add_u32 s39, s39, 245760
    buffer_load_dwordx4 v[132:135], v8, s[28:31], s39 offen nt
    s_add_u32 s39, s39, 245760
    buffer_load_dwordx4 v[136:139], v8, s[28:31], s39 offen nt
    s_add_u32 s39, s39, 245760
    buffer_load_dwordx4 v[140:143], v8, s[28:31], s39 offen nt
    s_add_u32 s39, s39, 245760
    buffer_load_dwordx4 v[144:147], v8, s[28:31], s39 offen nt
    s_add_u32 s39, s39, 245760
    buffer_load_dwordx4 v[148:151], v8, s[28:31], s39 offen nt
    s_add_u32 s39, s39, 245760
    buffer_load_dwordx4 v[152:155], v8, s[28:31], s39 offen nt
    s_add_u32 s39, s39, 245760
    buffer_load_dwordx4 v[156:159], v8, s[28:31], s39 offen nt
    s_add_u32 s39, s39, 245760
    buffer_load_dwordx4 v[160:163], v8, s[28:31], s39 offen nt
    s_add_u32 s39, s39, 245760
    buffer_load_dwordx4 v[164:167], v8, s[28:31], s39 offen nt
    s_add_u32 s39, s39, 245760
    buffer_load_dwordx4 v[168:171], v8, s[28:31], s39 offen nt
    s_add_u32 s39, s39, 245760
    buffer_load_dwordx4 v[172:175], v8, s[28:31], s39 offen nt
    s_add_u32 s39, s39, 245760
    buffer_load_dwordx4 v[176:179], v8, s[28:31], s39 offen nt
    s_add_u32 s39, s39, 245760
    buffer_load_dwordx4 v[180:183], v8, s[28:31], s39 offen nt
    buffer_load_dwordx4 v[84:87], v8, s[28:31], s36 offen nt
    s_add_u32 s36, s36, 245760
    buffer_load_dwordx4 v[88:91], v8, s[28:31], s36 offen nt
    s_add_u32 s36, s36, 245760
    buffer_load_dwordx4 v[92:95], v8, s[28:31], s36 offen nt
    s_add_u32 s36, s36, 245760
    buffer_load_dwordx4 v[96:99], v8, s[28:31], s36 offen nt
    s_add_u32 s36, s36, 245760
    buffer_load_dwordx4 v[100:103], v8, s[28:31], s36 offen nt
    s_waitcnt vmcnt(24)
    v_lshlrev_b32 v56, 16, v104
    v_and_b32 v57, 0xffff0000, v104
    v_lshlrev_b32 v58, 16, v105
    v_and_b32 v59, 0xffff0000, v105
    v_lshlrev_b32 v60, 16, v106
    v_and_b32 v61, 0xffff0000, v106
    v_lshlrev_b32 v62, 16, v107
    v_and_b32 v63, 0xffff0000, v107
    v_mul_f32 v48, v200, v56
    v_mul_f32 v49, v200, v57
    v_mul_f32 v50, v200, v58
    v_mul_f32 v51, v200, v59
    v_mul_f32 v52, v200, v60
    v_mul_f32 v53, v200, v61
    v_mul_f32 v54, v200, v62
    v_mul_f32 v55, v200, v63
    s_waitcnt vmcnt(23)
    v_lshlrev_b32 v56, 16, v108
    v_and_b32 v57, 0xffff0000, v108
    v_lshlrev_b32 v58, 16, v109
    v_and_b32 v59, 0xffff0000, v109
    v_lshlrev_b32 v60, 16, v110
    v_and_b32 v61, 0xffff0000, v110
    v_lshlrev_b32 v62, 16, v111
    v_and_b32 v63, 0xffff0000, v111
    v_fmac_f32 v48, v201, v56
    v_fmac_f32 v49, v201, v57
    v_fmac_f32 v50, v201, v58
    v_fmac_f32 v51, v201, v59
    v_fmac_f32 v52, v201, v60
    v_fmac_f32 v53, v201, v61
    v_fmac_f32 v54, v201, v62
    v_fmac_f32 v55, v201, v63
    s_waitcnt vmcnt(22)
    v_lshlrev_b32 v56, 16, v112
    v_and_b32 v57, 0xffff0000, v112
    v_lshlrev_b32 v58, 16, v113
    v_and_b32 v59, 0xffff0000, v113
    v_lshlrev_b32 v60, 16, v114
    v_and_b32 v61, 0xffff0000, v114
    v_lshlrev_b32 v62, 16, v115
    v_and_b32 v63, 0xffff0000, v115
    v_fmac_f32 v48, v202, v56
    v_fmac_f32 v49, v202, v57
    v_fmac_f32 v50, v202, v58
    v_fmac_f32 v51, v202, v59
    v_fmac_f32 v52, v202, v60
    v_fmac_f32 v53, v202, v61
    v_fmac_f32 v54, v202, v62
    v_fmac_f32 v55, v202, v63
    s_waitcnt vmcnt(21)
    v_lshlrev_b32 v56, 16, v116
    v_and_b32 v57, 0xffff0000, v116
    v_lshlrev_b32 v58, 16, v117
    v_and_b32 v59, 0xffff0000, v117
    v_lshlrev_b32 v60, 16, v118
    v_and_b32 v61, 0xffff0000, v118
    v_lshlrev_b32 v62, 16, v119
    v_and_b32 v63, 0xffff0000, v119
    v_fmac_f32 v48, v203, v56
    v_fmac_f32 v49, v203, v57
    v_fmac_f32 v50, v203, v58
    v_fmac_f32 v51, v203, v59
    v_fmac_f32 v52, v203, v60
    v_fmac_f32 v53, v203, v61
    v_fmac_f32 v54, v203, v62
    v_fmac_f32 v55, v203, v63
    s_waitcnt vmcnt(20)
    v_lshlrev_b32 v56, 16, v120
    v_and_b32 v57, 0xffff0000, v120
    v_lshlrev_b32 v58, 16, v121
    v_and_b32 v59, 0xffff0000, v121
    v_lshlrev_b32 v60, 16, v122
    v_and_b32 v61, 0xffff0000, v122
    v_lshlrev_b32 v62, 16, v123
    v_and_b32 v63, 0xffff0000, v123
    v_fmac_f32 v48, v204, v56
    v_fmac_f32 v49, v204, v57
    v_fmac_f32 v50, v204, v58
    v_fmac_f32 v51, v204, v59
    v_fmac_f32 v52, v204, v60
    v_fmac_f32 v53, v204, v61
    v_fmac_f32 v54, v204, v62
    v_fmac_f32 v55, v204, v63
    s_waitcnt vmcnt(19)
    v_lshlrev_b32 v56, 16, v124
    v_and_b32 v57, 0xffff0000, v124
    v_lshlrev_b32 v58, 16, v125
    v_and_b32 v59, 0xffff0000, v125
    v_lshlrev_b32 v60, 16, v126
    v_and_b32 v61, 0xffff0000, v126
    v_lshlrev_b32 v62, 16, v127
    v_and_b32 v63, 0xffff0000, v127
    v_fmac_f32 v48, v205, v56
    v_fmac_f32 v49, v205, v57
    v_fmac_f32 v50, v205, v58
    v_fmac_f32 v51, v205, v59
    v_fmac_f32 v52, v205, v60
    v_fmac_f32 v53, v205, v61
    v_fmac_f32 v54, v205, v62
    v_fmac_f32 v55, v205, v63
    s_waitcnt vmcnt(18)
    v_lshlrev_b32 v56, 16, v128
    v_and_b32 v57, 0xffff0000, v128
    v_lshlrev_b32 v58, 16, v129
    v_and_b32 v59, 0xffff0000, v129
    v_lshlrev_b32 v60, 16, v130
    v_and_b32 v61, 0xffff0000, v130
    v_lshlrev_b32 v62, 16, v131
    v_and_b32 v63, 0xffff0000, v131
    v_fmac_f32 v48, v206, v56
    v_fmac_f32 v49, v206, v57
    v_fmac_f32 v50, v206, v58
    v_fmac_f32 v51, v206, v59
    v_fmac_f32 v52, v206, v60
    v_fmac_f32 v53, v206, v61
    v_fmac_f32 v54, v206, v62
    v_fmac_f32 v55, v206, v63
    s_waitcnt vmcnt(17)
    v_lshlrev_b32 v56, 16, v132
    v_and_b32 v57, 0xffff0000, v132
    v_lshlrev_b32 v58, 16, v133
    v_and_b32 v59, 0xffff0000, v133
    v_lshlrev_b32 v60, 16, v134
    v_and_b32 v61, 0xffff0000, v134
    v_lshlrev_b32 v62, 16, v135
    v_and_b32 v63, 0xffff0000, v135
    v_fmac_f32 v48, v207, v56
    v_fmac_f32 v49, v207, v57
    v_fmac_f32 v50, v207, v58
    v_fmac_f32 v51, v207, v59
    v_fmac_f32 v52, v207, v60
    v_fmac_f32 v53, v207, v61
    v_fmac_f32 v54, v207, v62
    v_fmac_f32 v55, v207, v63
    s_waitcnt vmcnt(16)
    v_lshlrev_b32 v56, 16, v136
    v_and_b32 v57, 0xffff0000, v136
    v_lshlrev_b32 v58, 16, v137
    v_and_b32 v59, 0xffff0000, v137
    v_lshlrev_b32 v60, 16, v138
    v_and_b32 v61, 0xffff0000, v138
    v_lshlrev_b32 v62, 16, v139
    v_and_b32 v63, 0xffff0000, v139
    v_fmac_f32 v48, v208, v56
    v_fmac_f32 v49, v208, v57
    v_fmac_f32 v50, v208, v58
    v_fmac_f32 v51, v208, v59
    v_fmac_f32 v52, v208, v60
    v_fmac_f32 v53, v208, v61
    v_fmac_f32 v54, v208, v62
    v_fmac_f32 v55, v208, v63
    s_waitcnt vmcnt(15)
    v_lshlrev_b32 v56, 16, v140
    v_and_b32 v57, 0xffff0000, v140
    v_lshlrev_b32 v58, 16, v141
    v_and_b32 v59, 0xffff0000, v141
    v_lshlrev_b32 v60, 16, v142
    v_and_b32 v61, 0xffff0000, v142
    v_lshlrev_b32 v62, 16, v143
    v_and_b32 v63, 0xffff0000, v143
    v_fmac_f32 v48, v209, v56
    v_fmac_f32 v49, v209, v57
    v_fmac_f32 v50, v209, v58
    v_fmac_f32 v51, v209, v59
    v_fmac_f32 v52, v209, v60
    v_fmac_f32 v53, v209, v61
    v_fmac_f32 v54, v209, v62
    v_fmac_f32 v55, v209, v63
    s_waitcnt vmcnt(14)
    v_lshlrev_b32 v56, 16, v144
    v_and_b32 v57, 0xffff0000, v144
    v_lshlrev_b32 v58, 16, v145
    v_and_b32 v59, 0xffff0000, v145
    v_lshlrev_b32 v60, 16, v146
    v_and_b32 v61, 0xffff0000, v146
    v_lshlrev_b32 v62, 16, v147
    v_and_b32 v63, 0xffff0000, v147
    v_fmac_f32 v48, v210, v56
    v_fmac_f32 v49, v210, v57
    v_fmac_f32 v50, v210, v58
    v_fmac_f32 v51, v210, v59
    v_fmac_f32 v52, v210, v60
    v_fmac_f32 v53, v210, v61
    v_fmac_f32 v54, v210, v62
    v_fmac_f32 v55, v210, v63
    s_waitcnt vmcnt(13)
    v_lshlrev_b32 v56, 16, v148
    v_and_b32 v57, 0xffff0000, v148
    v_lshlrev_b32 v58, 16, v149
    v_and_b32 v59, 0xffff0000, v149
    v_lshlrev_b32 v60, 16, v150
    v_and_b32 v61, 0xffff0000, v150
    v_lshlrev_b32 v62, 16, v151
    v_and_b32 v63, 0xffff0000, v151
    v_fmac_f32 v48, v211, v56
    v_fmac_f32 v49, v211, v57
    v_fmac_f32 v50, v211, v58
    v_fmac_f32 v51, v211, v59
    v_fmac_f32 v52, v211, v60
    v_fmac_f32 v53, v211, v61
    v_fmac_f32 v54, v211, v62
    v_fmac_f32 v55, v211, v63
    s_waitcnt vmcnt(12)
    v_lshlrev_b32 v56, 16, v152
    v_and_b32 v57, 0xffff0000, v152
    v_lshlrev_b32 v58, 16, v153
    v_and_b32 v59, 0xffff0000, v153
    v_lshlrev_b32 v60, 16, v154
    v_and_b32 v61, 0xffff0000, v154
    v_lshlrev_b32 v62, 16, v155
    v_and_b32 v63, 0xffff0000, v155
    v_fmac_f32 v48, v212, v56
    v_fmac_f32 v49, v212, v57
    v_fmac_f32 v50, v212, v58
    v_fmac_f32 v51, v212, v59
    v_fmac_f32 v52, v212, v60
    v_fmac_f32 v53, v212, v61
    v_fmac_f32 v54, v212, v62
    v_fmac_f32 v55, v212, v63
    s_waitcnt vmcnt(11)
    v_lshlrev_b32 v56, 16, v156
    v_and_b32 v57, 0xffff0000, v156
    v_lshlrev_b32 v58, 16, v157
    v_and_b32 v59, 0xffff0000, v157
    v_lshlrev_b32 v60, 16, v158
    v_and_b32 v61, 0xffff0000, v158
    v_lshlrev_b32 v62, 16, v159
    v_and_b32 v63, 0xffff0000, v159
    v_fmac_f32 v48, v213, v56
    v_fmac_f32 v49, v213, v57
    v_fmac_f32 v50, v213, v58
    v_fmac_f32 v51, v213, v59
    v_fmac_f32 v52, v213, v60
    v_fmac_f32 v53, v213, v61
    v_fmac_f32 v54, v213, v62
    v_fmac_f32 v55, v213, v63
    s_waitcnt vmcnt(10)
    v_lshlrev_b32 v56, 16, v160
    v_and_b32 v57, 0xffff0000, v160
    v_lshlrev_b32 v58, 16, v161
    v_and_b32 v59, 0xffff0000, v161
    v_lshlrev_b32 v60, 16, v162
    v_and_b32 v61, 0xffff0000, v162
    v_lshlrev_b32 v62, 16, v163
    v_and_b32 v63, 0xffff0000, v163
    v_fmac_f32 v48, v214, v56
    v_fmac_f32 v49, v214, v57
    v_fmac_f32 v50, v214, v58
    v_fmac_f32 v51, v214, v59
    v_fmac_f32 v52, v214, v60
    v_fmac_f32 v53, v214, v61
    v_fmac_f32 v54, v214, v62
    v_fmac_f32 v55, v214, v63
    s_waitcnt vmcnt(9)
    v_lshlrev_b32 v56, 16, v164
    v_and_b32 v57, 0xffff0000, v164
    v_lshlrev_b32 v58, 16, v165
    v_and_b32 v59, 0xffff0000, v165
    v_lshlrev_b32 v60, 16, v166
    v_and_b32 v61, 0xffff0000, v166
    v_lshlrev_b32 v62, 16, v167
    v_and_b32 v63, 0xffff0000, v167
    v_fmac_f32 v48, v215, v56
    v_fmac_f32 v49, v215, v57
    v_fmac_f32 v50, v215, v58
    v_fmac_f32 v51, v215, v59
    v_fmac_f32 v52, v215, v60
    v_fmac_f32 v53, v215, v61
    v_fmac_f32 v54, v215, v62
    v_fmac_f32 v55, v215, v63
    s_waitcnt vmcnt(8)
    v_lshlrev_b32 v56, 16, v168
    v_and_b32 v57, 0xffff0000, v168
    v_lshlrev_b32 v58, 16, v169
    v_and_b32 v59, 0xffff0000, v169
    v_lshlrev_b32 v60, 16, v170
    v_and_b32 v61, 0xffff0000, v170
    v_lshlrev_b32 v62, 16, v171
    v_and_b32 v63, 0xffff0000, v171
    v_fmac_f32 v48, v216, v56
    v_fmac_f32 v49, v216, v57
    v_fmac_f32 v50, v216, v58
    v_fmac_f32 v51, v216, v59
    v_fmac_f32 v52, v216, v60
    v_fmac_f32 v53, v216, v61
    v_fmac_f32 v54, v216, v62
    v_fmac_f32 v55, v216, v63
    s_waitcnt vmcnt(7)
    v_lshlrev_b32 v56, 16, v172
    v_and_b32 v57, 0xffff0000, v172
    v_lshlrev_b32 v58, 16, v173
    v_and_b32 v59, 0xffff0000, v173
    v_lshlrev_b32 v60, 16, v174
    v_and_b32 v61, 0xffff0000, v174
    v_lshlrev_b32 v62, 16, v175
    v_and_b32 v63, 0xffff0000, v175
    v_fmac_f32 v48, v217, v56
    v_fmac_f32 v49, v217, v57
    v_fmac_f32 v50, v217, v58
    v_fmac_f32 v51, v217, v59
    v_fmac_f32 v52, v217, v60
    v_fmac_f32 v53, v217, v61
    v_fmac_f32 v54, v217, v62
    v_fmac_f32 v55, v217, v63
    s_waitcnt vmcnt(6)
    v_lshlrev_b32 v56, 16, v176
    v_and_b32 v57, 0xffff0000, v176
    v_lshlrev_b32 v58, 16, v177
    v_and_b32 v59, 0xffff0000, v177
    v_lshlrev_b32 v60, 16, v178
    v_and_b32 v61, 0xffff0000, v178
    v_lshlrev_b32 v62, 16, v179
    v_and_b32 v63, 0xffff0000, v179
    v_fmac_f32 v48, v218, v56
    v_fmac_f32 v49, v218, v57
    v_fmac_f32 v50, v218, v58
    v_fmac_f32 v51, v218, v59
    v_fmac_f32 v52, v218, v60
    v_fmac_f32 v53, v218, v61
    v_fmac_f32 v54, v218, v62
    v_fmac_f32 v55, v218, v63
    s_waitcnt vmcnt(5)
    v_lshlrev_b32 v56, 16, v180
    v_and_b32 v57, 0xffff0000, v180
    v_lshlrev_b32 v58, 16, v181
    v_and_b32 v59, 0xffff0000, v181
    v_lshlrev_b32 v60, 16, v182
    v_and_b32 v61, 0xffff0000, v182
    v_lshlrev_b32 v62, 16, v183
    v_and_b32 v63, 0xffff0000, v183
    v_fmac_f32 v48, v219, v56
    v_fmac_f32 v49, v219, v57
    v_fmac_f32 v50, v219, v58
    v_fmac_f32 v51, v219, v59
    v_fmac_f32 v52, v219, v60
    v_fmac_f32 v53, v219, v61
    v_fmac_f32 v54, v219, v62
    v_fmac_f32 v55, v219, v63
    ds_write_b128 v241, v[48:51] offset:8704
    ds_write_b128 v241, v[52:55] offset:8720
    s_waitcnt lgkmcnt(0)
    s_barrier
    ds_read_b32 v36, v242 offset:8704
    ds_read_b32 v37, v242 offset:9792
    ds_read_b32 v38, v242 offset:10880
    ds_read_b32 v39, v242 offset:11968
    ds_read_b32 v40, v242 offset:13056
    ds_read_b32 v41, v242 offset:14144
    ds_read_b32 v42, v242 offset:15232
    ds_read_b32 v43, v242 offset:16320
    s_waitcnt lgkmcnt(0)
    v_add_f32 v36, v36, v40
    v_add_f32 v37, v37, v41
    v_add_f32 v38, v38, v42
    v_add_f32 v39, v39, v43
    v_add_f32 v36, v36, v38
    v_add_f32 v37, v37, v39
    v_add_f32 v36, v36, v37
    v_mov_b32 v37, s64
    s_nop 0
    v_add_f32_dpp v36, v36, v36 quad_perm:[1,0,3,2] row_mask:0xf bank_mask:0xf
    s_nop 1
    v_add_f32_dpp v36, v36, v36 quad_perm:[2,3,0,1] row_mask:0xf bank_mask:0xf
    s_mov_b32 exec_lo, 0x11111111
    s_mov_b32 exec_hi, 0x11111111
    buffer_store_dwordx2 v[36:37], v244, s[24:27], s42 offen sc1
    s_mov_b64 exec, -1
    s_mov_b32 s32, s48
    s_mov_b32 s33, s49
    s_mov_b32 s34, 0x21c000
    s_mov_b32 s35, 0x20000
    s_mul_i32 s38, s22, 245760
    s_lshl_b32 s40, s21, 7
    s_add_u32 s38, s38, s40
    s_mul_i32 s40, s3, 10240
    s_add_u32 s38, s38, s40
    s_lshl_b32 s23, s3, 10
    s_add_u32 s23, s23, 107520
    v_lshrrev_b32 v247, 4, v2
    v_lshlrev_b32 v246, 10, v247
    v_bfe_u32 v248, v2, 2, 2
    v_lshl_add_u32 v246, v248, 7, v246
    v_lshl_add_u32 v246, v1, 5, v246
    v_and_b32 v248, 3, v2
    v_lshl_add_u32 v248, v248, 3, v246
    v_add_u32 v248, 107520, v248
    v_lshlrev_b32 v249, 4, v2
    s_mov_b32 m0, s23
    s_add_u32 s23, s23, 4096
    buffer_load_dwordx4 v9, s[32:35], s38 offen lds
    s_add_u32 s38, s38, 40960
    s_mov_b32 m0, s23
    s_add_u32 s23, s23, 4096
    buffer_load_dwordx4 v9, s[32:35], s38 offen lds
    s_add_u32 s38, s38, 40960
    s_mov_b32 m0, s23
    s_add_u32 s23, s23, 4096
    buffer_load_dwordx4 v9, s[32:35], s38 offen lds
    s_add_u32 s38, s38, 40960
    s_mov_b32 m0, s23
    s_add_u32 s23, s23, 4096
    buffer_load_dwordx4 v9, s[32:35], s38 offen lds
    s_add_u32 s38, s38, 40960
    s_mov_b32 m0, s23
    s_add_u32 s23, s23, 4096
    buffer_load_dwordx4 v9, s[32:35], s38 offen lds
    s_add_u32 s38, s38, 40960
    s_mov_b32 m0, s23
    s_add_u32 s23, s23, 4096
    buffer_load_dwordx4 v9, s[32:35], s38 offen lds
    s_add_u32 s41, s41, 5120
    s_mov_b32 s44, s48
    s_mov_b32 s45, s49
    s_mov_b32 s46, 0x21c000
    s_mov_b32 s47, 0x20000
    s_and_b32 s66, s2, 1
    s_lshl_b32 s66, s66, 2
    s_lshr_b32 s14, s2, 6
    s_add_u32 s66, s66, s14
    s_mul_i32 s66, s66, 160
    s_mul_i32 s14, s3, 14
    s_lshr_b32 s15, s3, 1
    s_sub_u32 s14, s14, s15
    s_mul_i32 s14, s14, 40960
    s_add_u32 s14, s14, s66
    s_mul_i32 s15, s3, 15360
    s_add_u32 s15, s15, 0
    v_add_u32 v239, 0, v2
    v_mul_u32_u24 v234, 205, v239
    v_lshrrev_b32 v234, 11, v234
    v_mul_u32_u24 v234, 1120, v234
    v_lshl_add_u32 v234, v2, 4, v234
    v_add_u32 v239, 64, v2
    v_mul_u32_u24 v235, 205, v239
    v_lshrrev_b32 v235, 11, v235
    v_mul_u32_u24 v235, 1120, v235
    v_lshl_add_u32 v235, v2, 4, v235
    v_add_u32 v239, 128, v2
    v_mul_u32_u24 v236, 205, v239
    v_lshrrev_b32 v236, 11, v236
    v_mul_u32_u24 v236, 1120, v236
    v_lshl_add_u32 v236, v2, 4, v236
    v_add_u32 v239, 192, v2
    v_mul_u32_u24 v237, 205, v239
    v_lshrrev_b32 v237, 11, v237
    v_mul_u32_u24 v237, 1120, v237
    v_lshl_add_u32 v237, v2, 4, v237
    v_add_u32 v239, 256, v2
    v_mul_u32_u24 v238, 205, v239
    v_lshrrev_b32 v238, 11, v238
    v_mul_u32_u24 v238, 1120, v238
    v_lshl_add_u32 v238, v239, 4, v238
    v_lshrrev_b32 v239, 4, v2
    v_mul_u32_u24 v239, 640, v239
    v_add_u32 v239, s15, v239
    v_lshrrev_b32 v240, 2, v2
    v_mul_u32_u24 v240, 160, v240
    v_add_u32 v239, v239, v240
    v_and_b32 v240, 3, v2
    v_lshl_add_u32 v239, v240, 3, v239
    s_add_u32 m0, s15, 0
    s_nop 0
    buffer_load_dwordx4 v234, s[44:47], s14 offen offset:0 lds
    buffer_load_dwordx4 v235, s[44:47], s14 offen offset:1024 lds
    buffer_load_dwordx4 v236, s[44:47], s14 offen offset:2048 lds
    buffer_load_dwordx4 v237, s[44:47], s14 offen offset:3072 lds
    s_add_u32 m0, s15, 4096
    s_nop 0
    buffer_load_dwordx4 v238, s[44:47], s14 offen offset:0 lds
    s_add_u32 m0, s15, 5120
    s_add_u32 s14, s14, 40960
    s_nop 0
    buffer_load_dwordx4 v234, s[44:47], s14 offen offset:0 lds
    buffer_load_dwordx4 v235, s[44:47], s14 offen offset:1024 lds
    buffer_load_dwordx4 v236, s[44:47], s14 offen offset:2048 lds
    buffer_load_dwordx4 v237, s[44:47], s14 offen offset:3072 lds
    s_add_u32 m0, s15, 9216
    s_nop 0
    buffer_load_dwordx4 v238, s[44:47], s14 offen offset:0 lds
    s_add_u32 m0, s15, 10240
    s_add_u32 s14, s14, 40960
    s_nop 0
    buffer_load_dwordx4 v234, s[44:47], s14 offen offset:0 lds
    buffer_load_dwordx4 v235, s[44:47], s14 offen offset:1024 lds
    buffer_load_dwordx4 v236, s[44:47], s14 offen offset:2048 lds
    buffer_load_dwordx4 v237, s[44:47], s14 offen offset:3072 lds
    s_add_u32 m0, s15, 14336
    s_nop 0
    buffer_load_dwordx4 v238, s[44:47], s14 offen offset:0 lds
    s_waitcnt vmcnt(26)
    v_lshlrev_b32 v56, 16, v84
    v_and_b32 v57, 0xffff0000, v84
    v_lshlrev_b32 v58, 16, v85
    v_and_b32 v59, 0xffff0000, v85
    v_lshlrev_b32 v60, 16, v86
    v_and_b32 v61, 0xffff0000, v86
    v_lshlrev_b32 v62, 16, v87
    v_and_b32 v63, 0xffff0000, v87
    v_mul_f32 v48, v20, v56
    v_mul_f32 v49, v20, v57
    v_mul_f32 v50, v20, v58
    v_mul_f32 v51, v20, v59
    v_mul_f32 v52, v20, v60
    v_mul_f32 v53, v20, v61
    v_mul_f32 v54, v20, v62
    v_mul_f32 v55, v20, v63
    s_waitcnt vmcnt(25)
    v_lshlrev_b32 v56, 16, v88
    v_and_b32 v57, 0xffff0000, v88
    v_lshlrev_b32 v58, 16, v89
    v_and_b32 v59, 0xffff0000, v89
    v_lshlrev_b32 v60, 16, v90
    v_and_b32 v61, 0xffff0000, v90
    v_lshlrev_b32 v62, 16, v91
    v_and_b32 v63, 0xffff0000, v91
    v_fmac_f32 v48, v21, v56
    v_fmac_f32 v49, v21, v57
    v_fmac_f32 v50, v21, v58
    v_fmac_f32 v51, v21, v59
    v_fmac_f32 v52, v21, v60
    v_fmac_f32 v53, v21, v61
    v_fmac_f32 v54, v21, v62
    v_fmac_f32 v55, v21, v63
    s_waitcnt vmcnt(24)
    v_lshlrev_b32 v56, 16, v92
    v_and_b32 v57, 0xffff0000, v92
    v_lshlrev_b32 v58, 16, v93
    v_and_b32 v59, 0xffff0000, v93
    v_lshlrev_b32 v60, 16, v94
    v_and_b32 v61, 0xffff0000, v94
    v_lshlrev_b32 v62, 16, v95
    v_and_b32 v63, 0xffff0000, v95
    v_fmac_f32 v48, v22, v56
    v_fmac_f32 v49, v22, v57
    v_fmac_f32 v50, v22, v58
    v_fmac_f32 v51, v22, v59
    v_fmac_f32 v52, v22, v60
    v_fmac_f32 v53, v22, v61
    v_fmac_f32 v54, v22, v62
    v_fmac_f32 v55, v22, v63
    s_waitcnt vmcnt(23)
    v_lshlrev_b32 v56, 16, v96
    v_and_b32 v57, 0xffff0000, v96
    v_lshlrev_b32 v58, 16, v97
    v_and_b32 v59, 0xffff0000, v97
    v_lshlrev_b32 v60, 16, v98
    v_and_b32 v61, 0xffff0000, v98
    v_lshlrev_b32 v62, 16, v99
    v_and_b32 v63, 0xffff0000, v99
    v_fmac_f32 v48, v23, v56
    v_fmac_f32 v49, v23, v57
    v_fmac_f32 v50, v23, v58
    v_fmac_f32 v51, v23, v59
    v_fmac_f32 v52, v23, v60
    v_fmac_f32 v53, v23, v61
    v_fmac_f32 v54, v23, v62
    v_fmac_f32 v55, v23, v63
    s_waitcnt vmcnt(22)
    v_lshlrev_b32 v56, 16, v100
    v_and_b32 v57, 0xffff0000, v100
    v_lshlrev_b32 v58, 16, v101
    v_and_b32 v59, 0xffff0000, v101
    v_lshlrev_b32 v60, 16, v102
    v_and_b32 v61, 0xffff0000, v102
    v_lshlrev_b32 v62, 16, v103
    v_and_b32 v63, 0xffff0000, v103
    v_fmac_f32 v48, v24, v56
    v_fmac_f32 v49, v24, v57
    v_fmac_f32 v50, v24, v58
    v_fmac_f32 v51, v24, v59
    v_fmac_f32 v52, v24, v60
    v_fmac_f32 v53, v24, v61
    v_fmac_f32 v54, v24, v62
    v_fmac_f32 v55, v24, v63
    ds_write_b128 v241, v[48:51] offset:0
    ds_write_b128 v241, v[52:55] offset:16
    s_waitcnt lgkmcnt(0)
    s_barrier
    ds_read_b32 v36, v242 offset:0
    ds_read_b32 v37, v242 offset:1088
    ds_read_b32 v38, v242 offset:2176
    ds_read_b32 v39, v242 offset:3264
    ds_read_b32 v40, v242 offset:4352
    ds_read_b32 v41, v242 offset:5440
    ds_read_b32 v42, v242 offset:6528
    ds_read_b32 v43, v242 offset:7616
    s_waitcnt lgkmcnt(0)
    v_add_f32 v36, v36, v40
    v_add_f32 v37, v37, v41
    v_add_f32 v38, v38, v42
    v_add_f32 v39, v39, v43
    v_add_f32 v36, v36, v38
    v_add_f32 v37, v37, v39
    v_add_f32 v36, v36, v37
    v_mov_b32 v37, s64
    s_nop 0
    v_add_f32_dpp v36, v36, v36 quad_perm:[1,0,3,2] row_mask:0xf bank_mask:0xf
    s_nop 1
    v_add_f32_dpp v36, v36, v36 quad_perm:[2,3,0,1] row_mask:0xf bank_mask:0xf
    s_mov_b32 exec_lo, 0x11111111
    s_mov_b32 exec_hi, 0x11111111
    buffer_store_dwordx2 v[36:37], v244, s[24:27], s41 offen sc1
    s_mov_b64 exec, -1
    s_waitcnt vmcnt(16)
    s_barrier
L_w2:
    s_bfe_u32 s67, s2, 0x20001
    s_lshl_b32 s67, s67, 2
    s_bfe_u32 s66, s2, 0x20003
    s_add_u32 s67, s67, s66
    s_mul_i32 s67, s67, 27
    s_lshr_b32 s67, s67, 2
    v_and_b32 v88, 3, v2
    v_lshl_add_u32 v88, v88, 1, s67
    v_lshrrev_b32 v88, 2, v88
    v_bfe_u32 v89, v2, 2, 1
    v_mul_u32_u24 v89, 27, v89
    v_add_u32 v88, v88, v89
    v_add_u32 v88, 160, v88
    v_lshlrev_b32 v88, 7, v88
    buffer_load_dword v90, v88, s[56:59], 0 offen offset:4 sc1
    s_add_u32 s24, s16, 0xbb8000
    s_addc_u32 s25, s17, 0
    s_mov_b32 s26, 0x21c000
    s_mov_b32 s27, 0x20000
    s_lshl_b32 s20, s21, 2
    s_add_u32 s20, s20, s3
    s_mul_i32 s39, s20, 55296
    s_mul_i32 s40, s22, 6144
    s_add_u32 s39, s39, s40
    ds_read_b64_tr_b16 v[32:33], v248 offset:0
    ds_read_b64_tr_b16 v[34:35], v248 offset:512
    ds_read_b64_tr_b16 v[36:37], v248 offset:4096
    ds_read_b64_tr_b16 v[38:39], v248 offset:4608
    ds_read_b64_tr_b16 v[40:41], v248 offset:8192
    ds_read_b64_tr_b16 v[42:43], v248 offset:8704
    ds_read_b64_tr_b16 v[44:45], v248 offset:12288
    ds_read_b64_tr_b16 v[46:47], v248 offset:12800
    ds_read_b64_tr_b16 v[48:49], v248 offset:16384
    ds_read_b64_tr_b16 v[50:51], v248 offset:16896
    ds_read_b64_tr_b16 v[52:53], v248 offset:20480
    ds_read_b64_tr_b16 v[54:55], v248 offset:20992
    s_waitcnt lgkmcnt(10)
    buffer_store_dwordx4 v[32:35], v249, s[24:27], s39 offen offset:0 sc1
    s_waitcnt lgkmcnt(8)
    buffer_store_dwordx4 v[36:39], v249, s[24:27], s39 offen offset:1024 sc1
    s_waitcnt lgkmcnt(6)
    buffer_store_dwordx4 v[40:43], v249, s[24:27], s39 offen offset:2048 sc1
    s_waitcnt lgkmcnt(4)
    buffer_store_dwordx4 v[44:47], v249, s[24:27], s39 offen offset:3072 sc1
    s_add_u32 s39, s39, 4096
    s_waitcnt lgkmcnt(2)
    buffer_store_dwordx4 v[48:51], v249, s[24:27], s39 offen offset:0 sc1
    s_waitcnt lgkmcnt(0)
    buffer_store_dwordx4 v[52:55], v249, s[24:27], s39 offen offset:1024 sc1
    v_lshrrev_b32 v4, 4, v2
    s_add_u32 s60, s16, 0x1540000
    s_addc_u32 s61, s17, 0
    s_mov_b32 s62, 0x1e000
    s_mov_b32 s63, 0x20000
    s_add_u32 s28, s16, 0x149c000
    s_addc_u32 s29, s17, 0
    s_mov_b32 s30, 0x36000
    s_mov_b32 s31, 0x20000
    s_sub_u32 s6, s2, 160
    s_cmp_ge_u32 s6, 54
    s_cbranch_scc1 L_noext
    s_cmp_ge_u32 s6, 27
    s_cselect_b32 s6, 2560, 0
    v_min_u32 v232, 159, v0
    v_lshl_add_u32 v232, v232, 4, s6
    s_movk_i32 s6, 15360
    s_mov_b32 s66, 0x8000
    s_branch L_gf_22
L_gl_19:
    s_sleep 8
L_gf_22:
    buffer_load_dwordx4 v[128:131], v232, s[60:63], s6 offen sc1
L_gc_20:
    s_sub_u32 s66, s66, 1
    s_cmp_eq_u32 s66, 0
    s_waitcnt vmcnt(0)
    s_cbranch_scc1 L_gd_21
    v_cmp_ne_u32 vcc, s64, v129
    s_cbranch_vccnz L_gl_19
    v_cmp_ne_u32 vcc, s64, v131
    s_cbranch_vccnz L_gl_19
L_gd_21:
    v_cvt_pk_bf16_f32 v100, v128, v130
    v_lshlrev_b32 v101, 2, v0
    v_add_u32 v101, 143360, v101
    ds_write_b32 v101, v100
    v_lshlrev_b32 v101, 4, v4
    v_add_u32 v101, 143360, v101
    s_waitcnt lgkmcnt(0)
    s_barrier
    ds_read_b128 v[48:51], v101 offset:0
    ds_read_b128 v[52:55], v101 offset:64
    ds_read_b128 v[56:59], v101 offset:128
    ds_read_b128 v[60:63], v101 offset:192
    ds_read_b128 v[64:67], v101 offset:256
    ds_read_b128 v[68:71], v101 offset:320
    ds_read_b128 v[72:75], v101 offset:384
    ds_read_b128 v[76:79], v101 offset:448
    ds_read_b128 v[80:83], v101 offset:512
    ds_read_b128 v[84:87], v101 offset:576
    s_waitcnt lgkmcnt(9)
    v_mfma_f32_16x16x32_bf16 v[104:107], v[48:51], v[144:147], 0
    v_mfma_f32_16x16x32_bf16 v[108:111], v[48:51], v[148:151], 0
    s_waitcnt lgkmcnt(8)
    v_mfma_f32_16x16x32_bf16 v[104:107], v[52:55], v[152:155], v[104:107]
    v_mfma_f32_16x16x32_bf16 v[108:111], v[52:55], v[156:159], v[108:111]
    s_waitcnt lgkmcnt(7)
    v_mfma_f32_16x16x32_bf16 v[104:107], v[56:59], v[160:163], v[104:107]
    v_mfma_f32_16x16x32_bf16 v[108:111], v[56:59], v[164:167], v[108:111]
    s_waitcnt lgkmcnt(6)
    v_mfma_f32_16x16x32_bf16 v[104:107], v[60:63], v[168:171], v[104:107]
    v_mfma_f32_16x16x32_bf16 v[108:111], v[60:63], v[172:175], v[108:111]
    s_waitcnt lgkmcnt(5)
    v_mfma_f32_16x16x32_bf16 v[104:107], v[64:67], v[176:179], v[104:107]
    v_mfma_f32_16x16x32_bf16 v[108:111], v[64:67], v[180:183], v[108:111]
    s_waitcnt lgkmcnt(4)
    v_mfma_f32_16x16x32_bf16 v[104:107], v[68:71], v[184:187], v[104:107]
    v_mfma_f32_16x16x32_bf16 v[108:111], v[68:71], v[188:191], v[108:111]
    s_waitcnt lgkmcnt(3)
    v_mfma_f32_16x16x32_bf16 v[104:107], v[72:75], v[192:195], v[104:107]
    v_mfma_f32_16x16x32_bf16 v[108:111], v[72:75], v[196:199], v[108:111]
    s_waitcnt lgkmcnt(2)
    v_mfma_f32_16x16x32_bf16 v[104:107], v[76:79], v[200:203], v[104:107]
    v_mfma_f32_16x16x32_bf16 v[108:111], v[76:79], v[204:207], v[108:111]
    s_waitcnt lgkmcnt(1)
    v_mfma_f32_16x16x32_bf16 v[104:107], v[80:83], v[208:211], v[104:107]
    v_mfma_f32_16x16x32_bf16 v[108:111], v[80:83], v[212:215], v[108:111]
    s_waitcnt lgkmcnt(0)
    v_mfma_f32_16x16x32_bf16 v[104:107], v[84:87], v[216:219], v[104:107]
    v_mfma_f32_16x16x32_bf16 v[108:111], v[84:87], v[220:223], v[108:111]
    v_lshrrev_b32 v100, 5, v2
    v_lshlrev_b32 v100, 10, v100
    v_and_b32 v101, 31, v2
    v_lshl_add_u32 v100, v101, 4, v100
    v_cmp_le_u32 vcc, 32, v2
    s_nop 4
    v_cndmask_b32 v112, v224, v228, vcc
    v_cndmask_b32 v114, v104, v108, vcc
    v_cmp_gt_u32 vcc, 16, v101
    s_nop 1
    v_cndmask_b32 v112, 0, v112, vcc
    v_cndmask_b32 v114, 0, v114, vcc
    v_cvt_pk_bf16_f32 v116, v112, v112
    v_cvt_pk_bf16_f32 v118, v114, v114
    v_lshlrev_b32 v113, 16, v116
    v_lshlrev_b32 v115, 16, v118
    v_sub_f32 v112, v112, v113
    v_sub_f32 v114, v114, v115
    v_cvt_pk_bf16_f32 v117, v112, v112
    v_cvt_pk_bf16_f32 v119, v114, v114
    buffer_store_dwordx4 v[116:119], v100, s[28:31], s12 offen sc1
L_noext:
    s_waitcnt vmcnt(6) lgkmcnt(0)
    ds_read_b64_tr_b16 a[48:49], v239 offset:0
    ds_read_b64_tr_b16 a[50:51], v239 offset:640
    ds_read_b64_tr_b16 a[52:53], v239 offset:32
    ds_read_b64_tr_b16 a[54:55], v239 offset:672
    ds_read_b64_tr_b16 a[56:57], v239 offset:64
    ds_read_b64_tr_b16 a[58:59], v239 offset:704
    ds_read_b64_tr_b16 a[60:61], v239 offset:96
    ds_read_b64_tr_b16 a[62:63], v239 offset:736
    ds_read_b64_tr_b16 a[64:65], v239 offset:128
    ds_read_b64_tr_b16 a[66:67], v239 offset:768
    s_waitcnt vmcnt(6) lgkmcnt(0)
    ds_read_b64_tr_b16 a[68:69], v239 offset:5120
    ds_read_b64_tr_b16 a[70:71], v239 offset:5760
    ds_read_b64_tr_b16 a[72:73], v239 offset:5152
    ds_read_b64_tr_b16 a[74:75], v239 offset:5792
    ds_read_b64_tr_b16 a[76:77], v239 offset:5184
    ds_read_b64_tr_b16 a[78:79], v239 offset:5824
    ds_read_b64_tr_b16 a[80:81], v239 offset:5216
    ds_read_b64_tr_b16 a[82:83], v239 offset:5856
    ds_read_b64_tr_b16 a[84:85], v239 offset:5248
    ds_read_b64_tr_b16 a[86:87], v239 offset:5888
    s_waitcnt vmcnt(6) lgkmcnt(0)
    ds_read_b64_tr_b16 a[88:89], v239 offset:10240
    ds_read_b64_tr_b16 a[90:91], v239 offset:10880
    ds_read_b64_tr_b16 a[92:93], v239 offset:10272
    ds_read_b64_tr_b16 a[94:95], v239 offset:10912
    ds_read_b64_tr_b16 a[96:97], v239 offset:10304
    ds_read_b64_tr_b16 a[98:99], v239 offset:10944
    ds_read_b64_tr_b16 a[100:101], v239 offset:10336
    ds_read_b64_tr_b16 a[102:103], v239 offset:10976
    ds_read_b64_tr_b16 a[104:105], v239 offset:10368
    ds_read_b64_tr_b16 a[106:107], v239 offset:11008
    s_waitcnt lgkmcnt(0)
    s_mov_b64 s[68:69], -1
    s_waitcnt vmcnt(6)
    s_barrier
L_g1:
    s_mov_b64 s[0:1], s[44:45]
    s_and_b32 s4, s2, 1
    s_lshl_b32 s4, s4, 3
    s_lshr_b32 s5, s2, 5
    s_add_u32 s4, s4, s5
    s_bfe_u32 s5, s2, 0x20001
    s_lshl_b32 s5, s5, 2
    s_bfe_u32 s6, s2, 0x20003
    s_add_u32 s5, s5, s6
    s_cmp_ge_u32 s5, 10
    s_cselect_b32 s7, 10, 0
    s_sub_u32 s7, s5, s7
    s_and_b32 s67, s5, 7
    s_mul_i32 s5, s5, 27
    s_lshr_b32 s5, s5, 2
    s_mov_b32 s8, 0
    s_lshl_b32 s9, s3, 10
    s_mov_b32 s10, 0
    s_and_b32 s14, s5, 1
    s_add_u32 s13, s5, s14
    s_lshl_b32 s13, s13, 9
    s_xor_b32 s15, s14, 1
    s_mul_i32 s15, s15, 6
    s_add_u32 s6, s5, s15
    s_lshl_b32 s6, s6, 9
    s_lshr_b32 s67, 0x21, s67
    s_and_b32 s67, s67, 1
    s_cselect_b32 s67, 0x40000000, s6
    s_add_u32 s24, s16, 0x780000
    s_addc_u32 s25, s17, 0
    s_mov_b32 s26, 0x438000
    s_mov_b32 s27, 0x20000
    s_add_u32 s6, s5, s14
    s_mul_i32 s6, s6, 40960
    v_lshl_add_u32 v7, v0, 4, s6
    v_add_u32 v8, 40960, v7
    v_add_u32 v9, 81920, v7
    v_add_u32 v10, 122880, v7
    v_add_u32 v11, 163840, v7
    v_add_u32 v12, 204800, v7
    s_add_u32 s6, s5, s15
    s_mul_i32 s6, s6, 40960
    s_and_b32 s11, s67, 0x40000000
    s_add_u32 s6, s6, s11
    v_lshl_add_u32 v13, v0, 4, s6
    v_cmp_ne_u32 vcc, s64, v90
    s_mov_b64 s[42:43], vcc
    s_cbranch_vccnz L_w1no
    s_add_u32 m0, s9, 57344
    s_nop 0
    buffer_load_dwordx4 v7, s[24:27], s8 offen sc1 lds
    s_add_u32 m0, s9, 61440
    s_nop 0
    buffer_load_dwordx4 v8, s[24:27], s8 offen sc1 lds
    s_add_u32 m0, s9, 65536
    s_nop 0
    buffer_load_dwordx4 v9, s[24:27], s8 offen sc1 lds
    s_add_u32 m0, s9, 69632
    s_nop 0
    buffer_load_dwordx4 v10, s[24:27], s8 offen sc1 lds
    s_add_u32 m0, s9, 73728
    s_nop 0
    buffer_load_dwordx4 v11, s[24:27], s8 offen sc1 lds
    s_add_u32 m0, s9, 77824
    s_nop 0
    buffer_load_dwordx4 v12, s[24:27], s8 offen sc1 lds
    s_add_u32 m0, s9, 81920
    s_nop 0
    buffer_load_dwordx4 v13, s[24:27], s8 offen sc1 lds
    s_add_u32 m0, s9, 86016
    s_add_u32 s8, s8, 4096
    buffer_load_dwordx4 v7, s[24:27], s8 offen sc1 lds
    s_add_u32 m0, s9, 90112
    s_nop 0
    buffer_load_dwordx4 v8, s[24:27], s8 offen sc1 lds
    s_add_u32 m0, s9, 94208
    s_nop 0
    buffer_load_dwordx4 v9, s[24:27], s8 offen sc1 lds
    s_waitcnt vmcnt(10)
    s_branch L_w1sig
L_w1no:
    s_waitcnt vmcnt(0)
L_w1sig:
    s_barrier
    s_cmp_lg_u32 s3, 0
    s_cbranch_scc1 L_sig_23
    v_mov_b32 v246, s64
    v_mov_b32 v247, 0
    s_mov_b64 exec, 1
    buffer_store_dword v246, v247, s[56:59], s65 offen offset:8 sc1
    s_mov_b64 exec, -1
L_sig_23:
    s_cmp_eq_u64 s[42:43], 0
    s_cbranch_scc1 L_w1ok
    s_mov_b32 s66, 0x8000
    s_branch L_pfst_27
L_poll_24:
    s_sleep 2
L_pfst_27:
    buffer_load_dword v90, v88, s[56:59], 0 offen offset:4 sc1
L_pchk_25:
    s_sub_u32 s66, s66, 1
    s_cmp_eq_u32 s66, 0
    s_waitcnt vmcnt(0)
    s_cbranch_scc1 L_pdone_26
    v_cmp_ne_u32 vcc, s64, v90
    s_cbranch_vccnz L_poll_24
L_pdone_26:
    s_add_u32 m0, s9, 57344
    s_nop 0
    buffer_load_dwordx4 v7, s[24:27], s8 offen sc1 lds
    s_add_u32 m0, s9, 61440
    s_nop 0
    buffer_load_dwordx4 v8, s[24:27], s8 offen sc1 lds
    s_add_u32 m0, s9, 65536
    s_nop 0
    buffer_load_dwordx4 v9, s[24:27], s8 offen sc1 lds
    s_add_u32 m0, s9, 69632
    s_nop 0
    buffer_load_dwordx4 v10, s[24:27], s8 offen sc1 lds
    s_add_u32 m0, s9, 73728
    s_nop 0
    buffer_load_dwordx4 v11, s[24:27], s8 offen sc1 lds
    s_add_u32 m0, s9, 77824
    s_nop 0
    buffer_load_dwordx4 v12, s[24:27], s8 offen sc1 lds
    s_add_u32 m0, s9, 81920
    s_nop 0
    buffer_load_dwordx4 v13, s[24:27], s8 offen sc1 lds
    s_add_u32 m0, s9, 86016
    s_add_u32 s8, s8, 4096
    buffer_load_dwordx4 v7, s[24:27], s8 offen sc1 lds
    s_add_u32 m0, s9, 90112
    s_nop 0
    buffer_load_dwordx4 v8, s[24:27], s8 offen sc1 lds
    s_add_u32 m0, s9, 94208
    s_nop 0
    buffer_load_dwordx4 v9, s[24:27], s8 offen sc1 lds
L_w1ok:
    s_add_u32 m0, s9, 98304
    s_bfe_u32 s44, s2, 0x20001
    s_lshl_b32 s44, s44, 3
    s_bfe_u32 s45, s2, 0x30003
    s_add_u32 s44, s44, s45
    buffer_load_dwordx4 v10, s[24:27], s8 offen sc1 lds
    s_add_u32 m0, s9, 102400
    s_and_b32 s45, s2, 1
    s_lshl_b32 s45, s45, 2
    s_lshr_b32 s46, s2, 6
    s_add_u32 s45, s45, s46
    buffer_load_dwordx4 v11, s[24:27], s8 offen sc1 lds
    s_add_u32 m0, s9, 106496
    s_mul_i32 s46, s3, 14
    s_lshr_b32 s47, s3, 1
    s_sub_u32 s46, s46, s47
    s_lshl_b32 s46, s46, 10
    buffer_load_dwordx4 v12, s[24:27], s8 offen sc1 lds
    s_add_u32 m0, s9, 110592
    s_mul_i32 s47, s45, 276480
    s_add_u32 s47, s47, s46
    s_add_u32 s48, s47, 55296
    s_add_u32 s49, s48, 55296
    buffer_load_dwordx4 v13, s[24:27], s8 offen sc1 lds
    s_add_u32 m0, s9, 114688
    s_add_u32 s8, s8, 4096
    buffer_load_dwordx4 v7, s[24:27], s8 offen sc1 lds
    s_add_u32 m0, s9, 118784
    s_add_u32 s50, s49, 55296
    s_add_u32 s51, s50, 55296
    s_mul_i32 s52, s44, 221184
    s_add_u32 s46, s46, s52
    buffer_load_dwordx4 v8, s[24:27], s8 offen sc1 lds
    s_add_u32 m0, s9, 122880
    s_mul_i32 s42, s45, 640
    s_add_u32 s42, s42, 25600
    v_min_u32 v40, 79, v0
    v_lshlrev_b32 v41, 3, v40
    buffer_load_dwordx4 v9, s[24:27], s8 offen sc1 lds
    s_add_u32 m0, s9, 126976
    v_lshlrev_b32 v40, 2, v40
    v_add_u32 v40, 159744, v40
    s_add_u32 s20, s16, 0x500000
    s_addc_u32 s21, s17, 0
    s_mov_b32 s22, 0x280000
    s_mov_b32 s23, 0x20000
    s_add_u32 s32, s16, 0xdd4000
    s_addc_u32 s33, s17, 0
    s_mov_b32 s34, 0x6c0000
    s_mov_b32 s35, 0x20000
    buffer_load_dwordx4 v10, s[24:27], s8 offen sc1 lds
    s_add_u32 m0, s9, 131072
    s_add_u32 s52, s16, 0xbb8000
    s_addc_u32 s53, s17, 0
    s_mov_b32 s54, 0x21c000
    s_mov_b32 s55, 0x20000
    s_add_u32 s60, s16, 0x1540000
    s_addc_u32 s61, s17, 0
    s_mov_b32 s62, 0x1e000
    s_mov_b32 s63, 0x20000
    s_add_u32 s28, s16, 0x149c000
    s_addc_u32 s29, s17, 0
    s_mov_b32 s30, 0x36000
    s_mov_b32 s31, 0x20000
    v_and_b32 v3, 15, v2
    buffer_load_dwordx4 v11, s[24:27], s8 offen sc1 lds
    s_add_u32 m0, s9, 135168
    v_lshrrev_b32 v4, 4, v2
    s_lshl_b32 s6, s4, 10
    v_lshl_add_u32 v5, v1, 8, s6
    v_lshl_add_u32 v5, v3, 4, v5
    buffer_load_dwordx4 v12, s[24:27], s8 offen sc1 lds
    s_add_u32 m0, s9, 139264
    v_lshl_add_u32 v5, v4, 15, v5
    v_add_u32 v6, 16384, v5
    s_lshl_b32 s6, s4, 3
    v_lshl_add_u32 v14, v1, 1, s6
    buffer_load_dwordx4 v13, s[24:27], s8 offen sc1 lds
    s_add_u32 m0, s9, 0
    s_add_u32 s8, s8, 4096
    buffer_load_dwordx4 v7, s[24:27], s8 offen sc1 lds
    s_add_u32 m0, s9, 4096
    v_lshrrev_b32 v15, 5, v2
    v_add_u32 v14, v14, v15
    v_mul_u32_u24 v14, 55296, v14
    v_and_b32 v15, 31, v2
    v_lshl_add_u32 v14, v15, 4, v14
    buffer_load_dwordx4 v8, s[24:27], s8 offen sc1 lds
    s_add_u32 m0, s9, 8192
    v_lshlrev_b32 v15, 4, v2
    v_add_u32 v16, 57344, v15
    v_add_u32 v17, 114688, v15
    s_lshl_b32 s14, s14, 11
    buffer_load_dwordx4 v9, s[24:27], s8 offen sc1 lds
    s_add_u32 m0, s9, 12288
    s_lshl_b32 s15, s15, 11
    v_add_u32 v46, s14, v17
    v_add_u32 v47, s15, v17
    v_mov_b32 v20, 0x3f803f80
    buffer_load_dwordx4 v10, s[24:27], s8 offen sc1 lds
    s_add_u32 m0, s9, 16384
    v_mov_b32 v21, v20
    v_mov_b32 v22, v20
    v_mov_b32 v23, v20
    v_lshlrev_b32 v35, 4, v0
    buffer_load_dwordx4 v11, s[24:27], s8 offen sc1 lds
    s_add_u32 m0, s9, 20480
    v_lshrrev_b32 v36, 2, v3
    v_cmp_eq_u32 s[68:69], v36, v4
    s_mul_i32 s6, s4, 20480
    v_lshl_add_u32 v36, v1, 9, s6
    buffer_load_dwordx4 v12, s[24:27], s8 offen sc1 lds
    s_add_u32 m0, s9, 24576
    v_lshl_add_u32 v36, v3, 5, v36
    v_lshl_add_u32 v44, v4, 11, v36
    v_and_b32 v45, 1, v4
    v_lshl_add_u32 v45, v45, 11, v36
    buffer_load_dwordx4 v13, s[24:27], s8 offen sc1 lds
    s_add_u32 m0, s9, 28672
    s_add_u32 s8, s8, 4096
    buffer_load_dwordx4 v7, s[24:27], s8 offen sc1 lds
    s_add_u32 m0, s9, 32768
    v_mov_b32 v34, 0x40000000
    v_cndmask_b32 v36, v34, v36, s[68:69]
    s_lshl_b32 s43, s7, 18
    s_lshl_b32 s7, s7, 11
    buffer_load_dwordx4 v8, s[24:27], s8 offen sc1 lds
    s_add_u32 m0, s9, 36864
    v_and_b32 v37, 3, v2
    v_cmp_eq_u32 s[36:37], 1, v37
    v_cmp_eq_u32 s[38:39], 2, v37
    v_cmp_eq_u32 s[40:41], 3, v37
    buffer_load_dwordx4 v9, s[24:27], s8 offen sc1 lds
    s_add_u32 m0, s9, 40960
    v_add_u32 v37, 4096, v15
    v_add_u32 v38, 8192, v15
    v_add_u32 v39, 12288, v15
    v_cmp_gt_u32 vcc, 160, v0
    buffer_load_dwordx4 v10, s[24:27], s8 offen sc1 lds
    s_add_u32 m0, s9, 45056
    v_lshlrev_b32 v244, 7, v0
    s_mov_b32 s6, 8
    v_add_u32 v245, s6, v244
    v_cndmask_b32 v244, v244, v245, vcc
    buffer_load_dwordx4 v11, s[24:27], s8 offen sc1 lds
    s_add_u32 m0, s9, 49152
    v_lshrrev_b32 v33, 1, v2
    v_min_u32 v33, 12, v33
    v_cmp_le_u32 vcc, 9, v33
    v_mul_u32_u24 v33, 10, v33
    buffer_load_dwordx4 v12, s[24:27], s8 offen sc1 lds
    s_add_u32 m0, s9, 53248
    v_subrev_u32 v32, 36, v33
    v_cndmask_b32 v33, v33, v32, vcc
    v_and_b32 v32, 1, v2
    v_add_u32 v33, v33, v32
    buffer_load_dwordx4 v13, s[24:27], s8 offen sc1 lds
    s_mul_i32 s6, s45, 5
    s_lshr_b32 s6, s6, 2
    s_add_u32 s6, s6, 160
    v_cmp_le_u32 vcc, 32, v2
    v_add_u32 v33, s6, v33
    v_lshlrev_b32 v33, 7, v33
    v_add_u32 v88, 0, v88
    v_cndmask_b32 v33, v33, v88, vcc
    s_mov_b32 s66, 0x8000
L_xp:
    buffer_load_dword v246, v244, s[56:59], 0 offen sc1
    s_sub_u32 s66, s66, 1
    s_cmp_eq_u32 s66, 0
    s_waitcnt vmcnt(0)
    s_cbranch_scc1 L_xpd
    v_cmp_ne_u32 vcc, s64, v246
    s_cbranch_vccz L_xpd
    s_mov_b64 exec, vcc
    s_sleep 2
    s_branch L_xp
L_xpd:
    s_mov_b64 exec, -1
    s_barrier
    s_or_b32 s6, s2, s3
    s_cmp_lg_u32 s6, 0
    s_cbranch_scc1 L_noepoch
    v_mov_b32 v246, s64
    v_mov_b32 v247, 32768
    s_mov_b64 exec, 1
    buffer_store_dword v246, v247, s[56:59], 0 offen sc1
    s_mov_b64 exec, -1
L_noepoch:
    buffer_load_dwordx4 v[48:51], v5, s[20:23], s10 offen sc1
    buffer_load_dwordx4 v[52:55], v6, s[20:23], s10 offen sc1
    s_add_u32 s10, s10, 131072
    buffer_load_dwordx4 v[56:59], v5, s[20:23], s10 offen sc1
    buffer_load_dwordx4 v[60:63], v6, s[20:23], s10 offen sc1
    s_add_u32 s10, s10, 131072
    buffer_load_dwordx4 v[64:67], v5, s[20:23], s10 offen sc1
    buffer_load_dwordx4 v[68:71], v6, s[20:23], s10 offen sc1
    s_add_u32 s10, s10, 131072
    buffer_load_dwordx4 v[72:75], v5, s[20:23], s10 offen sc1
    buffer_load_dwordx4 v[76:79], v6, s[20:23], s10 offen sc1
    s_add_u32 s10, s10, 131072
    buffer_load_dwordx4 v[80:83], v5, s[20:23], s10 offen sc1
    buffer_load_dwordx4 v[84:87], v6, s[20:23], s10 offen sc1
    ds_read_b128 a[0:3], v16 offset:0
    ds_read_b128 a[4:7], v16 offset:1024
    ds_read_b128 a[8:11], v16 offset:4096
    ds_read_b128 a[12:15], v16 offset:5120
    ds_read_b128 a[16:19], v16 offset:8192
    ds_read_b128 a[20:23], v16 offset:9216
    ds_read_b128 a[24:27], v16 offset:12288
    ds_read_b128 a[28:31], v16 offset:13312
    s_waitcnt vmcnt(8)
    v_swap_b32 v50, v52
    v_swap_b32 v51, v53
    s_nop 1
    s_waitcnt lgkmcnt(4)
    v_mfma_f32_16x16x32_bf16 v[128:131], a[0:3], v[48:51], 0
    ds_read_b128 a[32:35], v16 offset:16384
    s_add_u32 s10, s10, 131072
    v_mfma_f32_16x16x32_bf16 v[132:135], a[0:3], v[52:55], 0
    buffer_load_dwordx4 v[88:91], v5, s[20:23], s10 offen sc1
    v_mfma_f32_16x16x32_bf16 v[140:143], a[4:7], v[52:55], 0
    ds_read_b128 a[36:39], v16 offset:17408
    v_mfma_f32_16x16x32_bf16 v[136:139], a[4:7], v[48:51], 0
    v_mfma_f32_16x16x32_bf16 v[144:147], a[8:11], v[48:51], 0
    ds_read_b128 a[40:43], v16 offset:20480
    v_mfma_f32_16x16x32_bf16 v[148:151], a[8:11], v[52:55], 0
    buffer_load_dwordx4 v[92:95], v6, s[20:23], s10 offen sc1
    v_mfma_f32_16x16x32_bf16 v[156:159], a[12:15], v[52:55], 0
    ds_read_b128 a[44:47], v16 offset:21504
    v_mfma_f32_16x16x32_bf16 v[152:155], a[12:15], v[48:51], 0
    s_waitcnt lgkmcnt(4)
    v_mfma_f32_16x16x32_bf16 v[160:163], a[16:19], v[48:51], 0
    ds_read_b128 a[0:3], v16 offset:24576
    v_mfma_f32_16x16x32_bf16 v[164:167], a[16:19], v[52:55], 0
    buffer_load_dword v32, v33, s[56:59], 0 offen offset:8 sc1
    v_mfma_f32_16x16x32_bf16 v[172:175], a[20:23], v[52:55], 0
    ds_read_b128 a[4:7], v16 offset:25600
    v_mfma_f32_16x16x32_bf16 v[168:171], a[20:23], v[48:51], 0
    v_mfma_f32_16x16x32_bf16 v[176:179], a[24:27], v[48:51], 0
    ds_read_b128 a[8:11], v16 offset:2048
    s_add_u32 s10, s10, 131072
    v_mfma_f32_16x16x32_bf16 v[180:183], a[24:27], v[52:55], 0
    buffer_load_dwordx4 v[96:99], v5, s[20:23], s10 offen sc1
    v_mfma_f32_16x16x32_bf16 v[188:191], a[28:31], v[52:55], 0
    ds_read_b128 a[12:15], v16 offset:3072
    v_mfma_f32_16x16x32_bf16 v[184:187], a[28:31], v[48:51], 0
    s_waitcnt lgkmcnt(4)
    v_mfma_f32_16x16x32_bf16 v[192:195], a[32:35], v[48:51], 0
    ds_read_b128 a[16:19], v16 offset:6144
    v_mfma_f32_16x16x32_bf16 v[196:199], a[32:35], v[52:55], 0
    buffer_load_dwordx4 v[24:27], v5, s[20:23], s43 offen sc1
    v_mfma_f32_16x16x32_bf16 v[204:207], a[36:39], v[52:55], 0
    ds_read_b128 a[20:23], v16 offset:7168
    v_mfma_f32_16x16x32_bf16 v[200:203], a[36:39], v[48:51], 0
    v_mfma_f32_16x16x32_bf16 v[208:211], a[40:43], v[48:51], 0
    ds_read_b128 a[24:27], v16 offset:10240
    v_mfma_f32_16x16x32_bf16 v[212:215], a[40:43], v[52:55], 0
    buffer_load_dwordx4 v[28:31], v6, s[20:23], s43 offen sc1
    v_mfma_f32_16x16x32_bf16 v[220:223], a[44:47], v[52:55], 0
    ds_read_b128 a[28:31], v16 offset:11264
    v_mfma_f32_16x16x32_bf16 v[216:219], a[44:47], v[48:51], 0
    s_waitcnt lgkmcnt(4)
    v_mfma_f32_16x16x32_bf16 v[224:227], a[0:3], v[48:51], 0
    ds_read_b128 a[32:35], v16 offset:14336
    v_mfma_f32_16x16x32_bf16 v[228:231], a[0:3], v[52:55], 0
    s_waitcnt vmcnt(12)
    v_swap_b32 v58, v60
    v_swap_b32 v59, v61
    v_mfma_f32_16x16x32_bf16 v[236:239], a[4:7], v[52:55], 0
    ds_read_b128 a[36:39], v16 offset:15360
    v_mfma_f32_16x16x32_bf16 v[232:235], a[4:7], v[48:51], 0
    v_mfma_f32_16x16x32_bf16 v[128:131], a[8:11], v[56:59], v[128:131]
    ds_read_b128 a[40:43], v16 offset:18432
    v_mfma_f32_16x16x32_bf16 v[132:135], a[8:11], v[60:63], v[132:135]
    buffer_load_dwordx4 v[100:103], v6, s[20:23], s10 offen sc1
    v_mfma_f32_16x16x32_bf16 v[140:143], a[12:15], v[60:63], v[140:143]
    ds_read_b128 a[44:47], v16 offset:19456
    v_mfma_f32_16x16x32_bf16 v[136:139], a[12:15], v[56:59], v[136:139]
    s_waitcnt lgkmcnt(4)
    v_mfma_f32_16x16x32_bf16 v[144:147], a[16:19], v[56:59], v[144:147]
    ds_read_b128 a[0:3], v16 offset:22528
    s_add_u32 s10, s10, 131072
    v_mfma_f32_16x16x32_bf16 v[148:151], a[16:19], v[60:63], v[148:151]
    buffer_load_dwordx4 v[104:107], v5, s[20:23], s10 offen sc1
    v_mfma_f32_16x16x32_bf16 v[156:159], a[20:23], v[60:63], v[156:159]
    ds_read_b128 a[4:7], v16 offset:23552
    v_mfma_f32_16x16x32_bf16 v[152:155], a[20:23], v[56:59], v[152:155]
    v_mfma_f32_16x16x32_bf16 v[160:163], a[24:27], v[56:59], v[160:163]
    ds_read_b128 a[8:11], v16 offset:26624
    v_mfma_f32_16x16x32_bf16 v[164:167], a[24:27], v[60:63], v[164:167]
    buffer_load_dwordx4 v[108:111], v6, s[20:23], s10 offen sc1
    v_mfma_f32_16x16x32_bf16 v[172:175], a[28:31], v[60:63], v[172:175]
    ds_read_b128 a[12:15], v16 offset:27648
    v_mfma_f32_16x16x32_bf16 v[168:171], a[28:31], v[56:59], v[168:171]
    s_waitcnt lgkmcnt(4)
    v_mfma_f32_16x16x32_bf16 v[176:179], a[32:35], v[56:59], v[176:179]
    ds_read_b128 a[16:19], v16 offset:28672
    s_add_u32 s10, s10, 131072
    v_mfma_f32_16x16x32_bf16 v[180:183], a[32:35], v[60:63], v[180:183]
    buffer_load_dwordx4 v[112:115], v5, s[20:23], s10 offen sc1
    v_mfma_f32_16x16x32_bf16 v[188:191], a[36:39], v[60:63], v[188:191]
    ds_read_b128 a[20:23], v16 offset:29696
    v_mfma_f32_16x16x32_bf16 v[184:187], a[36:39], v[56:59], v[184:187]
    v_mfma_f32_16x16x32_bf16 v[192:195], a[40:43], v[56:59], v[192:195]
    ds_read_b128 a[24:27], v16 offset:32768
    v_mfma_f32_16x16x32_bf16 v[196:199], a[40:43], v[60:63], v[196:199]
    buffer_load_dwordx4 v[116:119], v6, s[20:23], s10 offen sc1
    v_mfma_f32_16x16x32_bf16 v[204:207], a[44:47], v[60:63], v[204:207]
    ds_read_b128 a[28:31], v16 offset:33792
    v_mfma_f32_16x16x32_bf16 v[200:203], a[44:47], v[56:59], v[200:203]
    s_waitcnt lgkmcnt(4)
    v_mfma_f32_16x16x32_bf16 v[208:211], a[0:3], v[56:59], v[208:211]
    ds_read_b128 a[32:35], v16 offset:36864
    s_add_u32 s10, s10, 131072
    v_mfma_f32_16x16x32_bf16 v[212:215], a[0:3], v[60:63], v[212:215]
    buffer_load_dwordx4 v[120:123], v5, s[20:23], s10 offen sc1
    v_mfma_f32_16x16x32_bf16 v[220:223], a[4:7], v[60:63], v[220:223]
    ds_read_b128 a[36:39], v16 offset:37888
    v_mfma_f32_16x16x32_bf16 v[216:219], a[4:7], v[56:59], v[216:219]
    v_mfma_f32_16x16x32_bf16 v[224:227], a[8:11], v[56:59], v[224:227]
    ds_read_b128 a[40:43], v16 offset:40960
    v_mfma_f32_16x16x32_bf16 v[228:231], a[8:11], v[60:63], v[228:231]
    s_waitcnt vmcnt(16)
    v_swap_b32 v66, v68
    v_swap_b32 v67, v69
    v_mfma_f32_16x16x32_bf16 v[236:239], a[12:15], v[60:63], v[236:239]
    ds_read_b128 a[44:47], v16 offset:41984
    v_mfma_f32_16x16x32_bf16 v[232:235], a[12:15], v[56:59], v[232:235]
    s_waitcnt lgkmcnt(4)
    v_mfma_f32_16x16x32_bf16 v[128:131], a[16:19], v[64:67], v[128:131]
    ds_read_b128 a[0:3], v16 offset:45056
    v_mfma_f32_16x16x32_bf16 v[132:135], a[16:19], v[68:71], v[132:135]
    buffer_load_dwordx4 v[124:127], v6, s[20:23], s10 offen sc1
    v_mfma_f32_16x16x32_bf16 v[140:143], a[20:23], v[68:71], v[140:143]
    ds_read_b128 a[4:7], v16 offset:46080
    v_mfma_f32_16x16x32_bf16 v[136:139], a[20:23], v[64:67], v[136:139]
    v_mfma_f32_16x16x32_bf16 v[144:147], a[24:27], v[64:67], v[144:147]
    ds_read_b128 a[8:11], v16 offset:49152
    s_waitcnt vmcnt(10)
    v_cmp_ne_u32 vcc, s64, v32
    v_mfma_f32_16x16x32_bf16 v[148:151], a[24:27], v[68:71], v[148:151]
    s_cbranch_vccz L_w2ok
    s_mov_b32 s66, 0x8000
    s_branch L_pfst_31
L_poll_28:
    s_sleep 2
L_pfst_31:
    buffer_load_dword v32, v33, s[56:59], 0 offen offset:8 sc1
L_pchk_29:
    s_sub_u32 s66, s66, 1
    s_cmp_eq_u32 s66, 0
    s_waitcnt vmcnt(0)
    s_cbranch_scc1 L_pdone_30
    v_cmp_ne_u32 vcc, s64, v32
    s_cbranch_vccnz L_poll_28
L_pdone_30:
L_w2ok:
    v_mfma_f32_16x16x32_bf16 v[156:159], a[28:31], v[68:71], v[156:159]
    ds_read_b128 a[12:15], v16 offset:50176
    v_mfma_f32_16x16x32_bf16 v[152:155], a[28:31], v[64:67], v[152:155]
    s_waitcnt lgkmcnt(4)
    v_mfma_f32_16x16x32_bf16 v[160:163], a[32:35], v[64:67], v[160:163]
    ds_read_b128 a[16:19], v16 offset:53248
    s_add_u32 m0, s9, 143360
    v_mfma_f32_16x16x32_bf16 v[164:167], a[32:35], v[68:71], v[164:167]
    s_lshl_b32 s11, s5, 11
    v_mfma_f32_16x16x32_bf16 v[172:175], a[36:39], v[68:71], v[172:175]
    ds_read_b128 a[20:23], v16 offset:54272
    buffer_load_dwordx4 v35, s[28:31], s11 offen sc1 lds
    v_mfma_f32_16x16x32_bf16 v[168:171], a[36:39], v[64:67], v[168:171]
    v_mfma_f32_16x16x32_bf16 v[176:179], a[40:43], v[64:67], v[176:179]
    ds_read_b128 a[24:27], v16 offset:30720
    s_add_u32 m0, s9, 147456
    v_mfma_f32_16x16x32_bf16 v[180:183], a[40:43], v[68:71], v[180:183]
    s_add_u32 s11, s11, 4096
    v_mfma_f32_16x16x32_bf16 v[188:191], a[44:47], v[68:71], v[188:191]
    ds_read_b128 a[28:31], v16 offset:31744
    buffer_load_dwordx4 v35, s[28:31], s11 offen sc1 lds
    v_mfma_f32_16x16x32_bf16 v[184:187], a[44:47], v[64:67], v[184:187]
    s_waitcnt lgkmcnt(4)
    v_mfma_f32_16x16x32_bf16 v[192:195], a[0:3], v[64:67], v[192:195]
    ds_read_b128 a[32:35], v16 offset:34816
    s_add_u32 m0, s9, 151552
    v_mfma_f32_16x16x32_bf16 v[196:199], a[0:3], v[68:71], v[196:199]
    s_add_u32 s11, s11, 4096
    v_mfma_f32_16x16x32_bf16 v[204:207], a[4:7], v[68:71], v[204:207]
    ds_read_b128 a[36:39], v16 offset:35840
    buffer_load_dwordx4 v35, s[28:31], s11 offen sc1 lds
    v_mfma_f32_16x16x32_bf16 v[200:203], a[4:7], v[64:67], v[200:203]
    v_mfma_f32_16x16x32_bf16 v[208:211], a[8:11], v[64:67], v[208:211]
    ds_read_b128 a[40:43], v16 offset:38912
    s_add_u32 m0, s9, 155648
    v_mfma_f32_16x16x32_bf16 v[212:215], a[8:11], v[68:71], v[212:215]
    s_add_u32 s11, s11, 4096
    v_mfma_f32_16x16x32_bf16 v[220:223], a[12:15], v[68:71], v[220:223]
    ds_read_b128 a[44:47], v16 offset:39936
    buffer_load_dwordx4 v35, s[28:31], s11 offen sc1 lds
    v_mfma_f32_16x16x32_bf16 v[216:219], a[12:15], v[64:67], v[216:219]
    s_waitcnt vmcnt(11)
    v_swap_b32 v26, v28
    v_swap_b32 v27, v29
    s_waitcnt lgkmcnt(4)
    v_mfma_f32_16x16x32_bf16 v[224:227], a[16:19], v[64:67], v[224:227]
    ds_read_b128 a[0:3], v16 offset:43008
    v_mfma_f32_16x16x32_bf16 v[228:231], a[16:19], v[68:71], v[228:231]
    v_swap_b32 v74, v76
    v_swap_b32 v75, v77
    v_mfma_f32_16x16x32_bf16 v[236:239], a[20:23], v[68:71], v[236:239]
    ds_read_b128 a[4:7], v16 offset:44032
    v_mfma_f32_16x16x32_bf16 v[232:235], a[20:23], v[64:67], v[232:235]
    v_mfma_f32_16x16x32_bf16 v[240:243], v[20:23], v[24:27], 0
    v_mfma_f32_16x16x32_bf16 v[248:251], v[24:27], v[24:27], 0
    v_mfma_f32_16x16x32_bf16 v[244:247], v[20:23], v[28:31], 0
    v_mfma_f32_16x16x32_bf16 v[252:255], v[28:31], v[28:31], 0
    v_mfma_f32_16x16x32_bf16 v[128:131], a[24:27], v[72:75], v[128:131]
    ds_read_b128 a[8:11], v16 offset:47104
    s_add_u32 s43, s43, 131072
    v_mfma_f32_16x16x32_bf16 v[132:135], a[24:27], v[76:79], v[132:135]
    buffer_load_dwordx4 v[24:27], v5, s[20:23], s43 offen sc1
    v_mfma_f32_16x16x32_bf16 v[140:143], a[28:31], v[76:79], v[140:143]
    ds_read_b128 a[12:15], v16 offset:48128
    v_mfma_f32_16x16x32_bf16 v[136:139], a[28:31], v[72:75], v[136:139]
    s_waitcnt lgkmcnt(4)
    v_mfma_f32_16x16x32_bf16 v[144:147], a[32:35], v[72:75], v[144:147]
    ds_read_b128 a[16:19], v16 offset:51200
    v_mfma_f32_16x16x32_bf16 v[148:151], a[32:35], v[76:79], v[148:151]
    buffer_load_dwordx4 v[28:31], v6, s[20:23], s43 offen sc1
    v_mfma_f32_16x16x32_bf16 v[156:159], a[36:39], v[76:79], v[156:159]
    ds_read_b128 a[20:23], v16 offset:52224
    v_mfma_f32_16x16x32_bf16 v[152:155], a[36:39], v[72:75], v[152:155]
    v_mfma_f32_16x16x32_bf16 v[160:163], a[40:43], v[72:75], v[160:163]
    ds_read_b128 a[24:27], v16 offset:55296
    v_mfma_f32_16x16x32_bf16 v[164:167], a[40:43], v[76:79], v[164:167]
    buffer_load_dword v42, v41, s[60:63], s42 offen sc1
    v_mfma_f32_16x16x32_bf16 v[172:175], a[44:47], v[76:79], v[172:175]
    ds_read_b128 a[28:31], v16 offset:56320
    v_mfma_f32_16x16x32_bf16 v[168:171], a[44:47], v[72:75], v[168:171]
    s_barrier
    s_waitcnt lgkmcnt(4)
    v_mfma_f32_16x16x32_bf16 v[176:179], a[0:3], v[72:75], v[176:179]
    ds_read_b128 a[32:35], v17 offset:0
    s_add_u32 s42, s42, 30720
    v_mfma_f32_16x16x32_bf16 v[180:183], a[0:3], v[76:79], v[180:183]
    buffer_load_dword v43, v41, s[60:63], s42 offen sc1
    v_mfma_f32_16x16x32_bf16 v[188:191], a[4:7], v[76:79], v[188:191]
    ds_read_b128 a[36:39], v17 offset:1024
    v_mfma_f32_16x16x32_bf16 v[184:187], a[4:7], v[72:75], v[184:187]
    v_mfma_f32_16x16x32_bf16 v[192:195], a[8:11], v[72:75], v[192:195]
    ds_read_b128 a[40:43], v17 offset:4096
    s_add_u32 s42, s42, 30720
    v_mfma_f32_16x16x32_bf16 v[196:199], a[8:11], v[76:79], v[196:199]
    buffer_load_dword v18, v41, s[60:63], s42 offen sc1
    v_mfma_f32_16x16x32_bf16 v[204:207], a[12:15], v[76:79], v[204:207]
    ds_read_b128 a[44:47], v17 offset:5120
    v_mfma_f32_16x16x32_bf16 v[200:203], a[12:15], v[72:75], v[200:203]
    s_waitcnt lgkmcnt(4)
    v_mfma_f32_16x16x32_bf16 v[208:211], a[16:19], v[72:75], v[208:211]
    ds_read_b128 a[0:3], v17 offset:8192
    s_add_u32 s42, s42, 30720
    v_mfma_f32_16x16x32_bf16 v[212:215], a[16:19], v[76:79], v[212:215]
    buffer_load_dword v19, v41, s[60:63], s42 offen sc1
    v_mfma_f32_16x16x32_bf16 v[220:223], a[20:23], v[76:79], v[220:223]
    ds_read_b128 a[4:7], v17 offset:9216
    v_mfma_f32_16x16x32_bf16 v[216:219], a[20:23], v[72:75], v[216:219]
    v_mfma_f32_16x16x32_bf16 v[224:227], a[24:27], v[72:75], v[224:227]
    ds_read_b128 a[8:11], v17 offset:12288
    v_mfma_f32_16x16x32_bf16 v[228:231], a[24:27], v[76:79], v[228:231]
    v_swap_b32 v82, v84
    v_swap_b32 v83, v85
    v_mfma_f32_16x16x32_bf16 v[236:239], a[28:31], v[76:79], v[236:239]
    ds_read_b128 a[12:15], v17 offset:13312
    v_mfma_f32_16x16x32_bf16 v[232:235], a[28:31], v[72:75], v[232:235]
    s_waitcnt lgkmcnt(4)
    v_mfma_f32_16x16x32_bf16 v[128:131], a[32:35], v[80:83], v[128:131]
    ds_read_b128 a[16:19], v17 offset:16384
    s_add_u32 s10, s10, 131072
    v_mfma_f32_16x16x32_bf16 v[132:135], a[32:35], v[84:87], v[132:135]
    buffer_load_dwordx4 v[48:51], v5, s[20:23], s10 offen sc1
    v_mfma_f32_16x16x32_bf16 v[140:143], a[36:39], v[84:87], v[140:143]
    ds_read_b128 a[20:23], v17 offset:17408
    v_mfma_f32_16x16x32_bf16 v[136:139], a[36:39], v[80:83], v[136:139]
    v_mfma_f32_16x16x32_bf16 v[144:147], a[40:43], v[80:83], v[144:147]
    ds_read_b128 a[24:27], v17 offset:20480
    v_mfma_f32_16x16x32_bf16 v[148:151], a[40:43], v[84:87], v[148:151]
    buffer_load_dwordx4 v[52:55], v6, s[20:23], s10 offen sc1
    v_mfma_f32_16x16x32_bf16 v[156:159], a[44:47], v[84:87], v[156:159]
    ds_read_b128 a[28:31], v17 offset:21504
    v_mfma_f32_16x16x32_bf16 v[152:155], a[44:47], v[80:83], v[152:155]
    s_waitcnt lgkmcnt(4)
    v_mfma_f32_16x16x32_bf16 v[160:163], a[0:3], v[80:83], v[160:163]
    ds_read_b128 a[32:35], v17 offset:24576
    s_add_u32 s10, s10, 131072
    v_mfma_f32_16x16x32_bf16 v[164:167], a[0:3], v[84:87], v[164:167]
    buffer_load_dwordx4 v[56:59], v5, s[20:23], s10 offen sc1
    v_mfma_f32_16x16x32_bf16 v[172:175], a[4:7], v[84:87], v[172:175]
    ds_read_b128 a[36:39], v17 offset:25600
    v_mfma_f32_16x16x32_bf16 v[168:171], a[4:7], v[80:83], v[168:171]
    v_mfma_f32_16x16x32_bf16 v[176:179], a[8:11], v[80:83], v[176:179]
    ds_read_b128 a[40:43], v17 offset:2048
    v_mfma_f32_16x16x32_bf16 v[180:183], a[8:11], v[84:87], v[180:183]
    buffer_load_dwordx4 v[60:63], v6, s[20:23], s10 offen sc1
    v_mfma_f32_16x16x32_bf16 v[188:191], a[12:15], v[84:87], v[188:191]
    ds_read_b128 a[44:47], v17 offset:3072
    v_mfma_f32_16x16x32_bf16 v[184:187], a[12:15], v[80:83], v[184:187]
    s_waitcnt lgkmcnt(4)
    v_mfma_f32_16x16x32_bf16 v[192:195], a[16:19], v[80:83], v[192:195]
    ds_read_b128 a[0:3], v17 offset:6144
    s_add_u32 s10, s10, 131072
    v_mfma_f32_16x16x32_bf16 v[196:199], a[16:19], v[84:87], v[196:199]
    buffer_load_dwordx4 v[64:67], v5, s[20:23], s10 offen sc1
    v_mfma_f32_16x16x32_bf16 v[204:207], a[20:23], v[84:87], v[204:207]
    ds_read_b128 a[4:7], v17 offset:7168
    v_mfma_f32_16x16x32_bf16 v[200:203], a[20:23], v[80:83], v[200:203]
    v_mfma_f32_16x16x32_bf16 v[208:211], a[24:27], v[80:83], v[208:211]
    ds_read_b128 a[8:11], v17 offset:10240
    v_mfma_f32_16x16x32_bf16 v[212:215], a[24:27], v[84:87], v[212:215]
    buffer_load_dwordx4 v[68:71], v6, s[20:23], s10 offen sc1
    v_mfma_f32_16x16x32_bf16 v[220:223], a[28:31], v[84:87], v[220:223]
    ds_read_b128 a[12:15], v17 offset:11264
    v_mfma_f32_16x16x32_bf16 v[216:219], a[28:31], v[80:83], v[216:219]
    s_waitcnt lgkmcnt(4)
    v_mfma_f32_16x16x32_bf16 v[224:227], a[32:35], v[80:83], v[224:227]
    ds_read_b128 a[16:19], v17 offset:14336
    v_mfma_f32_16x16x32_bf16 v[228:231], a[32:35], v[84:87], v[228:231]
    v_swap_b32 v90, v92
    v_swap_b32 v91, v93
    v_mfma_f32_16x16x32_bf16 v[236:239], a[36:39], v[84:87], v[236:239]
    ds_read_b128 a[20:23], v17 offset:15360
    v_mfma_f32_16x16x32_bf16 v[232:235], a[36:39], v[80:83], v[232:235]
    v_mfma_f32_16x16x32_bf16 v[128:131], a[40:43], v[88:91], v[128:131]
    ds_read_b128 a[24:27], v17 offset:18432
    s_add_u32 m0, s9, 57344
    v_mfma_f32_16x16x32_bf16 v[132:135], a[40:43], v[92:95], v[132:135]
    s_add_u32 s8, s8, 4096
    v_mfma_f32_16x16x32_bf16 v[140:143], a[44:47], v[92:95], v[140:143]
    ds_read_b128 a[28:31], v17 offset:19456
    buffer_load_dwordx4 v7, s[24:27], s8 offen sc1 lds
    v_mfma_f32_16x16x32_bf16 v[136:139], a[44:47], v[88:91], v[136:139]
    s_waitcnt vmcnt(11)
    v_swap_b32 v26, v28
    v_swap_b32 v27, v29
    s_waitcnt lgkmcnt(4)
    v_mfma_f32_16x16x32_bf16 v[144:147], a[0:3], v[88:91], v[144:147]
    ds_read_b128 a[32:35], v17 offset:22528
    s_add_u32 m0, s9, 61440
    v_mfma_f32_16x16x32_bf16 v[148:151], a[0:3], v[92:95], v[148:151]
    buffer_load_dwordx4 v8, s[24:27], s8 offen sc1 lds
    v_mfma_f32_16x16x32_bf16 v[156:159], a[4:7], v[92:95], v[156:159]
    ds_read_b128 a[36:39], v17 offset:23552
    v_mfma_f32_16x16x32_bf16 v[152:155], a[4:7], v[88:91], v[152:155]
    v_mfma_f32_16x16x32_bf16 v[240:243], v[20:23], v[24:27], v[240:243]
    v_mfma_f32_16x16x32_bf16 v[248:251], v[24:27], v[24:27], v[248:251]
    v_mfma_f32_16x16x32_bf16 v[244:247], v[20:23], v[28:31], v[244:247]
    v_mfma_f32_16x16x32_bf16 v[252:255], v[28:31], v[28:31], v[252:255]
    v_mfma_f32_16x16x32_bf16 v[160:163], a[8:11], v[88:91], v[160:163]
    ds_read_b128 a[40:43], v17 offset:26624
    s_add_u32 m0, s9, 65536
    v_mfma_f32_16x16x32_bf16 v[164:167], a[8:11], v[92:95], v[164:167]
    buffer_load_dwordx4 v9, s[24:27], s8 offen sc1 lds
    v_mfma_f32_16x16x32_bf16 v[172:175], a[12:15], v[92:95], v[172:175]
    ds_read_b128 a[44:47], v17 offset:27648
    v_mfma_f32_16x16x32_bf16 v[168:171], a[12:15], v[88:91], v[168:171]
    s_barrier
    s_waitcnt lgkmcnt(4)
    v_mfma_f32_16x16x32_bf16 v[176:179], a[16:19], v[88:91], v[176:179]
    ds_read_b128 a[0:3], v15 offset:0
    s_add_u32 m0, s9, 69632
    v_mfma_f32_16x16x32_bf16 v[180:183], a[16:19], v[92:95], v[180:183]
    buffer_load_dwordx4 v10, s[24:27], s8 offen sc1 lds
    v_mfma_f32_16x16x32_bf16 v[188:191], a[20:23], v[92:95], v[188:191]
    ds_read_b128 a[4:7], v15 offset:1024
    v_mfma_f32_16x16x32_bf16 v[184:187], a[20:23], v[88:91], v[184:187]
    v_mfma_f32_16x16x32_bf16 v[192:195], a[24:27], v[88:91], v[192:195]
    ds_read_b128 a[8:11], v15 offset:4096
    s_add_u32 m0, s9, 73728
    v_mfma_f32_16x16x32_bf16 v[196:199], a[24:27], v[92:95], v[196:199]
    buffer_load_dwordx4 v11, s[24:27], s8 offen sc1 lds
    v_cndmask_b32 v248, v248, v249, s[36:37]
    v_mfma_f32_16x16x32_bf16 v[204:207], a[28:31], v[92:95], v[204:207]
    ds_read_b128 a[12:15], v15 offset:5120
    v_cndmask_b32 v248, v248, v250, s[38:39]
    v_mfma_f32_16x16x32_bf16 v[200:203], a[28:31], v[88:91], v[200:203]
    v_cndmask_b32 v241, v248, v251, s[40:41]
    v_mov_b32 v242, s64
    s_waitcnt lgkmcnt(4)
    v_mfma_f32_16x16x32_bf16 v[208:211], a[32:35], v[88:91], v[208:211]
    ds_read_b128 a[16:19], v15 offset:8192
    s_add_u32 m0, s9, 77824
    v_mfma_f32_16x16x32_bf16 v[212:215], a[32:35], v[92:95], v[212:215]
    buffer_load_dwordx4 v12, s[24:27], s8 offen sc1 lds
    v_mov_b32 v243, s64
    v_mfma_f32_16x16x32_bf16 v[220:223], a[36:39], v[92:95], v[220:223]
    ds_read_b128 a[20:23], v15 offset:9216
    v_cndmask_b32 v252, v252, v253, s[36:37]
    v_mfma_f32_16x16x32_bf16 v[216:219], a[36:39], v[88:91], v[216:219]
    v_cndmask_b32 v252, v252, v254, s[38:39]
    v_cndmask_b32 v245, v252, v255, s[40:41]
    v_mfma_f32_16x16x32_bf16 v[224:227], a[40:43], v[88:91], v[224:227]
    ds_read_b128 a[24:27], v15 offset:12288
    v_mov_b32 v246, s64
    v_mfma_f32_16x16x32_bf16 v[228:231], a[40:43], v[92:95], v[228:231]
    v_swap_b32 v98, v100
    v_swap_b32 v99, v101
    v_mfma_f32_16x16x32_bf16 v[236:239], a[44:47], v[92:95], v[236:239]
    ds_read_b128 a[28:31], v15 offset:13312
    v_mov_b32 v247, s64
    v_mfma_f32_16x16x32_bf16 v[232:235], a[44:47], v[88:91], v[232:235]
    s_add_u32 s36, s16, 0x1640000
    s_addc_u32 s37, s17, 0
    s_mov_b32 s38, 0x50000
    s_waitcnt lgkmcnt(4)
    v_mfma_f32_16x16x32_bf16 v[128:131], a[0:3], v[96:99], v[128:131]
    ds_read_b128 a[32:35], v15 offset:16384
    s_add_u32 m0, s9, 81920
    v_mfma_f32_16x16x32_bf16 v[132:135], a[0:3], v[100:103], v[132:135]
    buffer_load_dwordx4 v13, s[24:27], s8 offen sc1 lds
    s_mov_b32 s39, 0x20000
    v_mfma_f32_16x16x32_bf16 v[140:143], a[4:7], v[100:103], v[140:143]
    ds_read_b128 a[36:39], v15 offset:17408
    s_movk_i32 s40, 8192
    v_mfma_f32_16x16x32_bf16 v[136:139], a[4:7], v[96:99], v[136:139]
    s_movk_i32 s41, 16384
    buffer_store_dwordx4 v[240:243], v36, s[36:39], s7 offen sc1
    v_mfma_f32_16x16x32_bf16 v[144:147], a[8:11], v[96:99], v[144:147]
    ds_read_b128 a[40:43], v15 offset:20480
    s_add_u32 s10, s10, 131072
    v_mfma_f32_16x16x32_bf16 v[148:151], a[8:11], v[100:103], v[148:151]
    buffer_load_dwordx4 v[72:75], v5, s[20:23], s10 offen sc1
    s_nop 0
    v_mfma_f32_16x16x32_bf16 v[156:159], a[12:15], v[100:103], v[156:159]
    ds_read_b128 a[44:47], v15 offset:21504
    buffer_store_dwordx4 v[244:247], v36, s[36:39], s7 offen offset:16 sc1
    v_mfma_f32_16x16x32_bf16 v[152:155], a[12:15], v[96:99], v[152:155]
    s_waitcnt lgkmcnt(4)
    v_mfma_f32_16x16x32_bf16 v[160:163], a[16:19], v[96:99], v[160:163]
    ds_read_b128 a[0:3], v15 offset:24576
    v_mfma_f32_16x16x32_bf16 v[164:167], a[16:19], v[100:103], v[164:167]
    buffer_load_dwordx4 v[76:79], v6, s[20:23], s10 offen sc1
    v_mfma_f32_16x16x32_bf16 v[172:175], a[20:23], v[100:103], v[172:175]
    ds_read_b128 a[4:7], v15 offset:25600
    v_mfma_f32_16x16x32_bf16 v[168:171], a[20:23], v[96:99], v[168:171]
    v_mfma_f32_16x16x32_bf16 v[176:179], a[24:27], v[96:99], v[176:179]
    ds_read_b128 a[8:11], v15 offset:2048
    s_add_u32 s10, s10, 131072
    v_mfma_f32_16x16x32_bf16 v[180:183], a[24:27], v[100:103], v[180:183]
    buffer_load_dwordx4 v[80:83], v5, s[20:23], s10 offen sc1
    v_mfma_f32_16x16x32_bf16 v[188:191], a[28:31], v[100:103], v[188:191]
    ds_read_b128 a[12:15], v15 offset:3072
    v_mfma_f32_16x16x32_bf16 v[184:187], a[28:31], v[96:99], v[184:187]
    s_waitcnt lgkmcnt(4)
    v_mfma_f32_16x16x32_bf16 v[192:195], a[32:35], v[96:99], v[192:195]
    ds_read_b128 a[16:19], v15 offset:6144
    v_mfma_f32_16x16x32_bf16 v[196:199], a[32:35], v[100:103], v[196:199]
    buffer_load_dwordx4 v[84:87], v6, s[20:23], s10 offen sc1
    v_mfma_f32_16x16x32_bf16 v[204:207], a[36:39], v[100:103], v[204:207]
    ds_read_b128 a[20:23], v15 offset:7168
    v_mfma_f32_16x16x32_bf16 v[200:203], a[36:39], v[96:99], v[200:203]
    v_mfma_f32_16x16x32_bf16 v[208:211], a[40:43], v[96:99], v[208:211]
    ds_read_b128 a[24:27], v15 offset:10240
    s_add_u32 m0, s9, 86016
    v_mfma_f32_16x16x32_bf16 v[212:215], a[40:43], v[100:103], v[212:215]
    s_add_u32 s8, s8, 4096
    v_mfma_f32_16x16x32_bf16 v[220:223], a[44:47], v[100:103], v[220:223]
    ds_read_b128 a[28:31], v15 offset:11264
    buffer_load_dwordx4 v7, s[24:27], s8 offen sc1 lds
    v_mfma_f32_16x16x32_bf16 v[216:219], a[44:47], v[96:99], v[216:219]
    s_waitcnt lgkmcnt(4)
    v_mfma_f32_16x16x32_bf16 v[224:227], a[0:3], v[96:99], v[224:227]
    ds_read_b128 a[32:35], v15 offset:14336
    v_mfma_f32_16x16x32_bf16 v[228:231], a[0:3], v[100:103], v[228:231]
    v_swap_b32 v106, v108
    v_swap_b32 v107, v109
    v_mfma_f32_16x16x32_bf16 v[236:239], a[4:7], v[100:103], v[236:239]
    ds_read_b128 a[36:39], v15 offset:15360
    v_mfma_f32_16x16x32_bf16 v[232:235], a[4:7], v[96:99], v[232:235]
    v_mfma_f32_16x16x32_bf16 v[128:131], a[8:11], v[104:107], v[128:131]
    ds_read_b128 a[40:43], v15 offset:18432
    s_add_u32 m0, s9, 90112
    v_mfma_f32_16x16x32_bf16 v[132:135], a[8:11], v[108:111], v[132:135]
    buffer_load_dwordx4 v8, s[24:27], s8 offen sc1 lds
    v_mfma_f32_16x16x32_bf16 v[140:143], a[12:15], v[108:111], v[140:143]
    ds_read_b128 a[44:47], v15 offset:19456
    v_mfma_f32_16x16x32_bf16 v[136:139], a[12:15], v[104:107], v[136:139]
    s_waitcnt lgkmcnt(4)
    v_mfma_f32_16x16x32_bf16 v[144:147], a[16:19], v[104:107], v[144:147]
    ds_read_b128 a[0:3], v15 offset:22528
    s_add_u32 m0, s9, 94208
    v_mfma_f32_16x16x32_bf16 v[148:151], a[16:19], v[108:111], v[148:151]
    buffer_load_dwordx4 v9, s[24:27], s8 offen sc1 lds
    v_mfma_f32_16x16x32_bf16 v[156:159], a[20:23], v[108:111], v[156:159]
    ds_read_b128 a[4:7], v15 offset:23552
    v_mfma_f32_16x16x32_bf16 v[152:155], a[20:23], v[104:107], v[152:155]
    v_mfma_f32_16x16x32_bf16 v[160:163], a[24:27], v[104:107], v[160:163]
    ds_read_b128 a[8:11], v15 offset:26624
    s_add_u32 m0, s9, 98304
    v_mfma_f32_16x16x32_bf16 v[164:167], a[24:27], v[108:111], v[164:167]
    buffer_load_dwordx4 v10, s[24:27], s8 offen sc1 lds
    v_mfma_f32_16x16x32_bf16 v[172:175], a[28:31], v[108:111], v[172:175]
    ds_read_b128 a[12:15], v15 offset:27648
    v_mfma_f32_16x16x32_bf16 v[168:171], a[28:31], v[104:107], v[168:171]
    s_barrier
    s_waitcnt lgkmcnt(4)
    v_mfma_f32_16x16x32_bf16 v[176:179], a[32:35], v[104:107], v[176:179]
    ds_read_b128 a[16:19], v15 offset:28672
    s_add_u32 m0, s9, 102400
    v_mfma_f32_16x16x32_bf16 v[180:183], a[32:35], v[108:111], v[180:183]
    buffer_load_dwordx4 v11, s[24:27], s8 offen sc1 lds
    v_mfma_f32_16x16x32_bf16 v[188:191], a[36:39], v[108:111], v[188:191]
    ds_read_b128 a[20:23], v15 offset:29696
    v_mfma_f32_16x16x32_bf16 v[184:187], a[36:39], v[104:107], v[184:187]
    v_mfma_f32_16x16x32_bf16 v[192:195], a[40:43], v[104:107], v[192:195]
    ds_read_b128 a[24:27], v15 offset:32768
    s_add_u32 m0, s9, 106496
    v_mfma_f32_16x16x32_bf16 v[196:199], a[40:43], v[108:111], v[196:199]
    buffer_load_dwordx4 v12, s[24:27], s8 offen sc1 lds
    v_mfma_f32_16x16x32_bf16 v[204:207], a[44:47], v[108:111], v[204:207]
    ds_read_b128 a[28:31], v15 offset:33792
    v_mfma_f32_16x16x32_bf16 v[200:203], a[44:47], v[104:107], v[200:203]
    s_waitcnt lgkmcnt(4)
    v_mfma_f32_16x16x32_bf16 v[208:211], a[0:3], v[104:107], v[208:211]
    ds_read_b128 a[32:35], v15 offset:36864
    s_add_u32 m0, s9, 110592
    v_mfma_f32_16x16x32_bf16 v[212:215], a[0:3], v[108:111], v[212:215]
    buffer_load_dwordx4 v13, s[24:27], s8 offen sc1 lds
    v_mfma_f32_16x16x32_bf16 v[220:223], a[4:7], v[108:111], v[220:223]
    ds_read_b128 a[36:39], v15 offset:37888
    v_mfma_f32_16x16x32_bf16 v[216:219], a[4:7], v[104:107], v[216:219]
    v_mfma_f32_16x16x32_bf16 v[224:227], a[8:11], v[104:107], v[224:227]
    ds_read_b128 a[40:43], v15 offset:40960
    v_mfma_f32_16x16x32_bf16 v[228:231], a[8:11], v[108:111], v[228:231]
    v_swap_b32 v114, v116
    v_swap_b32 v115, v117
    v_mfma_f32_16x16x32_bf16 v[236:239], a[12:15], v[108:111], v[236:239]
    ds_read_b128 a[44:47], v15 offset:41984
    v_mfma_f32_16x16x32_bf16 v[232:235], a[12:15], v[104:107], v[232:235]
    s_waitcnt lgkmcnt(4)
    v_mfma_f32_16x16x32_bf16 v[128:131], a[16:19], v[112:115], v[128:131]
    ds_read_b128 a[0:3], v15 offset:45056
    s_add_u32 s10, s10, 131072
    v_mfma_f32_16x16x32_bf16 v[132:135], a[16:19], v[116:119], v[132:135]
    buffer_load_dwordx4 v[88:91], v5, s[20:23], s10 offen sc1
    v_mfma_f32_16x16x32_bf16 v[140:143], a[20:23], v[116:119], v[140:143]
    ds_read_b128 a[4:7], v15 offset:46080
    v_mfma_f32_16x16x32_bf16 v[136:139], a[20:23], v[112:115], v[136:139]
    v_mfma_f32_16x16x32_bf16 v[144:147], a[24:27], v[112:115], v[144:147]
    ds_read_b128 a[8:11], v15 offset:49152
    v_mfma_f32_16x16x32_bf16 v[148:151], a[24:27], v[116:119], v[148:151]
    buffer_load_dwordx4 v[92:95], v6, s[20:23], s10 offen sc1
    v_mfma_f32_16x16x32_bf16 v[156:159], a[28:31], v[116:119], v[156:159]
    ds_read_b128 a[12:15], v15 offset:50176
    v_mfma_f32_16x16x32_bf16 v[152:155], a[28:31], v[112:115], v[152:155]
    s_waitcnt lgkmcnt(4)
    v_mfma_f32_16x16x32_bf16 v[160:163], a[32:35], v[112:115], v[160:163]
    ds_read_b128 a[16:19], v15 offset:53248
    s_add_u32 s10, s10, 131072
    v_mfma_f32_16x16x32_bf16 v[164:167], a[32:35], v[116:119], v[164:167]
    buffer_load_dwordx4 v[96:99], v5, s[20:23], s10 offen sc1
    v_mfma_f32_16x16x32_bf16 v[172:175], a[36:39], v[116:119], v[172:175]
    ds_read_b128 a[20:23], v15 offset:54272
    v_mfma_f32_16x16x32_bf16 v[168:171], a[36:39], v[112:115], v[168:171]
    v_mfma_f32_16x16x32_bf16 v[176:179], a[40:43], v[112:115], v[176:179]
    ds_read_b128 a[24:27], v15 offset:30720
    v_mfma_f32_16x16x32_bf16 v[180:183], a[40:43], v[116:119], v[180:183]
    buffer_load_dwordx4 v[100:103], v6, s[20:23], s10 offen sc1
    v_mfma_f32_16x16x32_bf16 v[188:191], a[44:47], v[116:119], v[188:191]
    ds_read_b128 a[28:31], v15 offset:31744
    v_mfma_f32_16x16x32_bf16 v[184:187], a[44:47], v[112:115], v[184:187]
    s_waitcnt lgkmcnt(4)
    v_mfma_f32_16x16x32_bf16 v[192:195], a[0:3], v[112:115], v[192:195]
    ds_read_b128 a[32:35], v15 offset:34816
    s_add_u32 m0, s9, 114688
    v_mfma_f32_16x16x32_bf16 v[196:199], a[0:3], v[116:119], v[196:199]
    s_add_u32 s8, s8, 4096
    s_waitcnt vmcnt(30)
    v_add_f32 v42, v42, v43
    v_mfma_f32_16x16x32_bf16 v[204:207], a[4:7], v[116:119], v[204:207]
    ds_read_b128 a[36:39], v15 offset:35840
    buffer_load_dwordx4 v7, s[24:27], s8 offen sc1 lds
    v_mfma_f32_16x16x32_bf16 v[200:203], a[4:7], v[112:115], v[200:203]
    v_add_f32 v18, v18, v19
    v_add_f32 v42, v42, v18
    v_mfma_f32_16x16x32_bf16 v[208:211], a[8:11], v[112:115], v[208:211]
    ds_read_b128 a[40:43], v15 offset:38912
    s_add_u32 m0, s9, 118784
    v_mfma_f32_16x16x32_bf16 v[212:215], a[8:11], v[116:119], v[212:215]
    buffer_load_dwordx4 v8, s[24:27], s8 offen sc1 lds
    v_cvt_pk_bf16_f32 v42, v42, v42
    v_mfma_f32_16x16x32_bf16 v[220:223], a[12:15], v[116:119], v[220:223]
    ds_read_b128 a[44:47], v15 offset:39936
    v_lshlrev_b32 v42, 16, v42
    v_mfma_f32_16x16x32_bf16 v[216:219], a[12:15], v[112:115], v[216:219]
    ds_write_b32 v40, v42
    s_waitcnt lgkmcnt(5)
    v_mfma_f32_16x16x32_bf16 v[224:227], a[16:19], v[112:115], v[224:227]
    ds_read_b128 a[0:3], v15 offset:43008
    v_mfma_f32_16x16x32_bf16 v[228:231], a[16:19], v[116:119], v[228:231]
    v_swap_b32 v122, v124
    v_swap_b32 v123, v125
    v_mfma_f32_16x16x32_bf16 v[236:239], a[20:23], v[116:119], v[236:239]
    ds_read_b128 a[4:7], v15 offset:44032
    v_mfma_f32_16x16x32_bf16 v[232:235], a[20:23], v[112:115], v[232:235]
    v_mfma_f32_16x16x32_bf16 v[128:131], a[24:27], v[120:123], v[128:131]
    ds_read_b128 a[8:11], v15 offset:47104
    s_add_u32 m0, s9, 122880
    v_mfma_f32_16x16x32_bf16 v[132:135], a[24:27], v[124:127], v[132:135]
    buffer_load_dwordx4 v9, s[24:27], s8 offen sc1 lds
    v_mfma_f32_16x16x32_bf16 v[140:143], a[28:31], v[124:127], v[140:143]
    ds_read_b128 a[12:15], v15 offset:48128
    v_mfma_f32_16x16x32_bf16 v[136:139], a[28:31], v[120:123], v[136:139]
    s_waitcnt lgkmcnt(5)
    v_mfma_f32_16x16x32_bf16 v[144:147], a[32:35], v[120:123], v[144:147]
    ds_read_b128 a[16:19], v15 offset:51200
    s_add_u32 m0, s9, 126976
    v_mfma_f32_16x16x32_bf16 v[148:151], a[32:35], v[124:127], v[148:151]
    buffer_load_dwordx4 v10, s[24:27], s8 offen sc1 lds
    v_mfma_f32_16x16x32_bf16 v[156:159], a[36:39], v[124:127], v[156:159]
    ds_read_b128 a[20:23], v15 offset:52224
    v_mfma_f32_16x16x32_bf16 v[152:155], a[36:39], v[120:123], v[152:155]
    v_mfma_f32_16x16x32_bf16 v[160:163], a[40:43], v[120:123], v[160:163]
    ds_read_b128 a[24:27], v15 offset:55296
    s_add_u32 m0, s9, 131072
    v_mfma_f32_16x16x32_bf16 v[164:167], a[40:43], v[124:127], v[164:167]
    buffer_load_dwordx4 v11, s[24:27], s8 offen sc1 lds
    v_mfma_f32_16x16x32_bf16 v[172:175], a[44:47], v[124:127], v[172:175]
    ds_read_b128 a[28:31], v15 offset:56320
    v_mfma_f32_16x16x32_bf16 v[168:171], a[44:47], v[120:123], v[168:171]
    s_waitcnt vmcnt(22)
    s_barrier
    s_waitcnt lgkmcnt(4)
    v_mfma_f32_16x16x32_bf16 v[176:179], a[0:3], v[120:123], v[176:179]
    ds_read_b128 a[32:35], v16 offset:0
    s_add_u32 m0, s9, 135168
    v_mfma_f32_16x16x32_bf16 v[180:183], a[0:3], v[124:127], v[180:183]
    buffer_load_dwordx4 v12, s[24:27], s8 offen sc1 lds
    v_mfma_f32_16x16x32_bf16 v[188:191], a[4:7], v[124:127], v[188:191]
    ds_read_b128 a[36:39], v16 offset:1024
    v_mfma_f32_16x16x32_bf16 v[184:187], a[4:7], v[120:123], v[184:187]
    v_mfma_f32_16x16x32_bf16 v[192:195], a[8:11], v[120:123], v[192:195]
    ds_read_b128 a[40:43], v16 offset:4096
    s_add_u32 m0, s9, 139264
    v_mfma_f32_16x16x32_bf16 v[196:199], a[8:11], v[124:127], v[196:199]
    buffer_load_dwordx4 v13, s[24:27], s8 offen sc1 lds
    v_mfma_f32_16x16x32_bf16 v[204:207], a[12:15], v[124:127], v[204:207]
    ds_read_b128 a[44:47], v16 offset:5120
    v_mfma_f32_16x16x32_bf16 v[200:203], a[12:15], v[120:123], v[200:203]
    s_waitcnt lgkmcnt(4)
    v_mfma_f32_16x16x32_bf16 v[208:211], a[16:19], v[120:123], v[208:211]
    ds_read_b128 a[0:3], v16 offset:8192
    s_add_u32 s10, s10, 131072
    v_mfma_f32_16x16x32_bf16 v[212:215], a[16:19], v[124:127], v[212:215]
    buffer_load_dwordx4 v[104:107], v5, s[20:23], s10 offen sc1
    v_mfma_f32_16x16x32_bf16 v[220:223], a[20:23], v[124:127], v[220:223]
    ds_read_b128 a[4:7], v16 offset:9216
    v_mfma_f32_16x16x32_bf16 v[216:219], a[20:23], v[120:123], v[216:219]
    v_mfma_f32_16x16x32_bf16 v[224:227], a[24:27], v[120:123], v[224:227]
    ds_read_b128 a[8:11], v16 offset:12288
    v_mfma_f32_16x16x32_bf16 v[228:231], a[24:27], v[124:127], v[228:231]
    v_swap_b32 v50, v52
    v_swap_b32 v51, v53
    v_mfma_f32_16x16x32_bf16 v[236:239], a[28:31], v[124:127], v[236:239]
    ds_read_b128 a[12:15], v16 offset:13312
    v_mfma_f32_16x16x32_bf16 v[232:235], a[28:31], v[120:123], v[232:235]
    s_waitcnt lgkmcnt(4)
    v_mfma_f32_16x16x32_bf16 v[128:131], a[32:35], v[48:51], v[128:131]
    ds_read_b128 a[16:19], v16 offset:16384
    v_mfma_f32_16x16x32_bf16 v[132:135], a[32:35], v[52:55], v[132:135]
    buffer_load_dwordx4 v[240:243], v44, s[36:39], 0 offen offset:0 sc1
    v_mfma_f32_16x16x32_bf16 v[140:143], a[36:39], v[52:55], v[140:143]
    ds_read_b128 a[20:23], v16 offset:17408
    v_mfma_f32_16x16x32_bf16 v[136:139], a[36:39], v[48:51], v[136:139]
    v_mfma_f32_16x16x32_bf16 v[144:147], a[40:43], v[48:51], v[144:147]
    ds_read_b128 a[24:27], v16 offset:20480
    v_mfma_f32_16x16x32_bf16 v[148:151], a[40:43], v[52:55], v[148:151]
    buffer_load_dwordx4 v[244:247], v44, s[36:39], 0 offen offset:16 sc1
    v_mfma_f32_16x16x32_bf16 v[156:159], a[44:47], v[52:55], v[156:159]
    ds_read_b128 a[28:31], v16 offset:21504
    v_mfma_f32_16x16x32_bf16 v[152:155], a[44:47], v[48:51], v[152:155]
    s_waitcnt lgkmcnt(4)
    v_mfma_f32_16x16x32_bf16 v[160:163], a[0:3], v[48:51], v[160:163]
    ds_read_b128 a[32:35], v16 offset:24576
    v_mfma_f32_16x16x32_bf16 v[164:167], a[0:3], v[52:55], v[164:167]
    buffer_load_dwordx4 v[248:251], v44, s[36:39], s40 offen offset:0 sc1
    v_mfma_f32_16x16x32_bf16 v[172:175], a[4:7], v[52:55], v[172:175]
    ds_read_b128 a[36:39], v16 offset:25600
    v_mfma_f32_16x16x32_bf16 v[168:171], a[4:7], v[48:51], v[168:171]
    v_mfma_f32_16x16x32_bf16 v[176:179], a[8:11], v[48:51], v[176:179]
    ds_read_b128 a[40:43], v16 offset:2048
    v_mfma_f32_16x16x32_bf16 v[180:183], a[8:11], v[52:55], v[180:183]
    buffer_load_dwordx4 v[252:255], v44, s[36:39], s40 offen offset:16 sc1
    v_mfma_f32_16x16x32_bf16 v[188:191], a[12:15], v[52:55], v[188:191]
    ds_read_b128 a[44:47], v16 offset:3072
    v_mfma_f32_16x16x32_bf16 v[184:187], a[12:15], v[48:51], v[184:187]
    s_waitcnt lgkmcnt(4)
    v_mfma_f32_16x16x32_bf16 v[192:195], a[16:19], v[48:51], v[192:195]
    ds_read_b128 a[0:3], v16 offset:6144
    v_mfma_f32_16x16x32_bf16 v[196:199], a[16:19], v[52:55], v[196:199]
    buffer_load_dwordx4 v[24:27], v45, s[36:39], s41 offen offset:0 sc1
    v_mfma_f32_16x16x32_bf16 v[204:207], a[20:23], v[52:55], v[204:207]
    ds_read_b128 a[4:7], v16 offset:7168
    v_mfma_f32_16x16x32_bf16 v[200:203], a[20:23], v[48:51], v[200:203]
    v_mfma_f32_16x16x32_bf16 v[208:211], a[24:27], v[48:51], v[208:211]
    ds_read_b128 a[8:11], v16 offset:10240
    v_mfma_f32_16x16x32_bf16 v[212:215], a[24:27], v[52:55], v[212:215]
    buffer_load_dwordx4 v[28:31], v45, s[36:39], s41 offen offset:16 sc1
    v_mfma_f32_16x16x32_bf16 v[220:223], a[28:31], v[52:55], v[220:223]
    ds_read_b128 a[12:15], v16 offset:11264
    v_mfma_f32_16x16x32_bf16 v[216:219], a[28:31], v[48:51], v[216:219]
    s_waitcnt lgkmcnt(4)
    v_mfma_f32_16x16x32_bf16 v[224:227], a[32:35], v[48:51], v[224:227]
    ds_read_b128 a[16:19], v16 offset:14336
    v_mfma_f32_16x16x32_bf16 v[228:231], a[32:35], v[52:55], v[228:231]
    v_swap_b32 v58, v60
    v_swap_b32 v59, v61
    v_mfma_f32_16x16x32_bf16 v[236:239], a[36:39], v[52:55], v[236:239]
    ds_read_b128 a[20:23], v16 offset:15360
    v_mfma_f32_16x16x32_bf16 v[232:235], a[36:39], v[48:51], v[232:235]
    v_mfma_f32_16x16x32_bf16 v[128:131], a[40:43], v[56:59], v[128:131]
    ds_read_b128 a[24:27], v16 offset:18432
    v_mfma_f32_16x16x32_bf16 v[132:135], a[40:43], v[60:63], v[132:135]
    buffer_load_dwordx4 v[108:111], v6, s[20:23], s10 offen sc1
    v_mfma_f32_16x16x32_bf16 v[140:143], a[44:47], v[60:63], v[140:143]
    ds_read_b128 a[28:31], v16 offset:19456
    v_mfma_f32_16x16x32_bf16 v[136:139], a[44:47], v[56:59], v[136:139]
    s_waitcnt lgkmcnt(4)
    v_mfma_f32_16x16x32_bf16 v[144:147], a[0:3], v[56:59], v[144:147]
    ds_read_b128 a[32:35], v16 offset:22528
    s_add_u32 s10, s10, 131072
    v_mfma_f32_16x16x32_bf16 v[148:151], a[0:3], v[60:63], v[148:151]
    buffer_load_dwordx4 v[112:115], v5, s[20:23], s10 offen sc1
    v_mfma_f32_16x16x32_bf16 v[156:159], a[4:7], v[60:63], v[156:159]
    ds_read_b128 a[36:39], v16 offset:23552
    v_mfma_f32_16x16x32_bf16 v[152:155], a[4:7], v[56:59], v[152:155]
    v_mfma_f32_16x16x32_bf16 v[160:163], a[8:11], v[56:59], v[160:163]
    ds_read_b128 a[40:43], v16 offset:26624
    v_mfma_f32_16x16x32_bf16 v[164:167], a[8:11], v[60:63], v[164:167]
    buffer_load_dwordx4 v[116:119], v6, s[20:23], s10 offen sc1
    v_mfma_f32_16x16x32_bf16 v[172:175], a[12:15], v[60:63], v[172:175]
    ds_read_b128 a[44:47], v16 offset:27648
    v_mfma_f32_16x16x32_bf16 v[168:171], a[12:15], v[56:59], v[168:171]
    s_waitcnt vmcnt(21)
    s_barrier
    s_waitcnt lgkmcnt(4)
    v_mfma_f32_16x16x32_bf16 v[176:179], a[16:19], v[56:59], v[176:179]
    ds_read_b128 a[0:3], v16 offset:28672
    s_add_u32 s10, s10, 131072
    v_mfma_f32_16x16x32_bf16 v[180:183], a[16:19], v[60:63], v[180:183]
    buffer_load_dwordx4 v[120:123], v5, s[20:23], s10 offen sc1
    v_mfma_f32_16x16x32_bf16 v[188:191], a[20:23], v[60:63], v[188:191]
    ds_read_b128 a[4:7], v16 offset:29696
    v_mfma_f32_16x16x32_bf16 v[184:187], a[20:23], v[56:59], v[184:187]
    v_mfma_f32_16x16x32_bf16 v[192:195], a[24:27], v[56:59], v[192:195]
    ds_read_b128 a[8:11], v16 offset:32768
    v_mfma_f32_16x16x32_bf16 v[196:199], a[24:27], v[60:63], v[196:199]
    buffer_load_dwordx4 v[124:127], v6, s[20:23], s10 offen sc1
    v_mfma_f32_16x16x32_bf16 v[204:207], a[28:31], v[60:63], v[204:207]
    ds_read_b128 a[12:15], v16 offset:33792
    v_mfma_f32_16x16x32_bf16 v[200:203], a[28:31], v[56:59], v[200:203]
    s_waitcnt lgkmcnt(4)
    v_mfma_f32_16x16x32_bf16 v[208:211], a[32:35], v[56:59], v[208:211]
    ds_read_b128 a[16:19], v16 offset:36864
    s_add_u32 m0, s9, 0
    v_mfma_f32_16x16x32_bf16 v[212:215], a[32:35], v[60:63], v[212:215]
    s_add_u32 s14, s8, 4096
    v_mfma_f32_16x16x32_bf16 v[220:223], a[36:39], v[60:63], v[220:223]
    ds_read_b128 a[20:23], v16 offset:37888
    buffer_load_dwordx4 v7, s[24:27], s14 offen sc1 lds
    v_mfma_f32_16x16x32_bf16 v[216:219], a[36:39], v[56:59], v[216:219]
    v_mfma_f32_16x16x32_bf16 v[224:227], a[40:43], v[56:59], v[224:227]
    ds_read_b128 a[24:27], v16 offset:40960
    v_mfma_f32_16x16x32_bf16 v[228:231], a[40:43], v[60:63], v[228:231]
    v_swap_b32 v66, v68
    v_swap_b32 v67, v69
    v_mfma_f32_16x16x32_bf16 v[236:239], a[44:47], v[60:63], v[236:239]
    ds_read_b128 a[28:31], v16 offset:41984
    v_mfma_f32_16x16x32_bf16 v[232:235], a[44:47], v[56:59], v[232:235]
    s_waitcnt lgkmcnt(4)
    v_mfma_f32_16x16x32_bf16 v[128:131], a[0:3], v[64:67], v[128:131]
    ds_read_b128 a[32:35], v16 offset:45056
    s_add_u32 m0, s9, 28672
    v_mfma_f32_16x16x32_bf16 v[132:135], a[0:3], v[68:71], v[132:135]
    s_add_u32 s15, s14, 4096
    v_mfma_f32_16x16x32_bf16 v[140:143], a[4:7], v[68:71], v[140:143]
    ds_read_b128 a[36:39], v16 offset:46080
    buffer_load_dwordx4 v7, s[24:27], s15 offen sc1 lds
    v_mfma_f32_16x16x32_bf16 v[136:139], a[4:7], v[64:67], v[136:139]
    v_mfma_f32_16x16x32_bf16 v[144:147], a[8:11], v[64:67], v[144:147]
    ds_read_b128 a[40:43], v16 offset:49152
    s_add_u32 m0, s9, 4096
    v_mfma_f32_16x16x32_bf16 v[148:151], a[8:11], v[68:71], v[148:151]
    buffer_load_dwordx4 v8, s[24:27], s14 offen sc1 lds
    v_mfma_f32_16x16x32_bf16 v[156:159], a[12:15], v[68:71], v[156:159]
    ds_read_b128 a[44:47], v16 offset:50176
    v_mfma_f32_16x16x32_bf16 v[152:155], a[12:15], v[64:67], v[152:155]
    s_waitcnt lgkmcnt(4)
    v_mfma_f32_16x16x32_bf16 v[160:163], a[16:19], v[64:67], v[160:163]
    ds_read_b128 a[0:3], v16 offset:53248
    s_add_u32 m0, s9, 32768
    v_mfma_f32_16x16x32_bf16 v[164:167], a[16:19], v[68:71], v[164:167]
    buffer_load_dwordx4 v8, s[24:27], s15 offen sc1 lds
    v_mfma_f32_16x16x32_bf16 v[172:175], a[20:23], v[68:71], v[172:175]
    ds_read_b128 a[4:7], v16 offset:54272
    v_mfma_f32_16x16x32_bf16 v[168:171], a[20:23], v[64:67], v[168:171]
    v_mfma_f32_16x16x32_bf16 v[176:179], a[24:27], v[64:67], v[176:179]
    ds_read_b128 a[8:11], v16 offset:30720
    s_add_u32 m0, s9, 8192
    v_mfma_f32_16x16x32_bf16 v[180:183], a[24:27], v[68:71], v[180:183]
    buffer_load_dwordx4 v9, s[24:27], s14 offen sc1 lds
    s_waitcnt vmcnt(10)
    v_min3_u32 v32, v242, v246, v250
    v_mfma_f32_16x16x32_bf16 v[188:191], a[28:31], v[68:71], v[188:191]
    ds_read_b128 a[12:15], v16 offset:31744
    v_max3_u32 v33, v242, v246, v250
    v_mfma_f32_16x16x32_bf16 v[184:187], a[28:31], v[64:67], v[184:187]
    v_min3_u32 v32, v32, v254, v26
    v_max3_u32 v33, v33, v254, v26
    s_waitcnt lgkmcnt(4)
    v_mfma_f32_16x16x32_bf16 v[192:195], a[32:35], v[64:67], v[192:195]
    ds_read_b128 a[16:19], v16 offset:34816
    s_add_u32 m0, s9, 36864
    v_mfma_f32_16x16x32_bf16 v[196:199], a[32:35], v[68:71], v[196:199]
    buffer_load_dwordx4 v9, s[24:27], s15 offen sc1 lds
    v_min_u32 v32, v32, v30
    v_mfma_f32_16x16x32_bf16 v[204:207], a[36:39], v[68:71], v[204:207]
    ds_read_b128 a[20:23], v16 offset:35840
    v_max_u32 v33, v33, v30
    v_mfma_f32_16x16x32_bf16 v[200:203], a[36:39], v[64:67], v[200:203]
    v_xor_b32 v32, s64, v32
    v_xor_b32 v33, s64, v33
    v_mfma_f32_16x16x32_bf16 v[208:211], a[40:43], v[64:67], v[208:211]
    ds_read_b128 a[24:27], v16 offset:38912
    s_add_u32 m0, s9, 12288
    v_mfma_f32_16x16x32_bf16 v[212:215], a[40:43], v[68:71], v[212:215]
    buffer_load_dwordx4 v10, s[24:27], s14 offen sc1 lds
    v_or_b32 v32, v32, v33
    v_mfma_f32_16x16x32_bf16 v[220:223], a[44:47], v[68:71], v[220:223]
    ds_read_b128 a[28:31], v16 offset:39936
    v_cmp_gt_u32 s[68:69], 2, v4
    v_mfma_f32_16x16x32_bf16 v[216:219], a[44:47], v[64:67], v[216:219]
    v_cmp_ne_u32 vcc, 0, v32
    s_cbranch_vccz L_pgok
    s_mov_b32 s66, 0x8000
    s_branch L_gf_35
L_gl_32:
    s_sleep 2
L_gf_35:
    buffer_load_dwordx4 v[240:243], v44, s[36:39], 0 offen offset:0 sc1
    buffer_load_dwordx4 v[244:247], v44, s[36:39], 0 offen offset:16 sc1
    buffer_load_dwordx4 v[248:251], v44, s[36:39], s40 offen offset:0 sc1
    buffer_load_dwordx4 v[252:255], v44, s[36:39], s40 offen offset:16 sc1
    buffer_load_dwordx4 v[24:27], v45, s[36:39], s41 offen offset:0 sc1
    buffer_load_dwordx4 v[28:31], v45, s[36:39], s41 offen offset:16 sc1
L_gc_33:
    s_sub_u32 s66, s66, 1
    s_cmp_eq_u32 s66, 0
    s_waitcnt vmcnt(0)
    s_cbranch_scc1 L_gd_34
    v_cmp_ne_u32 vcc, s64, v242
    s_cbranch_vccnz L_gl_32
    v_cmp_ne_u32 vcc, s64, v246
    s_cbranch_vccnz L_gl_32
    v_cmp_ne_u32 vcc, s64, v250
    s_cbranch_vccnz L_gl_32
    v_cmp_ne_u32 vcc, s64, v254
    s_cbranch_vccnz L_gl_32
    v_cmp_ne_u32 vcc, s64, v26
    s_cbranch_vccnz L_gl_32
    v_cmp_ne_u32 vcc, s64, v30
    s_cbranch_vccnz L_gl_32
L_gd_34:
L_pgok:
    s_waitcnt lgkmcnt(4)
    v_mfma_f32_16x16x32_bf16 v[224:227], a[0:3], v[64:67], v[224:227]
    ds_read_b128 a[32:35], v16 offset:43008
    v_cndmask_b32 v24, 0, v24, s[68:69]
    v_mfma_f32_16x16x32_bf16 v[228:231], a[0:3], v[68:71], v[228:231]
    v_swap_b32 v74, v76
    v_swap_b32 v75, v77
    v_mfma_f32_16x16x32_bf16 v[236:239], a[4:7], v[68:71], v[236:239]
    ds_read_b128 a[36:39], v16 offset:44032
    v_add_f32 v240, v240, v248
    v_mfma_f32_16x16x32_bf16 v[232:235], a[4:7], v[64:67], v[232:235]
    v_add_f32 v240, v240, v24
    v_cndmask_b32 v25, 0, v25, s[68:69]
    v_mfma_f32_16x16x32_bf16 v[128:131], a[8:11], v[72:75], v[128:131]
    ds_read_b128 a[40:43], v16 offset:47104
    s_add_u32 m0, s9, 40960
    v_mfma_f32_16x16x32_bf16 v[132:135], a[8:11], v[76:79], v[132:135]
    buffer_load_dwordx4 v10, s[24:27], s15 offen sc1 lds
    v_add_f32 v241, v241, v249
    v_mfma_f32_16x16x32_bf16 v[140:143], a[12:15], v[76:79], v[140:143]
    ds_read_b128 a[44:47], v16 offset:48128
    v_add_f32 v241, v241, v25
    v_mfma_f32_16x16x32_bf16 v[136:139], a[12:15], v[72:75], v[136:139]
    v_cndmask_b32 v28, 0, v28, s[68:69]
    v_add_f32 v244, v244, v252
    s_waitcnt lgkmcnt(4)
    v_mfma_f32_16x16x32_bf16 v[144:147], a[16:19], v[72:75], v[144:147]
    ds_read_b128 a[0:3], v16 offset:51200
    s_add_u32 m0, s9, 16384
    v_mfma_f32_16x16x32_bf16 v[148:151], a[16:19], v[76:79], v[148:151]
    buffer_load_dwordx4 v11, s[24:27], s14 offen sc1 lds
    v_add_f32 v244, v244, v28
    v_mfma_f32_16x16x32_bf16 v[156:159], a[20:23], v[76:79], v[156:159]
    ds_read_b128 a[4:7], v16 offset:52224
    v_cndmask_b32 v29, 0, v29, s[68:69]
    v_mfma_f32_16x16x32_bf16 v[152:155], a[20:23], v[72:75], v[152:155]
    v_add_f32 v245, v245, v253
    v_add_f32 v245, v245, v29
    v_mfma_f32_16x16x32_bf16 v[160:163], a[24:27], v[72:75], v[160:163]
    ds_read_b128 a[8:11], v16 offset:55296
    s_add_u32 m0, s9, 45056
    v_mfma_f32_16x16x32_bf16 v[164:167], a[24:27], v[76:79], v[164:167]
    buffer_load_dwordx4 v11, s[24:27], s15 offen sc1 lds
    v_mov_b32 v248, v240
    v_mfma_f32_16x16x32_bf16 v[172:175], a[28:31], v[76:79], v[172:175]
    ds_read_b128 a[12:15], v16 offset:56320
    v_mov_b32 v249, v241
    v_mfma_f32_16x16x32_bf16 v[168:171], a[28:31], v[72:75], v[168:171]
    v_mov_b32 v252, v244
    v_mov_b32 v253, v245
    s_barrier
    s_waitcnt lgkmcnt(4)
    v_mfma_f32_16x16x32_bf16 v[176:179], a[32:35], v[72:75], v[176:179]
    ds_read_b128 a[16:19], v17 offset:0
    s_add_u32 m0, s9, 20480
    v_mfma_f32_16x16x32_bf16 v[180:183], a[32:35], v[76:79], v[180:183]
    buffer_load_dwordx4 v12, s[24:27], s14 offen sc1 lds
    s_nop 0
    v_mfma_f32_16x16x32_bf16 v[188:191], a[36:39], v[76:79], v[188:191]
    ds_read_b128 a[20:23], v17 offset:1024
    v_permlane32_swap_b32 v248, v240
    v_mfma_f32_16x16x32_bf16 v[184:187], a[36:39], v[72:75], v[184:187]
    v_permlane32_swap_b32 v249, v241
    v_permlane32_swap_b32 v252, v244
    v_mfma_f32_16x16x32_bf16 v[192:195], a[40:43], v[72:75], v[192:195]
    ds_read_b128 a[24:27], v17 offset:4096
    s_add_u32 m0, s9, 49152
    v_mfma_f32_16x16x32_bf16 v[196:199], a[40:43], v[76:79], v[196:199]
    buffer_load_dwordx4 v12, s[24:27], s15 offen sc1 lds
    v_permlane32_swap_b32 v253, v245
    v_mfma_f32_16x16x32_bf16 v[204:207], a[44:47], v[76:79], v[204:207]
    ds_read_b128 a[28:31], v17 offset:5120
    v_add_f32 v240, v240, v248
    v_mfma_f32_16x16x32_bf16 v[200:203], a[44:47], v[72:75], v[200:203]
    v_add_f32 v241, v241, v249
    v_add_f32 v244, v244, v252
    s_waitcnt lgkmcnt(4)
    v_mfma_f32_16x16x32_bf16 v[208:211], a[0:3], v[72:75], v[208:211]
    ds_read_b128 a[32:35], v17 offset:8192
    s_add_u32 m0, s9, 24576
    v_mfma_f32_16x16x32_bf16 v[212:215], a[0:3], v[76:79], v[212:215]
    buffer_load_dwordx4 v13, s[24:27], s14 offen sc1 lds
    v_add_f32 v245, v245, v253
    v_mfma_f32_16x16x32_bf16 v[220:223], a[4:7], v[76:79], v[220:223]
    ds_read_b128 a[36:39], v17 offset:9216
    v_mov_b32 v248, v240
    v_mfma_f32_16x16x32_bf16 v[216:219], a[4:7], v[72:75], v[216:219]
    v_mov_b32 v249, v241
    v_mov_b32 v252, v244
    v_mfma_f32_16x16x32_bf16 v[224:227], a[8:11], v[72:75], v[224:227]
    ds_read_b128 a[40:43], v17 offset:12288
    v_mov_b32 v253, v245
    v_mfma_f32_16x16x32_bf16 v[228:231], a[8:11], v[76:79], v[228:231]
    v_swap_b32 v82, v84
    v_swap_b32 v83, v85
    v_mfma_f32_16x16x32_bf16 v[236:239], a[12:15], v[76:79], v[236:239]
    ds_read_b128 a[44:47], v17 offset:13312
    s_nop 0
    v_mfma_f32_16x16x32_bf16 v[232:235], a[12:15], v[72:75], v[232:235]
    v_permlane16_swap_b32 v248, v240
    v_permlane16_swap_b32 v249, v241
    s_waitcnt lgkmcnt(4)
    v_mfma_f32_16x16x32_bf16 v[128:131], a[16:19], v[80:83], v[128:131]
    ds_read_b128 a[0:3], v17 offset:16384
    s_add_u32 m0, s9, 53248
    v_mfma_f32_16x16x32_bf16 v[132:135], a[16:19], v[84:87], v[132:135]
    buffer_load_dwordx4 v13, s[24:27], s15 offen sc1 lds
    v_permlane16_swap_b32 v252, v244
    v_mfma_f32_16x16x32_bf16 v[140:143], a[20:23], v[84:87], v[140:143]
    ds_read_b128 a[4:7], v17 offset:17408
    v_permlane16_swap_b32 v253, v245
    v_mfma_f32_16x16x32_bf16 v[136:139], a[20:23], v[80:83], v[136:139]
    v_add_f32 v240, v240, v248
    v_add_f32 v241, v241, v249
    v_mfma_f32_16x16x32_bf16 v[144:147], a[24:27], v[80:83], v[144:147]
    ds_read_b128 a[8:11], v17 offset:20480
    v_add_f32 v244, v244, v252
    v_mfma_f32_16x16x32_bf16 v[148:151], a[24:27], v[84:87], v[148:151]
    buffer_load_dwordx4 a[108:111], v15, s[52:55], s47 offen offset:3072 sc1
    v_add_f32 v245, v245, v253
    v_mfma_f32_16x16x32_bf16 v[156:159], a[28:31], v[84:87], v[156:159]
    ds_read_b128 a[12:15], v17 offset:21504
    v_mul_f32 v240, 0xbacccccd, v240
    v_mfma_f32_16x16x32_bf16 v[152:155], a[28:31], v[80:83], v[152:155]
    v_mul_f32 v241, 0x3acccccd, v241
    v_and_b32 v32, 0xffff0000, v240
    s_waitcnt lgkmcnt(4)
    v_mfma_f32_16x16x32_bf16 v[160:163], a[32:35], v[80:83], v[160:163]
    ds_read_b128 a[16:19], v17 offset:24576
    v_sub_f32 v33, v240, v32
    v_mfma_f32_16x16x32_bf16 v[164:167], a[32:35], v[84:87], v[164:167]
    buffer_load_dwordx4 a[112:115], v15, s[52:55], s48 offen offset:3072 sc1
    v_cvt_pk_bf16_f32 v24, v32, v33
    v_mfma_f32_16x16x32_bf16 v[172:175], a[36:39], v[84:87], v[172:175]
    ds_read_b128 a[20:23], v17 offset:25600
    v_mov_b32 v25, v24
    v_mfma_f32_16x16x32_bf16 v[168:171], a[36:39], v[80:83], v[168:171]
    v_fma_f32 v241, -v240, v240, v241
    v_max_f32 v241, 0, v241
    v_mfma_f32_16x16x32_bf16 v[176:179], a[40:43], v[80:83], v[176:179]
    ds_read_b128 a[24:27], v17 offset:2048
    v_add_f32 v241, 0x3727c5ac, v241
    v_mfma_f32_16x16x32_bf16 v[180:183], a[40:43], v[84:87], v[180:183]
    buffer_load_dwordx4 a[116:119], v15, s[52:55], s49 offen offset:3072 sc1
    v_sqrt_f32 v34, v241
    v_mfma_f32_16x16x32_bf16 v[188:191], a[44:47], v[84:87], v[188:191]
    ds_read_b128 a[28:31], v17 offset:3072
    v_rcp_f32 v18, v241
    v_mfma_f32_16x16x32_bf16 v[184:187], a[44:47], v[80:83], v[184:187]
    v_and_b32 v33, 0xffff0000, v34
    v_sub_f32 v34, v34, v33
    s_waitcnt lgkmcnt(4)
    v_mfma_f32_16x16x32_bf16 v[192:195], a[0:3], v[80:83], v[192:195]
    ds_read_b128 a[32:35], v17 offset:6144
    v_cvt_pk_bf16_f32 v26, v33, v34
    v_mfma_f32_16x16x32_bf16 v[196:199], a[0:3], v[84:87], v[196:199]
    buffer_load_dwordx4 a[120:123], v15, s[52:55], s50 offen offset:3072 sc1
    v_mov_b32 v27, v26
    v_mfma_f32_16x16x32_bf16 v[204:207], a[4:7], v[84:87], v[204:207]
    ds_read_b128 a[36:39], v17 offset:7168
    v_mul_f32 v244, 0xbacccccd, v244
    v_mfma_f32_16x16x32_bf16 v[200:203], a[4:7], v[80:83], v[200:203]
    v_mul_f32 v245, 0x3acccccd, v245
    v_and_b32 v32, 0xffff0000, v244
    v_mfma_f32_16x16x32_bf16 v[208:211], a[8:11], v[80:83], v[208:211]
    ds_read_b128 a[40:43], v17 offset:10240
    v_sub_f32 v33, v244, v32
    v_mfma_f32_16x16x32_bf16 v[212:215], a[8:11], v[84:87], v[212:215]
    buffer_load_dwordx4 a[124:127], v15, s[52:55], s51 offen offset:3072 sc1
    v_cvt_pk_bf16_f32 v28, v32, v33
    v_mfma_f32_16x16x32_bf16 v[220:223], a[12:15], v[84:87], v[220:223]
    ds_read_b128 a[44:47], v17 offset:11264
    v_mov_b32 v29, v28
    v_mfma_f32_16x16x32_bf16 v[216:219], a[12:15], v[80:83], v[216:219]
    v_fma_f32 v245, -v244, v244, v245
    v_max_f32 v245, 0, v245
    s_waitcnt lgkmcnt(4)
    v_mfma_f32_16x16x32_bf16 v[224:227], a[16:19], v[80:83], v[224:227]
    ds_read_b128 a[0:3], v17 offset:14336
    v_add_f32 v245, 0x3727c5ac, v245
    v_mfma_f32_16x16x32_bf16 v[228:231], a[16:19], v[84:87], v[228:231]
    v_swap_b32 v90, v92
    v_swap_b32 v91, v93
    v_mfma_f32_16x16x32_bf16 v[236:239], a[20:23], v[84:87], v[236:239]
    ds_read_b128 a[4:7], v17 offset:15360
    v_sqrt_f32 v34, v245
    v_mfma_f32_16x16x32_bf16 v[232:235], a[20:23], v[80:83], v[232:235]
    v_rcp_f32 v19, v245
    v_and_b32 v33, 0xffff0000, v34
    v_mfma_f32_16x16x32_bf16 v[128:131], a[24:27], v[88:91], v[128:131]
    ds_read_b128 a[8:11], v17 offset:18432
    v_sub_f32 v34, v34, v33
    v_mfma_f32_16x16x32_bf16 v[132:135], a[24:27], v[92:95], v[132:135]
    buffer_load_dwordx4 a[128:131], v37, s[52:55], s47 offen offset:0 sc1
    v_cvt_pk_bf16_f32 v30, v33, v34
    v_mfma_f32_16x16x32_bf16 v[140:143], a[28:31], v[92:95], v[140:143]
    ds_read_b128 a[12:15], v17 offset:19456
    v_mov_b32 v31, v30
    v_mfma_f32_16x16x32_bf16 v[136:139], a[28:31], v[88:91], v[136:139]
    s_waitcnt lgkmcnt(4)
    v_mfma_f32_16x16x32_bf16 v[144:147], a[32:35], v[88:91], v[144:147]
    ds_read_b128 a[16:19], v17 offset:22528
    v_mfma_f32_16x16x32_bf16 v[148:151], a[32:35], v[92:95], v[148:151]
    buffer_load_dwordx4 a[132:135], v37, s[52:55], s48 offen offset:0 sc1
    v_mfma_f32_16x16x32_bf16 v[156:159], a[36:39], v[92:95], v[156:159]
    ds_read_b128 a[20:23], v17 offset:23552
    v_mfma_f32_16x16x32_bf16 v[152:155], a[36:39], v[88:91], v[152:155]
    v_mfma_f32_16x16x32_bf16 v[160:163], a[40:43], v[88:91], v[160:163]
    ds_read_b128 a[24:27], v17 offset:26624
    v_mfma_f32_16x16x32_bf16 v[164:167], a[40:43], v[92:95], v[164:167]
    buffer_load_dwordx4 a[136:139], v37, s[52:55], s49 offen offset:0 sc1
    v_mfma_f32_16x16x32_bf16 v[172:175], a[44:47], v[92:95], v[172:175]
    ds_read_b128 a[28:31], v17 offset:27648
    v_mfma_f32_16x16x32_bf16 v[168:171], a[44:47], v[88:91], v[168:171]
    s_waitcnt vmcnt(18)
    s_barrier
    s_waitcnt lgkmcnt(4)
    v_mfma_f32_16x16x32_bf16 v[176:179], a[0:3], v[88:91], v[176:179]
    ds_read_b128 a[32:35], v46 offset:28672
    v_mfma_f32_16x16x32_bf16 v[180:183], a[0:3], v[92:95], v[180:183]
    buffer_load_dwordx4 a[140:143], v37, s[52:55], s50 offen offset:0 sc1
    v_mfma_f32_16x16x32_bf16 v[188:191], a[4:7], v[92:95], v[188:191]
    ds_read_b128 a[36:39], v46 offset:29696
    v_mfma_f32_16x16x32_bf16 v[184:187], a[4:7], v[88:91], v[184:187]
    v_mfma_f32_16x16x32_bf16 v[192:195], a[8:11], v[88:91], v[192:195]
    ds_read_b128 a[40:43], v15 offset:0
    v_mfma_f32_16x16x32_bf16 v[196:199], a[8:11], v[92:95], v[196:199]
    buffer_load_dwordx4 a[144:147], v37, s[52:55], s51 offen offset:0 sc1
    v_mfma_f32_16x16x32_bf16 v[204:207], a[12:15], v[92:95], v[204:207]
    ds_read_b128 a[44:47], v15 offset:1024
    v_mfma_f32_16x16x32_bf16 v[200:203], a[12:15], v[88:91], v[200:203]
    s_waitcnt lgkmcnt(4)
    v_mfma_f32_16x16x32_bf16 v[208:211], a[16:19], v[88:91], v[208:211]
    ds_read_b128 a[0:3], v15 offset:2048
    v_mfma_f32_16x16x32_bf16 v[212:215], a[16:19], v[92:95], v[212:215]
    buffer_load_dwordx4 a[148:151], v37, s[52:55], s47 offen offset:1024 sc1
    v_mfma_f32_16x16x32_bf16 v[220:223], a[20:23], v[92:95], v[220:223]
    ds_read_b128 a[4:7], v15 offset:3072
    v_mfma_f32_16x16x32_bf16 v[216:219], a[20:23], v[88:91], v[216:219]
    v_mfma_f32_16x16x32_bf16 v[224:227], a[24:27], v[88:91], v[224:227]
    ds_read_b128 a[8:11], v15 offset:28672
    v_mfma_f32_16x16x32_bf16 v[228:231], a[24:27], v[92:95], v[228:231]
    v_swap_b32 v98, v100
    v_swap_b32 v99, v101
    v_mfma_f32_16x16x32_bf16 v[236:239], a[28:31], v[92:95], v[236:239]
    ds_read_b128 a[12:15], v15 offset:29696
    v_mfma_f32_16x16x32_bf16 v[232:235], a[28:31], v[88:91], v[232:235]
    s_nop 1
    s_waitcnt lgkmcnt(4)
    v_mfma_f32_16x16x32_bf16 v[128:131], a[32:35], v[24:27], v[128:131]
    ds_read_b128 a[16:19], v15 offset:30720
    v_mfma_f32_16x16x32_bf16 v[132:135], a[32:35], v[28:31], v[132:135]
    buffer_load_dwordx4 a[152:155], v37, s[52:55], s48 offen offset:1024 sc1
    v_swap_b32 v106, v108
    v_swap_b32 v107, v109
    v_mfma_f32_16x16x32_bf16 v[140:143], a[36:39], v[28:31], v[140:143]
    ds_read_b128 a[20:23], v15 offset:31744
    v_mfma_f32_16x16x32_bf16 v[136:139], a[36:39], v[24:27], v[136:139]
    v_mfma_f32_16x16x32_bf16 v[128:131], a[40:43], v[96:99], v[128:131]
    ds_read_b128 a[24:27], v46 offset:30720
    v_mfma_f32_16x16x32_bf16 v[132:135], a[40:43], v[100:103], v[132:135]
    buffer_load_dwordx4 a[156:159], v37, s[52:55], s49 offen offset:1024 sc1
    v_swap_b32 v114, v116
    v_swap_b32 v115, v117
    v_mfma_f32_16x16x32_bf16 v[140:143], a[44:47], v[100:103], v[140:143]
    ds_read_b128 a[28:31], v46 offset:31744
    v_mfma_f32_16x16x32_bf16 v[136:139], a[44:47], v[96:99], v[136:139]
    s_waitcnt lgkmcnt(4)
    v_mfma_f32_16x16x32_bf16 v[128:131], a[0:3], v[104:107], v[128:131]
    ds_read_b128 a[32:35], v15 offset:4096
    v_mfma_f32_16x16x32_bf16 v[132:135], a[0:3], v[108:111], v[132:135]
    buffer_load_dwordx4 a[160:163], v37, s[52:55], s50 offen offset:1024 sc1
    v_swap_b32 v122, v124
    v_swap_b32 v123, v125
    v_mfma_f32_16x16x32_bf16 v[140:143], a[4:7], v[108:111], v[140:143]
    ds_read_b128 a[36:39], v15 offset:5120
    v_mfma_f32_16x16x32_bf16 v[136:139], a[4:7], v[104:107], v[136:139]
    v_mfma_f32_16x16x32_bf16 v[128:131], a[8:11], v[112:115], v[128:131]
    ds_read_b128 a[40:43], v15 offset:6144
    v_mfma_f32_16x16x32_bf16 v[132:135], a[8:11], v[116:119], v[132:135]
    buffer_load_dwordx4 a[164:167], v37, s[52:55], s51 offen offset:1024 sc1
    v_mfma_f32_16x16x32_bf16 v[140:143], a[12:15], v[116:119], v[140:143]
    ds_read_b128 a[44:47], v15 offset:7168
    v_mfma_f32_16x16x32_bf16 v[136:139], a[12:15], v[112:115], v[136:139]
    s_waitcnt lgkmcnt(4)
    v_mfma_f32_16x16x32_bf16 v[128:131], a[16:19], v[120:123], v[128:131]
    ds_read_b128 a[0:3], v15 offset:32768
    v_mfma_f32_16x16x32_bf16 v[132:135], a[16:19], v[124:127], v[132:135]
    buffer_load_dwordx4 a[168:171], v37, s[52:55], s47 offen offset:2048 sc1
    v_mfma_f32_16x16x32_bf16 v[140:143], a[20:23], v[124:127], v[140:143]
    ds_read_b128 a[4:7], v15 offset:33792
    v_mfma_f32_16x16x32_bf16 v[136:139], a[20:23], v[120:123], v[136:139]
    v_mfma_f32_16x16x32_bf16 v[144:147], a[24:27], v[24:27], v[144:147]
    ds_read_b128 a[8:11], v15 offset:34816
    v_mfma_f32_16x16x32_bf16 v[148:151], a[24:27], v[28:31], v[148:151]
    buffer_load_dwordx4 a[172:175], v37, s[52:55], s48 offen offset:2048 sc1
    v_mfma_f32_16x16x32_bf16 v[156:159], a[28:31], v[28:31], v[156:159]
    ds_read_b128 a[12:15], v15 offset:35840
    v_mfma_f32_16x16x32_bf16 v[152:155], a[28:31], v[24:27], v[152:155]
    s_waitcnt vmcnt(23)
    s_barrier
    s_waitcnt lgkmcnt(4)
    v_mfma_f32_16x16x32_bf16 v[144:147], a[32:35], v[96:99], v[144:147]
    ds_read_b128 a[16:19], v46 offset:32768
    v_max_f32 v128, 0, v128
    v_mfma_f32_16x16x32_bf16 v[148:151], a[32:35], v[100:103], v[148:151]
    buffer_load_dwordx4 a[176:179], v37, s[52:55], s49 offen offset:2048 sc1
    v_max_f32 v129, 0, v129
    v_max_f32 v130, 0, v130
    v_mfma_f32_16x16x32_bf16 v[156:159], a[36:39], v[100:103], v[156:159]
    ds_read_b128 a[20:23], v46 offset:33792
    v_max_f32 v131, 0, v131
    v_mfma_f32_16x16x32_bf16 v[152:155], a[36:39], v[96:99], v[152:155]
    v_max_f32 v132, 0, v132
    v_max_f32 v133, 0, v133
    v_max_f32 v134, 0, v134
    v_mfma_f32_16x16x32_bf16 v[144:147], a[40:43], v[104:107], v[144:147]
    ds_read_b128 a[24:27], v15 offset:8192
    v_max_f32 v135, 0, v135
    v_mfma_f32_16x16x32_bf16 v[148:151], a[40:43], v[108:111], v[148:151]
    buffer_load_dwordx4 a[180:183], v37, s[52:55], s50 offen offset:2048 sc1
    v_mul_f32 v136, v18, v136
    v_mul_f32 v137, v18, v137
    v_mfma_f32_16x16x32_bf16 v[156:159], a[44:47], v[108:111], v[156:159]
    ds_read_b128 a[28:31], v15 offset:9216
    v_mul_f32 v138, v18, v138
    v_mfma_f32_16x16x32_bf16 v[152:155], a[44:47], v[104:107], v[152:155]
    v_mul_f32 v139, v18, v139
    v_mul_f32 v140, v19, v140
    v_mul_f32 v141, v19, v141
    s_waitcnt lgkmcnt(4)
    v_mfma_f32_16x16x32_bf16 v[144:147], a[0:3], v[112:115], v[144:147]
    ds_read_b128 a[32:35], v15 offset:10240
    v_mul_f32 v142, v19, v142
    v_mfma_f32_16x16x32_bf16 v[148:151], a[0:3], v[116:119], v[148:151]
    buffer_load_dwordx4 a[184:187], v37, s[52:55], s51 offen offset:2048 sc1
    v_mul_f32 v143, v19, v143
    v_mul_f32 v128, v128, v136
    v_mfma_f32_16x16x32_bf16 v[156:159], a[4:7], v[116:119], v[156:159]
    ds_read_b128 a[36:39], v15 offset:11264
    v_mul_f32 v129, v129, v137
    v_mfma_f32_16x16x32_bf16 v[152:155], a[4:7], v[112:115], v[152:155]
    v_mul_f32 v130, v130, v138
    v_mul_f32 v131, v131, v139
    v_mul_f32 v132, v132, v140
    v_mfma_f32_16x16x32_bf16 v[144:147], a[8:11], v[120:123], v[144:147]
    ds_read_b128 a[40:43], v15 offset:36864
    v_mul_f32 v133, v133, v141
    v_mfma_f32_16x16x32_bf16 v[148:151], a[8:11], v[124:127], v[148:151]
    buffer_load_dwordx4 a[188:191], v37, s[52:55], s47 offen offset:3072 sc1
    v_mul_f32 v134, v134, v142
    v_mul_f32 v135, v135, v143
    v_mfma_f32_16x16x32_bf16 v[156:159], a[12:15], v[124:127], v[156:159]
    ds_read_b128 a[44:47], v15 offset:37888
    v_cvt_pk_bf16_f32 v248, v128, v129
    v_mfma_f32_16x16x32_bf16 v[152:155], a[12:15], v[120:123], v[152:155]
    v_cvt_pk_bf16_f32 v249, v130, v131
    v_cvt_pk_bf16_f32 v250, v132, v133
    s_waitcnt lgkmcnt(4)
    v_mfma_f32_16x16x32_bf16 v[160:163], a[16:19], v[24:27], v[160:163]
    ds_read_b128 a[0:3], v15 offset:38912
    v_cvt_pk_bf16_f32 v251, v134, v135
    v_mfma_f32_16x16x32_bf16 v[164:167], a[16:19], v[28:31], v[164:167]
    buffer_load_dwordx4 a[192:195], v37, s[52:55], s48 offen offset:3072 sc1
    s_nop 0
    v_mfma_f32_16x16x32_bf16 v[172:175], a[20:23], v[28:31], v[172:175]
    ds_read_b128 a[4:7], v15 offset:39936
    v_permlane32_swap_b32 v248, v250
    v_mfma_f32_16x16x32_bf16 v[168:171], a[20:23], v[24:27], v[168:171]
    v_permlane32_swap_b32 v249, v251
    buffer_store_dwordx4 v[248:251], v14, s[32:35], s13 offen offset:0 sc1
    v_mfma_f32_16x16x32_bf16 v[160:163], a[24:27], v[96:99], v[160:163]
    ds_read_b128 a[8:11], v46 offset:34816
    v_max_f32 v144, 0, v144
    v_mfma_f32_16x16x32_bf16 v[164:167], a[24:27], v[100:103], v[164:167]
    buffer_load_dwordx4 a[196:199], v37, s[52:55], s49 offen offset:3072 sc1
    v_max_f32 v145, 0, v145
    v_max_f32 v146, 0, v146
    v_mfma_f32_16x16x32_bf16 v[172:175], a[28:31], v[100:103], v[172:175]
    ds_read_b128 a[12:15], v46 offset:35840
    v_max_f32 v147, 0, v147
    v_mfma_f32_16x16x32_bf16 v[168:171], a[28:31], v[96:99], v[168:171]
    v_max_f32 v148, 0, v148
    v_max_f32 v149, 0, v149
    v_max_f32 v150, 0, v150
    s_waitcnt lgkmcnt(4)
    v_mfma_f32_16x16x32_bf16 v[160:163], a[32:35], v[104:107], v[160:163]
    ds_read_b128 a[16:19], v15 offset:12288
    v_max_f32 v151, 0, v151
    v_mfma_f32_16x16x32_bf16 v[164:167], a[32:35], v[108:111], v[164:167]
    buffer_load_dwordx4 a[200:203], v37, s[52:55], s50 offen offset:3072 sc1
    v_mul_f32 v152, v18, v152
    v_mul_f32 v153, v18, v153
    v_mfma_f32_16x16x32_bf16 v[172:175], a[36:39], v[108:111], v[172:175]
    ds_read_b128 a[20:23], v15 offset:13312
    v_mul_f32 v154, v18, v154
    v_mfma_f32_16x16x32_bf16 v[168:171], a[36:39], v[104:107], v[168:171]
    v_mul_f32 v155, v18, v155
    v_mul_f32 v156, v19, v156
    v_mul_f32 v157, v19, v157
    v_mfma_f32_16x16x32_bf16 v[160:163], a[40:43], v[112:115], v[160:163]
    ds_read_b128 a[24:27], v15 offset:14336
    v_mul_f32 v158, v19, v158
    v_mfma_f32_16x16x32_bf16 v[164:167], a[40:43], v[116:119], v[164:167]
    buffer_load_dwordx4 a[204:207], v37, s[52:55], s51 offen offset:3072 sc1
    v_mul_f32 v159, v19, v159
    v_mul_f32 v144, v144, v152
    v_mfma_f32_16x16x32_bf16 v[172:175], a[44:47], v[116:119], v[172:175]
    ds_read_b128 a[28:31], v15 offset:15360
    v_mul_f32 v145, v145, v153
    v_mfma_f32_16x16x32_bf16 v[168:171], a[44:47], v[112:115], v[168:171]
    v_mul_f32 v146, v146, v154
    v_mul_f32 v147, v147, v155
    v_mul_f32 v148, v148, v156
    s_waitcnt lgkmcnt(4)
    v_mfma_f32_16x16x32_bf16 v[160:163], a[0:3], v[120:123], v[160:163]
    ds_read_b128 a[32:35], v15 offset:40960
    v_mul_f32 v149, v149, v157
    v_mfma_f32_16x16x32_bf16 v[164:167], a[0:3], v[124:127], v[164:167]
    buffer_load_dwordx4 a[208:211], v38, s[52:55], s47 offen offset:0 sc1
    v_mul_f32 v150, v150, v158
    v_mul_f32 v151, v151, v159
    v_mfma_f32_16x16x32_bf16 v[172:175], a[4:7], v[124:127], v[172:175]
    ds_read_b128 a[36:39], v15 offset:41984
    v_cvt_pk_bf16_f32 v252, v144, v145
    v_mfma_f32_16x16x32_bf16 v[168:171], a[4:7], v[120:123], v[168:171]
    v_cvt_pk_bf16_f32 v253, v146, v147
    v_cvt_pk_bf16_f32 v254, v148, v149
    v_mfma_f32_16x16x32_bf16 v[176:179], a[8:11], v[24:27], v[176:179]
    ds_read_b128 a[40:43], v15 offset:43008
    v_cvt_pk_bf16_f32 v255, v150, v151
    v_mfma_f32_16x16x32_bf16 v[180:183], a[8:11], v[28:31], v[180:183]
    buffer_load_dwordx4 a[212:215], v38, s[52:55], s48 offen offset:0 sc1
    s_nop 0
    v_mfma_f32_16x16x32_bf16 v[188:191], a[12:15], v[28:31], v[188:191]
    ds_read_b128 a[44:47], v15 offset:44032
    v_permlane32_swap_b32 v252, v254
    v_mfma_f32_16x16x32_bf16 v[184:187], a[12:15], v[24:27], v[184:187]
    v_permlane32_swap_b32 v253, v255
    buffer_store_dwordx4 v[252:255], v14, s[32:35], s13 offen offset:512 sc1
    s_waitcnt vmcnt(29)
    s_barrier
    s_waitcnt lgkmcnt(4)
    v_mfma_f32_16x16x32_bf16 v[176:179], a[16:19], v[96:99], v[176:179]
    ds_read_b128 a[0:3], v46 offset:36864
    v_max_f32 v160, 0, v160
    v_mfma_f32_16x16x32_bf16 v[180:183], a[16:19], v[100:103], v[180:183]
    buffer_load_dwordx4 a[216:219], v38, s[52:55], s49 offen offset:0 sc1
    v_max_f32 v161, 0, v161
    v_max_f32 v162, 0, v162
    v_mfma_f32_16x16x32_bf16 v[188:191], a[20:23], v[100:103], v[188:191]
    ds_read_b128 a[4:7], v46 offset:37888
    v_max_f32 v163, 0, v163
    v_mfma_f32_16x16x32_bf16 v[184:187], a[20:23], v[96:99], v[184:187]
    v_max_f32 v164, 0, v164
    v_max_f32 v165, 0, v165
    v_max_f32 v166, 0, v166
    v_mfma_f32_16x16x32_bf16 v[176:179], a[24:27], v[104:107], v[176:179]
    ds_read_b128 a[8:11], v15 offset:16384
    v_max_f32 v167, 0, v167
    v_mfma_f32_16x16x32_bf16 v[180:183], a[24:27], v[108:111], v[180:183]
    buffer_load_dwordx4 a[220:223], v38, s[52:55], s50 offen offset:0 sc1
    v_mul_f32 v168, v18, v168
    v_mul_f32 v169, v18, v169
    v_mfma_f32_16x16x32_bf16 v[188:191], a[28:31], v[108:111], v[188:191]
    ds_read_b128 a[12:15], v15 offset:17408
    v_mul_f32 v170, v18, v170
    v_mfma_f32_16x16x32_bf16 v[184:187], a[28:31], v[104:107], v[184:187]
    v_mul_f32 v171, v18, v171
    v_mul_f32 v172, v19, v172
    v_mul_f32 v173, v19, v173
    s_waitcnt lgkmcnt(4)
    v_mfma_f32_16x16x32_bf16 v[176:179], a[32:35], v[112:115], v[176:179]
    ds_read_b128 a[16:19], v15 offset:18432
    v_mul_f32 v174, v19, v174
    v_mfma_f32_16x16x32_bf16 v[180:183], a[32:35], v[116:119], v[180:183]
    buffer_load_dwordx4 a[224:227], v38, s[52:55], s51 offen offset:0 sc1
    v_mul_f32 v175, v19, v175
    v_mul_f32 v160, v160, v168
    v_mfma_f32_16x16x32_bf16 v[188:191], a[36:39], v[116:119], v[188:191]
    ds_read_b128 a[20:23], v15 offset:19456
    v_mul_f32 v161, v161, v169
    v_mfma_f32_16x16x32_bf16 v[184:187], a[36:39], v[112:115], v[184:187]
    v_mul_f32 v162, v162, v170
    v_mul_f32 v163, v163, v171
    v_mul_f32 v164, v164, v172
    v_mfma_f32_16x16x32_bf16 v[176:179], a[40:43], v[120:123], v[176:179]
    ds_read_b128 a[24:27], v15 offset:45056
    v_mul_f32 v165, v165, v173
    v_mfma_f32_16x16x32_bf16 v[180:183], a[40:43], v[124:127], v[180:183]
    buffer_load_dwordx4 a[228:231], v38, s[52:55], s47 offen offset:1024 sc1
    v_mul_f32 v166, v166, v174
    v_mul_f32 v167, v167, v175
    v_mfma_f32_16x16x32_bf16 v[188:191], a[44:47], v[124:127], v[188:191]
    ds_read_b128 a[28:31], v15 offset:46080
    v_cvt_pk_bf16_f32 v248, v160, v161
    v_mfma_f32_16x16x32_bf16 v[184:187], a[44:47], v[120:123], v[184:187]
    v_cvt_pk_bf16_f32 v249, v162, v163
    v_cvt_pk_bf16_f32 v250, v164, v165
    s_waitcnt lgkmcnt(4)
    v_mfma_f32_16x16x32_bf16 v[192:195], a[0:3], v[24:27], v[192:195]
    ds_read_b128 a[32:35], v15 offset:47104
    v_cvt_pk_bf16_f32 v251, v166, v167
    v_mfma_f32_16x16x32_bf16 v[196:199], a[0:3], v[28:31], v[196:199]
    buffer_load_dwordx4 a[232:235], v38, s[52:55], s48 offen offset:1024 sc1
    s_nop 0
    v_mfma_f32_16x16x32_bf16 v[204:207], a[4:7], v[28:31], v[204:207]
    ds_read_b128 a[36:39], v15 offset:48128
    v_permlane32_swap_b32 v248, v250
    v_mfma_f32_16x16x32_bf16 v[200:203], a[4:7], v[24:27], v[200:203]
    v_permlane32_swap_b32 v249, v251
    buffer_store_dwordx4 v[248:251], v14, s[32:35], s13 offen offset:1024 sc1
    v_mfma_f32_16x16x32_bf16 v[192:195], a[8:11], v[96:99], v[192:195]
    ds_read_b128 a[40:43], v46 offset:38912
    v_max_f32 v176, 0, v176
    v_mfma_f32_16x16x32_bf16 v[196:199], a[8:11], v[100:103], v[196:199]
    buffer_load_dwordx4 a[236:239], v38, s[52:55], s49 offen offset:1024 sc1
    v_max_f32 v177, 0, v177
    v_max_f32 v178, 0, v178
    v_mfma_f32_16x16x32_bf16 v[204:207], a[12:15], v[100:103], v[204:207]
    ds_read_b128 a[44:47], v46 offset:39936
    v_max_f32 v179, 0, v179
    v_mfma_f32_16x16x32_bf16 v[200:203], a[12:15], v[96:99], v[200:203]
    v_max_f32 v180, 0, v180
    v_max_f32 v181, 0, v181
    v_max_f32 v182, 0, v182
    s_waitcnt lgkmcnt(4)
    v_mfma_f32_16x16x32_bf16 v[192:195], a[16:19], v[104:107], v[192:195]
    ds_read_b128 a[0:3], v15 offset:20480
    v_max_f32 v183, 0, v183
    v_mfma_f32_16x16x32_bf16 v[196:199], a[16:19], v[108:111], v[196:199]
    buffer_load_dwordx4 a[240:243], v38, s[52:55], s50 offen offset:1024 sc1
    v_mul_f32 v184, v18, v184
    v_mul_f32 v185, v18, v185
    v_mfma_f32_16x16x32_bf16 v[204:207], a[20:23], v[108:111], v[204:207]
    ds_read_b128 a[4:7], v15 offset:21504
    v_mul_f32 v186, v18, v186
    v_mfma_f32_16x16x32_bf16 v[200:203], a[20:23], v[104:107], v[200:203]
    v_mul_f32 v187, v18, v187
    v_mul_f32 v188, v19, v188
    v_mul_f32 v189, v19, v189
    v_mfma_f32_16x16x32_bf16 v[192:195], a[24:27], v[112:115], v[192:195]
    ds_read_b128 a[8:11], v15 offset:22528
    v_mul_f32 v190, v19, v190
    v_mfma_f32_16x16x32_bf16 v[196:199], a[24:27], v[116:119], v[196:199]
    buffer_load_dwordx4 a[244:247], v38, s[52:55], s51 offen offset:1024 sc1
    v_mul_f32 v191, v19, v191
    v_mul_f32 v176, v176, v184
    v_mfma_f32_16x16x32_bf16 v[204:207], a[28:31], v[116:119], v[204:207]
    ds_read_b128 a[12:15], v15 offset:23552
    v_mul_f32 v177, v177, v185
    v_mfma_f32_16x16x32_bf16 v[200:203], a[28:31], v[112:115], v[200:203]
    v_mul_f32 v178, v178, v186
    v_mul_f32 v179, v179, v187
    v_mul_f32 v180, v180, v188
    s_waitcnt lgkmcnt(4)
    v_mfma_f32_16x16x32_bf16 v[192:195], a[32:35], v[120:123], v[192:195]
    ds_read_b128 a[16:19], v15 offset:49152
    v_mul_f32 v181, v181, v189
    v_mfma_f32_16x16x32_bf16 v[196:199], a[32:35], v[124:127], v[196:199]
    v_mul_f32 v182, v182, v190
    v_mul_f32 v183, v183, v191
    v_cvt_pk_bf16_f32 v252, v176, v177
    v_mfma_f32_16x16x32_bf16 v[204:207], a[36:39], v[124:127], v[204:207]
    ds_read_b128 a[20:23], v15 offset:50176
    v_cvt_pk_bf16_f32 v253, v178, v179
    v_mfma_f32_16x16x32_bf16 v[200:203], a[36:39], v[120:123], v[200:203]
    v_cvt_pk_bf16_f32 v254, v180, v181
    v_cvt_pk_bf16_f32 v255, v182, v183
    v_mfma_f32_16x16x32_bf16 v[208:211], a[40:43], v[24:27], v[208:211]
    ds_read_b128 a[24:27], v15 offset:51200
    s_nop 0
    v_mfma_f32_16x16x32_bf16 v[212:215], a[40:43], v[28:31], v[212:215]
    v_permlane32_swap_b32 v252, v254
    v_permlane32_swap_b32 v253, v255
    v_mfma_f32_16x16x32_bf16 v[220:223], a[44:47], v[28:31], v[220:223]
    ds_read_b128 a[28:31], v15 offset:52224
    buffer_store_dwordx4 v[252:255], v14, s[32:35], s13 offen offset:1536 sc1
    v_mfma_f32_16x16x32_bf16 v[216:219], a[44:47], v[24:27], v[216:219]
    s_waitcnt lgkmcnt(4)
    v_mfma_f32_16x16x32_bf16 v[208:211], a[0:3], v[96:99], v[208:211]
    ds_read_b128 a[32:35], v47 offset:28672
    v_max_f32 v192, 0, v192
    v_mfma_f32_16x16x32_bf16 v[212:215], a[0:3], v[100:103], v[212:215]
    v_max_f32 v193, 0, v193
    v_max_f32 v194, 0, v194
    v_max_f32 v195, 0, v195
    v_mfma_f32_16x16x32_bf16 v[220:223], a[4:7], v[100:103], v[220:223]
    ds_read_b128 a[36:39], v47 offset:29696
    v_max_f32 v196, 0, v196
    v_mfma_f32_16x16x32_bf16 v[216:219], a[4:7], v[96:99], v[216:219]
    v_max_f32 v197, 0, v197
    v_max_f32 v198, 0, v198
    v_max_f32 v199, 0, v199
    v_mfma_f32_16x16x32_bf16 v[208:211], a[8:11], v[104:107], v[208:211]
    ds_read_b128 a[40:43], v15 offset:24576
    v_mul_f32 v200, v18, v200
    v_mfma_f32_16x16x32_bf16 v[212:215], a[8:11], v[108:111], v[212:215]
    v_mul_f32 v201, v18, v201
    v_mul_f32 v202, v18, v202
    v_mul_f32 v203, v18, v203
    v_mfma_f32_16x16x32_bf16 v[220:223], a[12:15], v[108:111], v[220:223]
    ds_read_b128 a[44:47], v15 offset:25600
    v_mul_f32 v204, v19, v204
    v_mfma_f32_16x16x32_bf16 v[216:219], a[12:15], v[104:107], v[216:219]
    v_mul_f32 v205, v19, v205
    v_mul_f32 v206, v19, v206
    v_mul_f32 v207, v19, v207
    s_waitcnt lgkmcnt(4)
    v_mfma_f32_16x16x32_bf16 v[208:211], a[16:19], v[112:115], v[208:211]
    ds_read_b128 a[0:3], v15 offset:26624
    v_mul_f32 v192, v192, v200
    v_mfma_f32_16x16x32_bf16 v[212:215], a[16:19], v[116:119], v[212:215]
    v_mul_f32 v193, v193, v201
    v_mul_f32 v194, v194, v202
    v_mul_f32 v195, v195, v203
    v_mfma_f32_16x16x32_bf16 v[220:223], a[20:23], v[116:119], v[220:223]
    ds_read_b128 a[4:7], v15 offset:27648
    v_mul_f32 v196, v196, v204
    v_mfma_f32_16x16x32_bf16 v[216:219], a[20:23], v[112:115], v[216:219]
    v_mul_f32 v197, v197, v205
    v_mul_f32 v198, v198, v206
    v_mul_f32 v199, v199, v207
    v_mfma_f32_16x16x32_bf16 v[208:211], a[24:27], v[120:123], v[208:211]
    ds_read_b128 a[8:11], v15 offset:53248
    v_cvt_pk_bf16_f32 v248, v192, v193
    v_mfma_f32_16x16x32_bf16 v[212:215], a[24:27], v[124:127], v[212:215]
    v_cvt_pk_bf16_f32 v249, v194, v195
    v_cvt_pk_bf16_f32 v250, v196, v197
    v_mfma_f32_16x16x32_bf16 v[220:223], a[28:31], v[124:127], v[220:223]
    ds_read_b128 a[12:15], v15 offset:54272
    v_cvt_pk_bf16_f32 v251, v198, v199
    v_mfma_f32_16x16x32_bf16 v[216:219], a[28:31], v[120:123], v[216:219]
    s_nop 0
    v_permlane32_swap_b32 v248, v250
    s_waitcnt lgkmcnt(4)
    v_mfma_f32_16x16x32_bf16 v[224:227], a[32:35], v[24:27], v[224:227]
    ds_read_b128 a[16:19], v15 offset:55296
    v_permlane32_swap_b32 v249, v251
    v_mfma_f32_16x16x32_bf16 v[228:231], a[32:35], v[28:31], v[228:231]
    buffer_store_dwordx4 v[248:251], v14, s[32:35], s13 offen offset:2048 sc1
    v_mfma_f32_16x16x32_bf16 v[236:239], a[36:39], v[28:31], v[236:239]
    ds_read_b128 a[20:23], v15 offset:56320
    v_mfma_f32_16x16x32_bf16 v[232:235], a[36:39], v[24:27], v[232:235]
    v_mfma_f32_16x16x32_bf16 v[224:227], a[40:43], v[96:99], v[224:227]
    v_max_f32 v208, 0, v208
    v_max_f32 v209, 0, v209
    v_mfma_f32_16x16x32_bf16 v[228:231], a[40:43], v[100:103], v[228:231]
    v_max_f32 v210, 0, v210
    v_max_f32 v211, 0, v211
    v_max_f32 v212, 0, v212
    v_mfma_f32_16x16x32_bf16 v[236:239], a[44:47], v[100:103], v[236:239]
    v_max_f32 v213, 0, v213
    v_max_f32 v214, 0, v214
    v_mfma_f32_16x16x32_bf16 v[232:235], a[44:47], v[96:99], v[232:235]
    v_max_f32 v215, 0, v215
    v_mul_f32 v216, v18, v216
    v_mul_f32 v217, v18, v217
    s_waitcnt lgkmcnt(2)
    v_mfma_f32_16x16x32_bf16 v[224:227], a[0:3], v[104:107], v[224:227]
    v_mul_f32 v218, v18, v218
    v_mul_f32 v219, v18, v219
    v_mfma_f32_16x16x32_bf16 v[228:231], a[0:3], v[108:111], v[228:231]
    v_mul_f32 v220, v19, v220
    v_mul_f32 v221, v19, v221
    v_mul_f32 v222, v19, v222
    v_mfma_f32_16x16x32_bf16 v[236:239], a[4:7], v[108:111], v[236:239]
    v_mul_f32 v223, v19, v223
    v_mul_f32 v208, v208, v216
    v_mfma_f32_16x16x32_bf16 v[232:235], a[4:7], v[104:107], v[232:235]
    v_mul_f32 v209, v209, v217
    v_mul_f32 v210, v210, v218
    v_mul_f32 v211, v211, v219
    v_mfma_f32_16x16x32_bf16 v[224:227], a[8:11], v[112:115], v[224:227]
    v_mul_f32 v212, v212, v220
    v_mul_f32 v213, v213, v221
    v_mfma_f32_16x16x32_bf16 v[228:231], a[8:11], v[116:119], v[228:231]
    v_mul_f32 v214, v214, v222
    v_mul_f32 v215, v215, v223
    v_cvt_pk_bf16_f32 v252, v208, v209
    v_mfma_f32_16x16x32_bf16 v[236:239], a[12:15], v[116:119], v[236:239]
    v_cvt_pk_bf16_f32 v253, v210, v211
    v_cvt_pk_bf16_f32 v254, v212, v213
    v_mfma_f32_16x16x32_bf16 v[232:235], a[12:15], v[112:115], v[232:235]
    v_cvt_pk_bf16_f32 v255, v214, v215
    s_nop 0
    s_waitcnt lgkmcnt(0)
    v_mfma_f32_16x16x32_bf16 v[224:227], a[16:19], v[120:123], v[224:227]
    v_permlane32_swap_b32 v252, v254
    v_permlane32_swap_b32 v253, v255
    v_mfma_f32_16x16x32_bf16 v[228:231], a[16:19], v[124:127], v[228:231]
    buffer_store_dwordx4 v[252:255], v14, s[32:35], s13 offen offset:2560 sc1
    v_mfma_f32_16x16x32_bf16 v[236:239], a[20:23], v[124:127], v[236:239]
    v_mfma_f32_16x16x32_bf16 v[232:235], a[20:23], v[120:123], v[232:235]
    s_nop 7
    v_max_f32 v224, 0, v224
    v_max_f32 v225, 0, v225
    v_max_f32 v226, 0, v226
    v_max_f32 v227, 0, v227
    v_max_f32 v228, 0, v228
    v_max_f32 v229, 0, v229
    v_max_f32 v230, 0, v230
    v_max_f32 v231, 0, v231
    v_mul_f32 v232, v18, v232
    v_mul_f32 v233, v18, v233
    v_mul_f32 v234, v18, v234
    v_mul_f32 v235, v18, v235
    v_mul_f32 v236, v19, v236
    v_mul_f32 v237, v19, v237
    v_mul_f32 v238, v19, v238
    v_mul_f32 v239, v19, v239
    v_mul_f32 v224, v224, v232
    v_mul_f32 v225, v225, v233
    v_mul_f32 v226, v226, v234
    v_mul_f32 v227, v227, v235
    v_mul_f32 v228, v228, v236
    v_mul_f32 v229, v229, v237
    v_mul_f32 v230, v230, v238
    v_mul_f32 v231, v231, v239
    v_cvt_pk_bf16_f32 v248, v224, v225
    v_cvt_pk_bf16_f32 v249, v226, v227
    v_cvt_pk_bf16_f32 v250, v228, v229
    v_cvt_pk_bf16_f32 v251, v230, v231
    s_nop 0
    v_permlane32_swap_b32 v248, v250
    v_permlane32_swap_b32 v249, v251
    buffer_store_dwordx4 v[248:251], v14, s[32:35], s67 offen offset:0 sc1
    s_and_b32 s10, s3, 1
    s_lshl_b32 s10, s10, 30
    v_add_u32 v35, s10, v39
    buffer_load_dwordx4 a[0:3], v38, s[52:55], s47 offen offset:2048 sc1
    s_lshr_b32 s6, s44, 4
    s_bfe_u32 s7, s44, 0x30001
    s_lshl_b32 s7, s7, 5
    s_or_b32 s6, s6, s7
    v_min_u32 v6, 4, v2
    v_lshl_add_u32 v6, v1, 2, v6
    buffer_load_dwordx4 a[4:7], v38, s[52:55], s48 offen offset:2048 sc1
    v_min_u32 v6, 15, v6
    v_lshrrev_b32 v5, 2, v6
    v_lshlrev_b32 v5, 1, v5
    v_and_b32 v6, 3, v6
    v_lshl_add_u32 v5, v6, 3, v5
    v_add_u32 v5, s6, v5
    buffer_load_dwordx4 a[8:11], v38, s[52:55], s49 offen offset:2048 sc1
    v_lshlrev_b32 v5, 7, v5
    s_add_u32 s10, s3, 0
    s_and_b32 s10, s10, 3
    s_mul_i32 s10, s10, 55296
    s_add_u32 s60, s46, s10
    s_add_u32 s10, s3, 1
    buffer_load_dwordx4 a[12:15], v38, s[52:55], s50 offen offset:2048 sc1
    s_and_b32 s10, s10, 3
    s_mul_i32 s10, s10, 55296
    s_add_u32 s61, s46, s10
    s_add_u32 s10, s3, 2
    s_and_b32 s10, s10, 3
    s_mul_i32 s10, s10, 55296
    buffer_load_dwordx4 a[16:19], v38, s[52:55], s51 offen offset:2048 sc1
    s_add_u32 s62, s46, s10
    s_add_u32 s10, s3, 3
    s_and_b32 s10, s10, 3
    s_mul_i32 s10, s10, 55296
    s_add_u32 s63, s46, s10
    s_mov_b32 s24, s18
    buffer_load_dwordx4 a[20:23], v38, s[52:55], s47 offen offset:3072 sc1
    s_mov_b32 s25, s19
    s_mov_b32 s26, 0x280000
    s_mov_b32 s27, 0x20000
    s_lshl_b32 s10, s44, 6
    s_lshr_b32 s11, s3, 1
    s_lshl_b32 s11, s11, 5
    buffer_load_dwordx4 a[24:27], v38, s[52:55], s48 offen offset:3072 sc1
    s_add_u32 s10, s10, s11
    s_and_b32 s11, s3, 1
    s_add_u32 s10, s10, s11
    v_lshl_add_u32 v9, v3, 1, s10
    s_mul_i32 s11, s45, 20
    v_add_u32 v10, s11, v4
    buffer_load_dwordx4 a[28:31], v38, s[52:55], s49 offen offset:3072 sc1
    v_lshlrev_b32 v11, 14, v10
    v_lshl_add_u32 v11, v9, 3, v11
    v_lshlrev_b32 v12, 4, v4
    v_add_u32 v12, 159744, v12
    v_mul_u32_u24 v13, 1280, v9
    v_lshl_add_u32 v13, v10, 3, v13
    buffer_load_dwordx4 a[32:35], v38, s[52:55], s50 offen offset:3072 sc1
    v_and_b32 v14, 1, v4
    v_mad_u32_u24 v14, v14, 24, v13
    s_mov_b32 s10, 0
    buffer_load_dwordx4 a[36:39], v38, s[52:55], s51 offen offset:3072 sc1
    buffer_load_dwordx4 a[40:43], v39, s[52:55], s47 offen offset:0 sc1
    buffer_load_dwordx4 a[44:47], v39, s[52:55], s48 offen offset:0 sc1
    s_waitcnt vmcnt(12)
    s_barrier
    s_cmp_lg_u32 s3, 0
    s_cbranch_scc1 L_sig_36
    v_mov_b32 v6, s64
    v_mov_b32 v7, 0
    s_mov_b64 exec, 1
    buffer_store_dword v6, v7, s[56:59], s65 offen offset:12 sc1
    s_mov_b64 exec, -1
L_sig_36:
    ds_read_b128 v[212:215], v12 offset:0
    ds_read_b128 v[216:219], v12 offset:64
    ds_read_b128 v[220:223], v12 offset:128
    ds_read_b128 v[224:227], v12 offset:192
    ds_read_b128 v[228:231], v12 offset:256
    buffer_load_dwordx4 a[248:251], v39, s[52:55], s49 offen offset:0 sc1
    buffer_load_dwordx4 a[252:255], v39, s[52:55], s50 offen offset:0 sc1
    buffer_load_dwordx4 v[232:235], v39, s[52:55], s51 offen offset:0 sc1
    buffer_load_dwordx4 v[236:239], v35, s[52:55], s47 offen offset:1024 sc1
    buffer_load_dwordx4 v[240:243], v35, s[52:55], s48 offen offset:1024 sc1
    buffer_load_dwordx4 v[244:247], v35, s[52:55], s49 offen offset:1024 sc1
    buffer_load_dwordx4 v[248:251], v35, s[52:55], s50 offen offset:1024 sc1
    buffer_load_dwordx4 v[252:255], v35, s[52:55], s51 offen offset:1024 sc1
    buffer_load_dwordx2 v[200:201], v11, s[20:23], s10 offen sc1
    s_add_u32 s10, s10, 65536
    buffer_load_dwordx2 v[202:203], v11, s[20:23], s10 offen sc1
    s_add_u32 s10, s10, 65536
    buffer_load_dwordx2 v[204:205], v11, s[20:23], s10 offen sc1
    s_add_u32 s10, s10, 65536
    buffer_load_dwordx2 v[206:207], v11, s[20:23], s10 offen sc1
    s_add_u32 s10, s10, 65536
    buffer_load_dwordx2 v[208:209], v11, s[20:23], s10 offen sc1
    buffer_load_dword v8, v5, s[56:59], 0 offen offset:12 sc1
    s_waitcnt vmcnt(0)
    v_cmp_ne_u32 vcc, s64, v8
    s_cbranch_vccz L_g2wait
    s_mov_b32 s66, 0x8000
    s_branch L_pfst_40
L_poll_37:
    s_sleep 2
L_pfst_40:
    buffer_load_dword v8, v5, s[56:59], 0 offen offset:12 sc1
L_pchk_38:
    s_sub_u32 s66, s66, 1
    s_cmp_eq_u32 s66, 0
    s_waitcnt vmcnt(0)
    s_cbranch_scc1 L_pdone_39
    v_cmp_ne_u32 vcc, s64, v8
    s_cbranch_vccnz L_poll_37
L_pdone_39:
L_g2wait:
    buffer_load_dwordx4 v[120:123], v15, s[32:35], s61 offen offset:0 sc1
    buffer_load_dwordx4 v[124:127], v15, s[32:35], s62 offen offset:0 sc1
    buffer_load_dwordx4 v[128:131], v15, s[32:35], s63 offen offset:0 sc1
    buffer_load_dwordx4 v[132:135], v15, s[32:35], s60 offen offset:0 sc1
    buffer_load_dwordx4 v[136:139], v15, s[32:35], s61 offen offset:1024 sc1
    buffer_load_dwordx4 v[140:143], v15, s[32:35], s62 offen offset:1024 sc1
    buffer_load_dwordx4 v[144:147], v15, s[32:35], s63 offen offset:1024 sc1
    buffer_load_dwordx4 v[148:151], v15, s[32:35], s60 offen offset:1024 sc1
    buffer_load_dwordx4 v[152:155], v15, s[32:35], s61 offen offset:2048 sc1
    buffer_load_dwordx4 v[156:159], v15, s[32:35], s62 offen offset:2048 sc1
    s_waitcnt vmcnt(9)
    v_mfma_f32_16x16x32_bf16 v[60:63], a[48:51], v[120:123], 0
    buffer_load_dwordx4 v[160:163], v15, s[32:35], s63 offen offset:2048 sc1
    v_mfma_f32_16x16x32_bf16 v[64:67], a[52:55], v[120:123], 0
    v_mfma_f32_16x16x32_bf16 v[68:71], a[56:59], v[120:123], 0
    v_mfma_f32_16x16x32_bf16 v[72:75], a[60:63], v[120:123], 0
    v_mfma_f32_16x16x32_bf16 v[76:79], a[64:67], v[120:123], 0
    s_waitcnt vmcnt(9)
    v_mfma_f32_16x16x32_bf16 v[80:83], a[48:51], v[124:127], 0
    buffer_load_dwordx4 v[164:167], v15, s[32:35], s60 offen offset:2048 sc1
    v_mfma_f32_16x16x32_bf16 v[84:87], a[52:55], v[124:127], 0
    v_mfma_f32_16x16x32_bf16 v[88:91], a[56:59], v[124:127], 0
    v_mfma_f32_16x16x32_bf16 v[92:95], a[60:63], v[124:127], 0
    v_mfma_f32_16x16x32_bf16 v[96:99], a[64:67], v[124:127], 0
    s_waitcnt vmcnt(9)
    v_mfma_f32_16x16x32_bf16 v[100:103], a[48:51], v[128:131], 0
    buffer_load_dwordx4 v[168:171], v15, s[32:35], s61 offen offset:3072 sc1
    v_mfma_f32_16x16x32_bf16 v[104:107], a[52:55], v[128:131], 0
    v_mfma_f32_16x16x32_bf16 v[108:111], a[56:59], v[128:131], 0
    v_mfma_f32_16x16x32_bf16 v[112:115], a[60:63], v[128:131], 0
    v_mfma_f32_16x16x32_bf16 v[116:119], a[64:67], v[128:131], 0
    s_waitcnt vmcnt(9)
    v_mfma_f32_16x16x32_bf16 v[40:43], a[48:51], v[132:135], 0
    buffer_load_dwordx4 v[172:175], v15, s[32:35], s62 offen offset:3072 sc1
    v_mfma_f32_16x16x32_bf16 v[44:47], a[52:55], v[132:135], 0
    v_mfma_f32_16x16x32_bf16 v[48:51], a[56:59], v[132:135], 0
    v_mfma_f32_16x16x32_bf16 v[52:55], a[60:63], v[132:135], 0
    v_mfma_f32_16x16x32_bf16 v[56:59], a[64:67], v[132:135], 0
    s_waitcnt vmcnt(9)
    v_mfma_f32_16x16x32_bf16 v[60:63], a[68:71], v[136:139], v[60:63]
    buffer_load_dwordx4 v[176:179], v15, s[32:35], s63 offen offset:3072 sc1
    v_mfma_f32_16x16x32_bf16 v[64:67], a[72:75], v[136:139], v[64:67]
    v_mfma_f32_16x16x32_bf16 v[68:71], a[76:79], v[136:139], v[68:71]
    v_mfma_f32_16x16x32_bf16 v[72:75], a[80:83], v[136:139], v[72:75]
    v_mfma_f32_16x16x32_bf16 v[76:79], a[84:87], v[136:139], v[76:79]
    s_waitcnt vmcnt(9)
    v_mfma_f32_16x16x32_bf16 v[80:83], a[68:71], v[140:143], v[80:83]
    buffer_load_dwordx4 v[180:183], v15, s[32:35], s60 offen offset:3072 sc1
    v_mfma_f32_16x16x32_bf16 v[84:87], a[72:75], v[140:143], v[84:87]
    v_mfma_f32_16x16x32_bf16 v[88:91], a[76:79], v[140:143], v[88:91]
    v_mfma_f32_16x16x32_bf16 v[92:95], a[80:83], v[140:143], v[92:95]
    v_mfma_f32_16x16x32_bf16 v[96:99], a[84:87], v[140:143], v[96:99]
    s_waitcnt vmcnt(9)
    v_mfma_f32_16x16x32_bf16 v[100:103], a[68:71], v[144:147], v[100:103]
    buffer_load_dwordx4 v[184:187], v37, s[32:35], s61 offen offset:0 sc1
    v_mfma_f32_16x16x32_bf16 v[104:107], a[72:75], v[144:147], v[104:107]
    v_mfma_f32_16x16x32_bf16 v[108:111], a[76:79], v[144:147], v[108:111]
    v_mfma_f32_16x16x32_bf16 v[112:115], a[80:83], v[144:147], v[112:115]
    v_mfma_f32_16x16x32_bf16 v[116:119], a[84:87], v[144:147], v[116:119]
    s_waitcnt vmcnt(9)
    v_mfma_f32_16x16x32_bf16 v[40:43], a[68:71], v[148:151], v[40:43]
    buffer_load_dwordx4 v[188:191], v37, s[32:35], s62 offen offset:0 sc1
    v_mfma_f32_16x16x32_bf16 v[44:47], a[72:75], v[148:151], v[44:47]
    v_mfma_f32_16x16x32_bf16 v[48:51], a[76:79], v[148:151], v[48:51]
    v_mfma_f32_16x16x32_bf16 v[52:55], a[80:83], v[148:151], v[52:55]
    v_mfma_f32_16x16x32_bf16 v[56:59], a[84:87], v[148:151], v[56:59]
    s_waitcnt vmcnt(9)
    v_mfma_f32_16x16x32_bf16 v[60:63], a[88:91], v[152:155], v[60:63]
    buffer_load_dwordx4 v[192:195], v37, s[32:35], s63 offen offset:0 sc1
    v_mfma_f32_16x16x32_bf16 v[64:67], a[92:95], v[152:155], v[64:67]
    v_mfma_f32_16x16x32_bf16 v[68:71], a[96:99], v[152:155], v[68:71]
    v_mfma_f32_16x16x32_bf16 v[72:75], a[100:103], v[152:155], v[72:75]
    v_mfma_f32_16x16x32_bf16 v[76:79], a[104:107], v[152:155], v[76:79]
    s_add_u32 s11, s3, 0
    s_and_b32 s11, s11, 3
    s_mul_i32 s11, s11, 15360
    v_add_u32 v5, s11, v15
    s_waitcnt vmcnt(9)
    v_mfma_f32_16x16x32_bf16 v[80:83], a[88:91], v[156:159], v[80:83]
    buffer_load_dwordx4 v[196:199], v37, s[32:35], s60 offen offset:0 sc1
    v_mfma_f32_16x16x32_bf16 v[84:87], a[92:95], v[156:159], v[84:87]
    v_mfma_f32_16x16x32_bf16 v[88:91], a[96:99], v[156:159], v[88:91]
    v_mfma_f32_16x16x32_bf16 v[92:95], a[100:103], v[156:159], v[92:95]
    v_mfma_f32_16x16x32_bf16 v[96:99], a[104:107], v[156:159], v[96:99]
    s_add_u32 s11, s3, 1
    s_and_b32 s11, s11, 3
    s_mul_i32 s11, s11, 15360
    v_add_u32 v6, s11, v15
    s_waitcnt vmcnt(9)
    v_mfma_f32_16x16x32_bf16 v[100:103], a[88:91], v[160:163], v[100:103]
    buffer_load_dwordx4 v[120:123], v37, s[32:35], s61 offen offset:1024 sc1
    v_mfma_f32_16x16x32_bf16 v[104:107], a[92:95], v[160:163], v[104:107]
    v_mfma_f32_16x16x32_bf16 v[108:111], a[96:99], v[160:163], v[108:111]
    v_mfma_f32_16x16x32_bf16 v[112:115], a[100:103], v[160:163], v[112:115]
    v_mfma_f32_16x16x32_bf16 v[116:119], a[104:107], v[160:163], v[116:119]
    s_add_u32 s11, s3, 2
    s_and_b32 s11, s11, 3
    s_mul_i32 s11, s11, 15360
    v_add_u32 v7, s11, v15
    s_waitcnt vmcnt(9)
    v_mfma_f32_16x16x32_bf16 v[40:43], a[88:91], v[164:167], v[40:43]
    buffer_load_dwordx4 v[124:127], v37, s[32:35], s62 offen offset:1024 sc1
    v_mfma_f32_16x16x32_bf16 v[44:47], a[92:95], v[164:167], v[44:47]
    v_mfma_f32_16x16x32_bf16 v[48:51], a[96:99], v[164:167], v[48:51]
    v_mfma_f32_16x16x32_bf16 v[52:55], a[100:103], v[164:167], v[52:55]
    v_mfma_f32_16x16x32_bf16 v[56:59], a[104:107], v[164:167], v[56:59]
    s_add_u32 s11, s3, 3
    s_and_b32 s11, s11, 3
    s_mul_i32 s11, s11, 15360
    v_add_u32 v8, s11, v15
    s_waitcnt vmcnt(9)
    v_mfma_f32_16x16x32_bf16 v[60:63], a[108:111], v[168:171], v[60:63]
    buffer_load_dwordx4 v[128:131], v37, s[32:35], s63 offen offset:1024 sc1
    v_mfma_f32_16x16x32_bf16 v[64:67], a[112:115], v[168:171], v[64:67]
    v_mfma_f32_16x16x32_bf16 v[68:71], a[116:119], v[168:171], v[68:71]
    v_mfma_f32_16x16x32_bf16 v[72:75], a[120:123], v[168:171], v[72:75]
    v_mfma_f32_16x16x32_bf16 v[76:79], a[124:127], v[168:171], v[76:79]
    s_waitcnt vmcnt(9)
    v_mfma_f32_16x16x32_bf16 v[80:83], a[108:111], v[172:175], v[80:83]
    buffer_load_dwordx4 v[132:135], v37, s[32:35], s60 offen offset:1024 sc1
    v_mfma_f32_16x16x32_bf16 v[84:87], a[112:115], v[172:175], v[84:87]
    v_mfma_f32_16x16x32_bf16 v[88:91], a[116:119], v[172:175], v[88:91]
    v_mfma_f32_16x16x32_bf16 v[92:95], a[120:123], v[172:175], v[92:95]
    v_mfma_f32_16x16x32_bf16 v[96:99], a[124:127], v[172:175], v[96:99]
    s_waitcnt vmcnt(9)
    v_mfma_f32_16x16x32_bf16 v[100:103], a[108:111], v[176:179], v[100:103]
    buffer_load_dwordx4 v[136:139], v37, s[32:35], s61 offen offset:2048 sc1
    v_mfma_f32_16x16x32_bf16 v[104:107], a[112:115], v[176:179], v[104:107]
    v_mfma_f32_16x16x32_bf16 v[108:111], a[116:119], v[176:179], v[108:111]
    v_mfma_f32_16x16x32_bf16 v[112:115], a[120:123], v[176:179], v[112:115]
    v_mfma_f32_16x16x32_bf16 v[116:119], a[124:127], v[176:179], v[116:119]
    s_waitcnt vmcnt(9)
    v_mfma_f32_16x16x32_bf16 v[40:43], a[108:111], v[180:183], v[40:43]
    buffer_load_dwordx4 v[140:143], v37, s[32:35], s61 offen offset:3072 sc1
    v_mfma_f32_16x16x32_bf16 v[44:47], a[112:115], v[180:183], v[44:47]
    v_mfma_f32_16x16x32_bf16 v[48:51], a[116:119], v[180:183], v[48:51]
    v_mfma_f32_16x16x32_bf16 v[52:55], a[120:123], v[180:183], v[52:55]
    v_mfma_f32_16x16x32_bf16 v[56:59], a[124:127], v[180:183], v[56:59]
    s_waitcnt vmcnt(9)
    v_mfma_f32_16x16x32_bf16 v[60:63], a[128:131], v[184:187], v[60:63]
    buffer_load_dwordx4 v[144:147], v38, s[32:35], s61 offen offset:0 sc1
    v_mfma_f32_16x16x32_bf16 v[64:67], a[132:135], v[184:187], v[64:67]
    v_mfma_f32_16x16x32_bf16 v[68:71], a[136:139], v[184:187], v[68:71]
    v_mfma_f32_16x16x32_bf16 v[72:75], a[140:143], v[184:187], v[72:75]
    v_mfma_f32_16x16x32_bf16 v[76:79], a[144:147], v[184:187], v[76:79]
    s_waitcnt vmcnt(9)
    v_mfma_f32_16x16x32_bf16 v[80:83], a[128:131], v[188:191], v[80:83]
    buffer_load_dwordx4 v[148:151], v38, s[32:35], s61 offen offset:1024 sc1
    v_mfma_f32_16x16x32_bf16 v[84:87], a[132:135], v[188:191], v[84:87]
    v_mfma_f32_16x16x32_bf16 v[88:91], a[136:139], v[188:191], v[88:91]
    v_mfma_f32_16x16x32_bf16 v[92:95], a[140:143], v[188:191], v[92:95]
    v_mfma_f32_16x16x32_bf16 v[96:99], a[144:147], v[188:191], v[96:99]
    s_waitcnt vmcnt(9)
    v_mfma_f32_16x16x32_bf16 v[100:103], a[128:131], v[192:195], v[100:103]
    buffer_load_dwordx4 v[152:155], v38, s[32:35], s61 offen offset:2048 sc1
    v_mfma_f32_16x16x32_bf16 v[104:107], a[132:135], v[192:195], v[104:107]
    v_mfma_f32_16x16x32_bf16 v[108:111], a[136:139], v[192:195], v[108:111]
    v_mfma_f32_16x16x32_bf16 v[112:115], a[140:143], v[192:195], v[112:115]
    v_mfma_f32_16x16x32_bf16 v[116:119], a[144:147], v[192:195], v[116:119]
    s_waitcnt vmcnt(9)
    v_mfma_f32_16x16x32_bf16 v[40:43], a[128:131], v[196:199], v[40:43]
    buffer_load_dwordx4 v[156:159], v38, s[32:35], s61 offen offset:3072 sc1
    v_mfma_f32_16x16x32_bf16 v[44:47], a[132:135], v[196:199], v[44:47]
    v_mfma_f32_16x16x32_bf16 v[48:51], a[136:139], v[196:199], v[48:51]
    v_mfma_f32_16x16x32_bf16 v[52:55], a[140:143], v[196:199], v[52:55]
    v_mfma_f32_16x16x32_bf16 v[56:59], a[144:147], v[196:199], v[56:59]
    s_waitcnt vmcnt(9)
    v_mfma_f32_16x16x32_bf16 v[60:63], a[148:151], v[120:123], v[60:63]
    buffer_load_dwordx4 v[160:163], v39, s[32:35], s61 offen offset:0 sc1
    v_mfma_f32_16x16x32_bf16 v[64:67], a[152:155], v[120:123], v[64:67]
    v_mfma_f32_16x16x32_bf16 v[68:71], a[156:159], v[120:123], v[68:71]
    v_mfma_f32_16x16x32_bf16 v[72:75], a[160:163], v[120:123], v[72:75]
    v_mfma_f32_16x16x32_bf16 v[76:79], a[164:167], v[120:123], v[76:79]
    s_waitcnt vmcnt(9)
    v_mfma_f32_16x16x32_bf16 v[80:83], a[148:151], v[124:127], v[80:83]
    buffer_load_dwordx4 v[164:167], v35, s[32:35], s61 offen offset:1024 sc1
    v_mfma_f32_16x16x32_bf16 v[84:87], a[152:155], v[124:127], v[84:87]
    v_mfma_f32_16x16x32_bf16 v[88:91], a[156:159], v[124:127], v[88:91]
    v_mfma_f32_16x16x32_bf16 v[92:95], a[160:163], v[124:127], v[92:95]
    v_mfma_f32_16x16x32_bf16 v[96:99], a[164:167], v[124:127], v[96:99]
    s_waitcnt vmcnt(9)
    v_mfma_f32_16x16x32_bf16 v[100:103], a[148:151], v[128:131], v[100:103]
    buffer_load_dwordx4 v[168:171], v37, s[32:35], s62 offen offset:2048 sc1
    v_mfma_f32_16x16x32_bf16 v[104:107], a[152:155], v[128:131], v[104:107]
    v_mfma_f32_16x16x32_bf16 v[108:111], a[156:159], v[128:131], v[108:111]
    v_mfma_f32_16x16x32_bf16 v[112:115], a[160:163], v[128:131], v[112:115]
    v_mfma_f32_16x16x32_bf16 v[116:119], a[164:167], v[128:131], v[116:119]
    s_waitcnt vmcnt(9)
    v_mfma_f32_16x16x32_bf16 v[40:43], a[148:151], v[132:135], v[40:43]
    buffer_load_dwordx4 v[172:175], v37, s[32:35], s62 offen offset:3072 sc1
    v_mfma_f32_16x16x32_bf16 v[44:47], a[152:155], v[132:135], v[44:47]
    v_mfma_f32_16x16x32_bf16 v[48:51], a[156:159], v[132:135], v[48:51]
    v_mfma_f32_16x16x32_bf16 v[52:55], a[160:163], v[132:135], v[52:55]
    v_mfma_f32_16x16x32_bf16 v[56:59], a[164:167], v[132:135], v[56:59]
    s_waitcnt vmcnt(9)
    v_mfma_f32_16x16x32_bf16 v[60:63], a[168:171], v[136:139], v[60:63]
    buffer_load_dwordx4 v[176:179], v38, s[32:35], s62 offen offset:0 sc1
    v_mfma_f32_16x16x32_bf16 v[64:67], a[172:175], v[136:139], v[64:67]
    v_mfma_f32_16x16x32_bf16 v[68:71], a[176:179], v[136:139], v[68:71]
    v_mfma_f32_16x16x32_bf16 v[72:75], a[180:183], v[136:139], v[72:75]
    v_mfma_f32_16x16x32_bf16 v[76:79], a[184:187], v[136:139], v[76:79]
    s_waitcnt vmcnt(9)
    v_mfma_f32_16x16x32_bf16 v[60:63], a[188:191], v[140:143], v[60:63]
    buffer_load_dwordx4 v[180:183], v38, s[32:35], s62 offen offset:1024 sc1
    v_mfma_f32_16x16x32_bf16 v[64:67], a[192:195], v[140:143], v[64:67]
    v_mfma_f32_16x16x32_bf16 v[68:71], a[196:199], v[140:143], v[68:71]
    v_mfma_f32_16x16x32_bf16 v[72:75], a[200:203], v[140:143], v[72:75]
    v_mfma_f32_16x16x32_bf16 v[76:79], a[204:207], v[140:143], v[76:79]
    s_waitcnt vmcnt(9)
    v_mfma_f32_16x16x32_bf16 v[60:63], a[208:211], v[144:147], v[60:63]
    buffer_load_dwordx4 v[184:187], v38, s[32:35], s62 offen offset:2048 sc1
    v_mfma_f32_16x16x32_bf16 v[64:67], a[212:215], v[144:147], v[64:67]
    v_mfma_f32_16x16x32_bf16 v[68:71], a[216:219], v[144:147], v[68:71]
    v_mfma_f32_16x16x32_bf16 v[72:75], a[220:223], v[144:147], v[72:75]
    v_mfma_f32_16x16x32_bf16 v[76:79], a[224:227], v[144:147], v[76:79]
    s_waitcnt vmcnt(9)
    v_mfma_f32_16x16x32_bf16 v[60:63], a[228:231], v[148:151], v[60:63]
    buffer_load_dwordx4 v[188:191], v38, s[32:35], s62 offen offset:3072 sc1
    v_mfma_f32_16x16x32_bf16 v[64:67], a[232:235], v[148:151], v[64:67]
    v_mfma_f32_16x16x32_bf16 v[68:71], a[236:239], v[148:151], v[68:71]
    v_mfma_f32_16x16x32_bf16 v[72:75], a[240:243], v[148:151], v[72:75]
    v_mfma_f32_16x16x32_bf16 v[76:79], a[244:247], v[148:151], v[76:79]
    s_waitcnt vmcnt(9)
    v_mfma_f32_16x16x32_bf16 v[60:63], a[0:3], v[152:155], v[60:63]
    buffer_load_dwordx4 v[192:195], v39, s[32:35], s62 offen offset:0 sc1
    v_mfma_f32_16x16x32_bf16 v[64:67], a[4:7], v[152:155], v[64:67]
    v_mfma_f32_16x16x32_bf16 v[68:71], a[8:11], v[152:155], v[68:71]
    v_mfma_f32_16x16x32_bf16 v[72:75], a[12:15], v[152:155], v[72:75]
    v_mfma_f32_16x16x32_bf16 v[76:79], a[16:19], v[152:155], v[76:79]
    s_waitcnt vmcnt(9)
    v_mfma_f32_16x16x32_bf16 v[60:63], a[20:23], v[156:159], v[60:63]
    buffer_load_dwordx4 v[196:199], v35, s[32:35], s62 offen offset:1024 sc1
    v_mfma_f32_16x16x32_bf16 v[64:67], a[24:27], v[156:159], v[64:67]
    v_mfma_f32_16x16x32_bf16 v[68:71], a[28:31], v[156:159], v[68:71]
    v_mfma_f32_16x16x32_bf16 v[72:75], a[32:35], v[156:159], v[72:75]
    v_mfma_f32_16x16x32_bf16 v[76:79], a[36:39], v[156:159], v[76:79]
    s_waitcnt vmcnt(9)
    v_mfma_f32_16x16x32_bf16 v[60:63], a[40:43], v[160:163], v[60:63]
    buffer_load_dwordx4 v[120:123], v37, s[32:35], s63 offen offset:2048 sc1
    v_mfma_f32_16x16x32_bf16 v[64:67], a[44:47], v[160:163], v[64:67]
    v_mfma_f32_16x16x32_bf16 v[68:71], a[248:251], v[160:163], v[68:71]
    v_mfma_f32_16x16x32_bf16 v[72:75], a[252:255], v[160:163], v[72:75]
    v_mfma_f32_16x16x32_bf16 v[76:79], v[232:235], v[160:163], v[76:79]
    s_waitcnt vmcnt(9)
    v_mfma_f32_16x16x32_bf16 v[60:63], v[236:239], v[164:167], v[60:63]
    buffer_load_dwordx4 v[124:127], v37, s[32:35], s63 offen offset:3072 sc1
    v_mfma_f32_16x16x32_bf16 v[64:67], v[240:243], v[164:167], v[64:67]
    v_mfma_f32_16x16x32_bf16 v[68:71], v[244:247], v[164:167], v[68:71]
    v_mfma_f32_16x16x32_bf16 v[72:75], v[248:251], v[164:167], v[72:75]
    v_mfma_f32_16x16x32_bf16 v[76:79], v[252:255], v[164:167], v[76:79]
    s_waitcnt vmcnt(9)
    v_mfma_f32_16x16x32_bf16 v[80:83], a[168:171], v[168:171], v[80:83]
    buffer_load_dwordx4 v[128:131], v38, s[32:35], s63 offen offset:0 sc1
    v_mfma_f32_16x16x32_bf16 v[84:87], a[172:175], v[168:171], v[84:87]
    v_mfma_f32_16x16x32_bf16 v[88:91], a[176:179], v[168:171], v[88:91]
    v_mfma_f32_16x16x32_bf16 v[92:95], a[180:183], v[168:171], v[92:95]
    ds_write_b128 v6, v[60:63] offset:0
    v_mfma_f32_16x16x32_bf16 v[96:99], a[184:187], v[168:171], v[96:99]
    ds_write_b128 v6, v[64:67] offset:1024
    s_waitcnt vmcnt(9)
    v_mfma_f32_16x16x32_bf16 v[80:83], a[188:191], v[172:175], v[80:83]
    buffer_load_dwordx4 v[132:135], v38, s[32:35], s63 offen offset:1024 sc1
    ds_write_b128 v6, v[68:71] offset:2048
    v_mfma_f32_16x16x32_bf16 v[84:87], a[192:195], v[172:175], v[84:87]
    ds_write_b128 v6, v[72:75] offset:3072
    v_mfma_f32_16x16x32_bf16 v[88:91], a[196:199], v[172:175], v[88:91]
    ds_write_b128 v6, v[76:79] offset:4096
    v_mfma_f32_16x16x32_bf16 v[92:95], a[200:203], v[172:175], v[92:95]
    v_mfma_f32_16x16x32_bf16 v[96:99], a[204:207], v[172:175], v[96:99]
    s_waitcnt vmcnt(9)
    v_mfma_f32_16x16x32_bf16 v[80:83], a[208:211], v[176:179], v[80:83]
    buffer_load_dwordx4 v[136:139], v38, s[32:35], s63 offen offset:2048 sc1
    v_mfma_f32_16x16x32_bf16 v[84:87], a[212:215], v[176:179], v[84:87]
    v_mfma_f32_16x16x32_bf16 v[88:91], a[216:219], v[176:179], v[88:91]
    v_mfma_f32_16x16x32_bf16 v[92:95], a[220:223], v[176:179], v[92:95]
    v_mfma_f32_16x16x32_bf16 v[96:99], a[224:227], v[176:179], v[96:99]
    s_waitcnt vmcnt(9)
    v_mfma_f32_16x16x32_bf16 v[80:83], a[228:231], v[180:183], v[80:83]
    buffer_load_dwordx4 v[140:143], v38, s[32:35], s63 offen offset:3072 sc1
    v_mfma_f32_16x16x32_bf16 v[84:87], a[232:235], v[180:183], v[84:87]
    v_mfma_f32_16x16x32_bf16 v[88:91], a[236:239], v[180:183], v[88:91]
    v_mfma_f32_16x16x32_bf16 v[92:95], a[240:243], v[180:183], v[92:95]
    v_mfma_f32_16x16x32_bf16 v[96:99], a[244:247], v[180:183], v[96:99]
    s_waitcnt vmcnt(9)
    v_mfma_f32_16x16x32_bf16 v[80:83], a[0:3], v[184:187], v[80:83]
    buffer_load_dwordx4 v[144:147], v39, s[32:35], s63 offen offset:0 sc1
    v_mfma_f32_16x16x32_bf16 v[84:87], a[4:7], v[184:187], v[84:87]
    v_mfma_f32_16x16x32_bf16 v[88:91], a[8:11], v[184:187], v[88:91]
    v_mfma_f32_16x16x32_bf16 v[92:95], a[12:15], v[184:187], v[92:95]
    v_mfma_f32_16x16x32_bf16 v[96:99], a[16:19], v[184:187], v[96:99]
    s_waitcnt vmcnt(9)
    v_mfma_f32_16x16x32_bf16 v[80:83], a[20:23], v[188:191], v[80:83]
    buffer_load_dwordx4 v[148:151], v35, s[32:35], s63 offen offset:1024 sc1
    v_mfma_f32_16x16x32_bf16 v[84:87], a[24:27], v[188:191], v[84:87]
    v_mfma_f32_16x16x32_bf16 v[88:91], a[28:31], v[188:191], v[88:91]
    v_mfma_f32_16x16x32_bf16 v[92:95], a[32:35], v[188:191], v[92:95]
    v_mfma_f32_16x16x32_bf16 v[96:99], a[36:39], v[188:191], v[96:99]
    s_waitcnt vmcnt(9)
    v_mfma_f32_16x16x32_bf16 v[80:83], a[40:43], v[192:195], v[80:83]
    buffer_load_dwordx4 v[152:155], v37, s[32:35], s60 offen offset:2048 sc1
    v_mfma_f32_16x16x32_bf16 v[84:87], a[44:47], v[192:195], v[84:87]
    v_mfma_f32_16x16x32_bf16 v[88:91], a[248:251], v[192:195], v[88:91]
    v_mfma_f32_16x16x32_bf16 v[92:95], a[252:255], v[192:195], v[92:95]
    v_mfma_f32_16x16x32_bf16 v[96:99], v[232:235], v[192:195], v[96:99]
    s_waitcnt vmcnt(9)
    v_mfma_f32_16x16x32_bf16 v[80:83], v[236:239], v[196:199], v[80:83]
    buffer_load_dwordx4 v[156:159], v37, s[32:35], s60 offen offset:3072 sc1
    v_mfma_f32_16x16x32_bf16 v[84:87], v[240:243], v[196:199], v[84:87]
    v_mfma_f32_16x16x32_bf16 v[88:91], v[244:247], v[196:199], v[88:91]
    v_mfma_f32_16x16x32_bf16 v[92:95], v[248:251], v[196:199], v[92:95]
    v_mfma_f32_16x16x32_bf16 v[96:99], v[252:255], v[196:199], v[96:99]
    s_waitcnt vmcnt(9)
    v_mfma_f32_16x16x32_bf16 v[100:103], a[168:171], v[120:123], v[100:103]
    buffer_load_dwordx4 v[160:163], v38, s[32:35], s60 offen offset:0 sc1
    v_mfma_f32_16x16x32_bf16 v[104:107], a[172:175], v[120:123], v[104:107]
    v_mfma_f32_16x16x32_bf16 v[108:111], a[176:179], v[120:123], v[108:111]
    v_mfma_f32_16x16x32_bf16 v[112:115], a[180:183], v[120:123], v[112:115]
    ds_write_b128 v7, v[80:83] offset:5120
    v_mfma_f32_16x16x32_bf16 v[116:119], a[184:187], v[120:123], v[116:119]
    ds_write_b128 v7, v[84:87] offset:6144
    s_waitcnt vmcnt(9)
    v_mfma_f32_16x16x32_bf16 v[100:103], a[188:191], v[124:127], v[100:103]
    buffer_load_dwordx4 v[164:167], v38, s[32:35], s60 offen offset:1024 sc1
    ds_write_b128 v7, v[88:91] offset:7168
    v_mfma_f32_16x16x32_bf16 v[104:107], a[192:195], v[124:127], v[104:107]
    ds_write_b128 v7, v[92:95] offset:8192
    v_mfma_f32_16x16x32_bf16 v[108:111], a[196:199], v[124:127], v[108:111]
    ds_write_b128 v7, v[96:99] offset:9216
    v_mfma_f32_16x16x32_bf16 v[112:115], a[200:203], v[124:127], v[112:115]
    v_mfma_f32_16x16x32_bf16 v[116:119], a[204:207], v[124:127], v[116:119]
    s_waitcnt vmcnt(9)
    v_mfma_f32_16x16x32_bf16 v[100:103], a[208:211], v[128:131], v[100:103]
    buffer_load_dwordx4 v[168:171], v38, s[32:35], s60 offen offset:2048 sc1
    v_mfma_f32_16x16x32_bf16 v[104:107], a[212:215], v[128:131], v[104:107]
    v_mfma_f32_16x16x32_bf16 v[108:111], a[216:219], v[128:131], v[108:111]
    v_mfma_f32_16x16x32_bf16 v[112:115], a[220:223], v[128:131], v[112:115]
    v_mfma_f32_16x16x32_bf16 v[116:119], a[224:227], v[128:131], v[116:119]
    s_waitcnt vmcnt(9)
    v_mfma_f32_16x16x32_bf16 v[100:103], a[228:231], v[132:135], v[100:103]
    buffer_load_dwordx4 v[172:175], v38, s[32:35], s60 offen offset:3072 sc1
    v_mfma_f32_16x16x32_bf16 v[104:107], a[232:235], v[132:135], v[104:107]
    v_mfma_f32_16x16x32_bf16 v[108:111], a[236:239], v[132:135], v[108:111]
    v_mfma_f32_16x16x32_bf16 v[112:115], a[240:243], v[132:135], v[112:115]
    v_mfma_f32_16x16x32_bf16 v[116:119], a[244:247], v[132:135], v[116:119]
    s_waitcnt vmcnt(9)
    v_mfma_f32_16x16x32_bf16 v[100:103], a[0:3], v[136:139], v[100:103]
    buffer_load_dwordx4 v[176:179], v39, s[32:35], s60 offen offset:0 sc1
    v_mfma_f32_16x16x32_bf16 v[104:107], a[4:7], v[136:139], v[104:107]
    v_mfma_f32_16x16x32_bf16 v[108:111], a[8:11], v[136:139], v[108:111]
    v_mfma_f32_16x16x32_bf16 v[112:115], a[12:15], v[136:139], v[112:115]
    v_mfma_f32_16x16x32_bf16 v[116:119], a[16:19], v[136:139], v[116:119]
    s_waitcnt vmcnt(9)
    v_mfma_f32_16x16x32_bf16 v[100:103], a[20:23], v[140:143], v[100:103]
    buffer_load_dwordx4 v[180:183], v35, s[32:35], s60 offen offset:1024 sc1
    v_mfma_f32_16x16x32_bf16 v[104:107], a[24:27], v[140:143], v[104:107]
    v_mfma_f32_16x16x32_bf16 v[108:111], a[28:31], v[140:143], v[108:111]
    v_mfma_f32_16x16x32_bf16 v[112:115], a[32:35], v[140:143], v[112:115]
    v_mfma_f32_16x16x32_bf16 v[116:119], a[36:39], v[140:143], v[116:119]
    s_waitcnt vmcnt(9)
    v_mfma_f32_16x16x32_bf16 v[100:103], a[40:43], v[144:147], v[100:103]
    v_mfma_f32_16x16x32_bf16 v[104:107], a[44:47], v[144:147], v[104:107]
    v_mfma_f32_16x16x32_bf16 v[108:111], a[248:251], v[144:147], v[108:111]
    v_mfma_f32_16x16x32_bf16 v[112:115], a[252:255], v[144:147], v[112:115]
    v_mfma_f32_16x16x32_bf16 v[116:119], v[232:235], v[144:147], v[116:119]
    s_waitcnt vmcnt(8)
    v_mfma_f32_16x16x32_bf16 v[100:103], v[236:239], v[148:151], v[100:103]
    v_mfma_f32_16x16x32_bf16 v[104:107], v[240:243], v[148:151], v[104:107]
    v_mfma_f32_16x16x32_bf16 v[108:111], v[244:247], v[148:151], v[108:111]
    v_mfma_f32_16x16x32_bf16 v[112:115], v[248:251], v[148:151], v[112:115]
    v_mfma_f32_16x16x32_bf16 v[116:119], v[252:255], v[148:151], v[116:119]
    s_waitcnt vmcnt(7)
    v_mfma_f32_16x16x32_bf16 v[40:43], a[168:171], v[152:155], v[40:43]
    v_mfma_f32_16x16x32_bf16 v[44:47], a[172:175], v[152:155], v[44:47]
    v_mfma_f32_16x16x32_bf16 v[48:51], a[176:179], v[152:155], v[48:51]
    v_mfma_f32_16x16x32_bf16 v[52:55], a[180:183], v[152:155], v[52:55]
    ds_write_b128 v8, v[100:103] offset:10240
    v_lshlrev_b32 v16, 16, v200
    v_mfma_f32_16x16x32_bf16 v[56:59], a[184:187], v[152:155], v[56:59]
    v_and_b32 v17, 0xffff0000, v200
    v_lshlrev_b32 v18, 16, v201
    s_waitcnt vmcnt(6)
    v_mfma_f32_16x16x32_bf16 v[40:43], a[188:191], v[156:159], v[40:43]
    v_and_b32 v19, 0xffff0000, v201
    v_lshlrev_b32 v20, 16, v202
    v_mfma_f32_16x16x32_bf16 v[44:47], a[192:195], v[156:159], v[44:47]
    v_and_b32 v21, 0xffff0000, v202
    v_lshlrev_b32 v22, 16, v203
    v_mfma_f32_16x16x32_bf16 v[48:51], a[196:199], v[156:159], v[48:51]
    v_and_b32 v23, 0xffff0000, v203
    v_lshlrev_b32 v24, 16, v204
    v_mfma_f32_16x16x32_bf16 v[52:55], a[200:203], v[156:159], v[52:55]
    v_and_b32 v25, 0xffff0000, v204
    v_lshlrev_b32 v26, 16, v205
    v_mfma_f32_16x16x32_bf16 v[56:59], a[204:207], v[156:159], v[56:59]
    v_and_b32 v27, 0xffff0000, v205
    v_lshlrev_b32 v28, 16, v206
    s_waitcnt vmcnt(5)
    v_mfma_f32_16x16x32_bf16 v[40:43], a[208:211], v[160:163], v[40:43]
    v_and_b32 v29, 0xffff0000, v206
    v_lshlrev_b32 v30, 16, v207
    v_mfma_f32_16x16x32_bf16 v[44:47], a[212:215], v[160:163], v[44:47]
    v_and_b32 v31, 0xffff0000, v207
    v_lshlrev_b32 v32, 16, v208
    v_mfma_f32_16x16x32_bf16 v[48:51], a[216:219], v[160:163], v[48:51]
    v_and_b32 v33, 0xffff0000, v208
    v_lshlrev_b32 v34, 16, v209
    v_mfma_f32_16x16x32_bf16 v[52:55], a[220:223], v[160:163], v[52:55]
    v_and_b32 v35, 0xffff0000, v209
    ds_write_b128 v8, v[104:107] offset:11264
    v_mfma_f32_16x16x32_bf16 v[56:59], a[224:227], v[160:163], v[56:59]
    ds_write_b128 v8, v[108:111] offset:12288
    ds_write_b128 v8, v[112:115] offset:13312
    s_waitcnt vmcnt(4)
    v_mfma_f32_16x16x32_bf16 v[40:43], a[228:231], v[164:167], v[40:43]
    ds_write_b128 v8, v[116:119] offset:14336
    s_waitcnt lgkmcnt(0)
    s_barrier
    v_mfma_f32_16x16x32_bf16 v[44:47], a[232:235], v[164:167], v[44:47]
    ds_read_b128 v[60:63], v5 offset:0
    ds_read_b128 v[64:67], v5 offset:5120
    ds_read_b128 v[68:71], v5 offset:10240
    v_mfma_f32_16x16x32_bf16 v[48:51], a[236:239], v[164:167], v[48:51]
    ds_read_b128 v[72:75], v5 offset:1024
    ds_read_b128 v[76:79], v5 offset:6144
    ds_read_b128 v[80:83], v5 offset:11264
    v_mfma_f32_16x16x32_bf16 v[52:55], a[240:243], v[164:167], v[52:55]
    ds_read_b128 v[84:87], v5 offset:2048
    ds_read_b128 v[88:91], v5 offset:7168
    ds_read_b128 v[92:95], v5 offset:12288
    v_mfma_f32_16x16x32_bf16 v[56:59], a[244:247], v[164:167], v[56:59]
    ds_read_b128 v[96:99], v5 offset:3072
    ds_read_b128 v[100:103], v5 offset:8192
    ds_read_b128 v[104:107], v5 offset:13312
    s_waitcnt vmcnt(3)
    v_mfma_f32_16x16x32_bf16 v[40:43], a[0:3], v[168:171], v[40:43]
    ds_read_b128 v[108:111], v5 offset:4096
    ds_read_b128 v[112:115], v5 offset:9216
    ds_read_b128 v[116:119], v5 offset:14336
    v_mfma_f32_16x16x32_bf16 v[44:47], a[4:7], v[168:171], v[44:47]
    s_waitcnt lgkmcnt(12)
    v_add_f32 v60, v60, v64
    v_add_f32 v61, v61, v65
    v_add_f32 v62, v62, v66
    v_mfma_f32_16x16x32_bf16 v[48:51], a[8:11], v[168:171], v[48:51]
    v_add_f32 v63, v63, v67
    v_add_f32 v60, v60, v68
    v_add_f32 v61, v61, v69
    v_mfma_f32_16x16x32_bf16 v[52:55], a[12:15], v[168:171], v[52:55]
    v_add_f32 v62, v62, v70
    v_add_f32 v63, v63, v71
    v_fma_f32 v60, v60, v212, v16
    v_mfma_f32_16x16x32_bf16 v[56:59], a[16:19], v[168:171], v[56:59]
    v_fma_f32 v61, v61, v213, v17
    v_fma_f32 v62, v62, v214, v18
    v_fma_f32 v63, v63, v215, v19
    s_waitcnt vmcnt(2)
    v_mfma_f32_16x16x32_bf16 v[40:43], a[20:23], v[172:175], v[40:43]
    s_waitcnt lgkmcnt(9)
    v_add_f32 v72, v72, v76
    v_add_f32 v73, v73, v77
    v_add_f32 v74, v74, v78
    v_mfma_f32_16x16x32_bf16 v[44:47], a[24:27], v[172:175], v[44:47]
    v_add_f32 v75, v75, v79
    v_add_f32 v72, v72, v80
    v_add_f32 v73, v73, v81
    v_mfma_f32_16x16x32_bf16 v[48:51], a[28:31], v[172:175], v[48:51]
    v_add_f32 v74, v74, v82
    v_add_f32 v75, v75, v83
    v_fma_f32 v72, v72, v216, v20
    v_mfma_f32_16x16x32_bf16 v[52:55], a[32:35], v[172:175], v[52:55]
    v_fma_f32 v73, v73, v217, v21
    v_fma_f32 v74, v74, v218, v22
    v_fma_f32 v75, v75, v219, v23
    v_mfma_f32_16x16x32_bf16 v[56:59], a[36:39], v[172:175], v[56:59]
    s_waitcnt lgkmcnt(6)
    v_add_f32 v84, v84, v88
    v_add_f32 v85, v85, v89
    v_add_f32 v86, v86, v90
    s_waitcnt vmcnt(1)
    v_mfma_f32_16x16x32_bf16 v[40:43], a[40:43], v[176:179], v[40:43]
    v_add_f32 v87, v87, v91
    v_add_f32 v84, v84, v92
    v_add_f32 v85, v85, v93
    v_mfma_f32_16x16x32_bf16 v[44:47], a[44:47], v[176:179], v[44:47]
    v_add_f32 v86, v86, v94
    v_add_f32 v87, v87, v95
    v_fma_f32 v84, v84, v220, v24
    v_mfma_f32_16x16x32_bf16 v[48:51], a[248:251], v[176:179], v[48:51]
    v_fma_f32 v85, v85, v221, v25
    v_fma_f32 v86, v86, v222, v26
    v_fma_f32 v87, v87, v223, v27
    v_mfma_f32_16x16x32_bf16 v[52:55], a[252:255], v[176:179], v[52:55]
    s_waitcnt lgkmcnt(3)
    v_add_f32 v96, v96, v100
    v_add_f32 v97, v97, v101
    v_add_f32 v98, v98, v102
    v_mfma_f32_16x16x32_bf16 v[56:59], v[232:235], v[176:179], v[56:59]
    v_add_f32 v99, v99, v103
    v_add_f32 v96, v96, v104
    v_add_f32 v97, v97, v105
    s_waitcnt vmcnt(0)
    v_mfma_f32_16x16x32_bf16 v[40:43], v[236:239], v[180:183], v[40:43]
    v_add_f32 v98, v98, v106
    v_add_f32 v99, v99, v107
    v_fma_f32 v96, v96, v224, v28
    v_mfma_f32_16x16x32_bf16 v[44:47], v[240:243], v[180:183], v[44:47]
    v_fma_f32 v97, v97, v225, v29
    v_fma_f32 v98, v98, v226, v30
    v_fma_f32 v99, v99, v227, v31
    v_mfma_f32_16x16x32_bf16 v[48:51], v[244:247], v[180:183], v[48:51]
    s_waitcnt lgkmcnt(0)
    v_add_f32 v108, v108, v112
    v_add_f32 v109, v109, v113
    v_add_f32 v110, v110, v114
    v_mfma_f32_16x16x32_bf16 v[52:55], v[248:251], v[180:183], v[52:55]
    v_add_f32 v111, v111, v115
    v_add_f32 v108, v108, v116
    v_add_f32 v109, v109, v117
    v_mfma_f32_16x16x32_bf16 v[56:59], v[252:255], v[180:183], v[56:59]
    v_add_f32 v110, v110, v118
    v_add_f32 v111, v111, v119
    v_fma_f32 v108, v108, v228, v32
    v_fma_f32 v109, v109, v229, v33
    v_fma_f32 v110, v110, v230, v34
    v_fma_f32 v111, v111, v231, v35
    v_pk_fma_f32 v[60:61], v[40:41], v[212:213], v[60:61]
    v_pk_fma_f32 v[62:63], v[42:43], v[214:215], v[62:63]
    v_cvt_pk_bf16_f32 v200, v60, v61
    v_cvt_pk_bf16_f32 v201, v62, v63
    v_pk_fma_f32 v[72:73], v[44:45], v[216:217], v[72:73]
    v_pk_fma_f32 v[74:75], v[46:47], v[218:219], v[74:75]
    v_cvt_pk_bf16_f32 v202, v72, v73
    v_cvt_pk_bf16_f32 v203, v74, v75
    s_nop 0
    v_permlane16_swap_b32 v200, v202
    v_permlane16_swap_b32 v201, v203
    buffer_store_dwordx4 v[200:203], v14, s[24:27], 0 offen offset:0
    v_pk_fma_f32 v[84:85], v[48:49], v[220:221], v[84:85]
    v_pk_fma_f32 v[86:87], v[50:51], v[222:223], v[86:87]
    v_cvt_pk_bf16_f32 v204, v84, v85
    v_cvt_pk_bf16_f32 v205, v86, v87
    v_pk_fma_f32 v[96:97], v[52:53], v[224:225], v[96:97]
    v_pk_fma_f32 v[98:99], v[54:55], v[226:227], v[98:99]
    v_cvt_pk_bf16_f32 v206, v96, v97
    v_cvt_pk_bf16_f32 v207, v98, v99
    s_nop 0
    v_permlane16_swap_b32 v204, v206
    v_permlane16_swap_b32 v205, v207
    buffer_store_dwordx4 v[204:207], v14, s[24:27], 0 offen offset:64
    v_pk_fma_f32 v[108:109], v[56:57], v[228:229], v[108:109]
    v_pk_fma_f32 v[110:111], v[58:59], v[230:231], v[110:111]
    v_cvt_pk_bf16_f32 v208, v108, v109
    v_cvt_pk_bf16_f32 v209, v110, v111
    buffer_store_dwordx2 v[208:209], v13, s[24:27], 0 offen offset:128
L_end:
    s_endpgm
.fill (45056 - (. - adaLN_cond__ssm_conv_h3__glu_gated_reglu__prompt_kernel)) / 4, 4, 0xbf800000
    s_endpgm
.section .rodata,"a"
.p2align 6
.amdhsa_kernel adaLN_cond__ssm_conv_h3__glu_gated_reglu__prompt_kernel
  .amdhsa_next_free_vgpr 512
  .amdhsa_next_free_sgpr 102
  .amdhsa_accum_offset 256
  .amdhsa_group_segment_fixed_size 0
  .amdhsa_kernarg_size 120
  .amdhsa_user_sgpr_count 2
  .amdhsa_user_sgpr_kernarg_segment_ptr 1
  .amdhsa_system_sgpr_workgroup_id_x 1
  .amdhsa_float_denorm_mode_32 3
.end_amdhsa_kernel
```
